```python
import torch

def _softmax(x, axis=-1):
    return torch.softmax(x, dim=axis)
def _gelu(x):
    return torch.nn.functional.gelu(x, approximate="tanh")
def _silu(x):
    return torch.nn.functional.silu(x)
def _sigmoid(x):
    return torch.sigmoid(x)
def _layernorm(x, axis=-1, eps=1e-5):
    m = x.mean(dim=axis, keepdim=True)
    v = x.var(dim=axis, keepdim=True, unbiased=False)
    return (x - m) / torch.sqrt(v + eps)
def _scatter_add(tgt, idx, src, axis=0):
    return tgt.clone().index_add_(axis, idx, src)
def _segment_sum(src, seg, n):
    out = torch.zeros((n,) + src.shape[1:], dtype=src.dtype)
    return out.index_add_(0, seg, src)
def _pad(x, pw):
    flat = tuple(v for pair in reversed(pw) for v in pair)
    return torch.nn.functional.pad(x, flat)

kernel_name = 'sequential_preLN__grouped_kv_mqa__geglu_ffn__prompt'

def setup_inputs():

    _w = (lambda a: (lambda t: t.to(torch.bfloat16) if t.is_floating_point() else t)(torch.as_tensor(a)))
    def _A_setup():
        B, S, D, H = 1, 2048, 512, 32
        Dh = D // H
        return {
            "x": _w((lambda *s: torch.randn(*s, dtype=torch.bfloat16) * 0.05)(B, S, D)),
            "wq": _w((lambda *s: torch.randn(*s, dtype=torch.bfloat16) * 0.05)(D, H * Dh)),
            "wk": _w((lambda *s: torch.randn(*s, dtype=torch.bfloat16) * 0.05)(D, Dh)),
            "wv": _w((lambda *s: torch.randn(*s, dtype=torch.bfloat16) * 0.05)(D, Dh)),
            "wo": _w((lambda *s: torch.randn(*s, dtype=torch.bfloat16) * 0.05)(H * Dh, D)),
        }
    _A_in = _A_setup()

    def _B_setup():
        B, S, D, F = 1, 2048, 512, 1792
        return {
            "x": _w((lambda *s: torch.randn(*s, dtype=torch.bfloat16) * 0.05)(B, S, D)),
            "w_gate": _w((lambda *s: torch.randn(*s, dtype=torch.bfloat16) * 0.05)(D, F)),
            "w_up": _w((lambda *s: torch.randn(*s, dtype=torch.bfloat16) * 0.05)(D, F)),
            "w_down": _w((lambda *s: torch.randn(*s, dtype=torch.bfloat16) * 0.05)(F, D)),
        }
    _B_in = _B_setup()

    return {
        "A_x": _A_in["x"],
        "A_wq": _A_in["wq"],
        "A_wk": _A_in["wk"],
        "A_wv": _A_in["wv"],
        "A_wo": _A_in["wo"],
        "B_x": _B_in["x"],
        "B_w_gate": _B_in["w_gate"],
        "B_w_up": _B_in["w_up"],
        "B_w_down": _B_in["w_down"],
    }

def reference(A_x, A_wq, A_wk, A_wv, A_wo, B_x, B_w_gate, B_w_up, B_w_down):
    def _A_ref(x, wq, wk, wv, wo):
        B, S, D = x.shape
        H = 32
        Dh = D // H
        q = (lambda x, *d: x.permute(*d))((x @ wq).reshape(B, S, H, Dh), 0, 2, 1, 3)
        k = x @ wk
        v = x @ wv
        scores = torch.einsum("bhqd,bkd->bhqk", q, k) * (Dh ** -0.5)
        p = _softmax(scores, axis=-1)
        o = torch.einsum("bhqk,bkd->bhqd", p, v)
        return (lambda x, *d: x.permute(*d))(o, 0, 2, 1, 3).reshape(B, S, H * Dh) @ wo

    def _B_ref(x, w_gate, w_up, w_down):
        return (_gelu(x @ w_gate) * (x @ w_up)) @ w_down

    x = A_x
    h = x + _A_ref(_layernorm(x, axis=-1), A_wq, A_wk, A_wv, A_wo)
    h2 = h + _B_ref(_layernorm(h, axis=-1), B_w_gate, B_w_up, B_w_down)
    return h2
```

```asm
; @launch grid=(256,1,1) block=(512,1,1) lds=163840
.amdgcn_target "amdgcn-amd-amdhsa--gfx950"
.text
.globl sequential_preLN__grouped_kv_mqa__geglu_ffn__prompt_kernel
.p2align 8
.type sequential_preLN__grouped_kv_mqa__geglu_ffn__prompt_kernel,@function
sequential_preLN__grouped_kv_mqa__geglu_ffn__prompt_kernel:
    s_load_dwordx8 s[4:11], s[0:1], 0
    s_load_dwordx2 s[12:13], s[0:1], 88
    s_cmp_ge_u32 s2, 256
    s_cbranch_scc1 M_END
    v_lshrrev_b32 v1, 6, v0
    v_and_b32 v0, 63, v0
    v_readfirstlane_b32 s32, v1
    s_and_b32 s43, s2, 7
    s_lshr_b32 s34, s2, 3
    s_lshl_b32 s33, s43, 5
    s_add_u32 s33, s33, s34
    s_lshr_b32 s96, s33, 3
    s_and_b32 s97, s34, 7
    s_add_u32 s98, s96, s97
    s_and_b32 s98, s98, 1
    s_lshl_b32 s98, s98, 2
    s_getpc_b64 s[100:101]
F_PCt:
    s_lshl_b32 s35, s34, 3
    s_add_u32 s35, s35, s32
    s_lshl_b32 s35, s35, 8
    v_lshlrev_b32 v5, 7, v0
    v_add_u32 v5, s35, v5
    v_min_u32 v5, CODE_END-F_PCt-4, v5
    s_mov_b64 exec, 3
    global_load_dword v186, v5, s[100:101]
    s_mov_b64 exec, -1
    v_lshrrev_b32 v2, 3, v0
    v_and_b32 v3, 7, v0
    v_lshrrev_b32 v4, 4, v0
    v_xor_b32 v5, v3, v4
    v_lshlrev_b32 v5, 4, v5
    v_lshl_add_u32 v64, v2, 10, v5
    v_xor_b32 v65, 64, v64
    v_add_u32 v65, 0x2000, v65
    s_cmp_ge_u32 s32, 4
    s_cbranch_scc1 F_HS
    s_load_dwordx4 s[24:27], s[0:1], 64
    s_load_dwordx2 s[14:15], s[0:1], 32
    v_lshlrev_b32 v6, 4, v0
    s_lshr_b32 s42, s97, 1
    s_lshl_b32 s40, s96, 16
    s_lshl_b32 s35, s42, 14
    s_add_u32 s40, s40, s35
    s_lshl_b32 s41, s32, 1
    s_add_u32 s41, s41, s98
    s_and_b32 s41, s41, 7
    s_lshl_b32 s35, s41, 7
    s_add_u32 s40, s40, s35
    s_lshl_b32 s41, s41, 11
    s_lshl_b32 s44, s32, 14
    s_lshl_b32 s35, s42, 11
    s_add_u32 s44, s44, s35
    s_lshl_b32 s46, s32, 12
    s_add_u32 s46, s46, 0x20000
    s_mov_b32 s18, 0x200000
    s_mov_b32 s19, 0x00020000
    s_mov_b32 s22, 0x4000
    s_mov_b32 s23, 0x00020000
    s_bitcmp0_b32 s97, 0
    s_waitcnt lgkmcnt(0)
    s_cselect_b32 s20, s8, s10
    s_cselect_b32 s21, s9, s11
    s_and_b32 s21, s21, 0xffff
    s_mov_b32 s16, s4
    s_and_b32 s17, s5, 0xffff
    s_add_u32 m0, s44, 0
    s_nop 0
    buffer_load_dwordx4 v64, s[16:19], s40 offen offset:0 lds
    s_add_u32 m0, s44, 1024
    s_nop 0
    buffer_load_dwordx4 v65, s[16:19], s40 offen offset:0 lds
    s_add_u32 m0, s44, 8064
    s_nop 0
    buffer_load_dwordx4 v64, s[16:19], s40 offen offset:128 lds
    s_add_u32 m0, s44, 9088
    s_nop 0
    buffer_load_dwordx4 v65, s[16:19], s40 offen offset:128 lds
    s_mov_b32 m0, s46
    s_mov_b32 s28, s12
    buffer_load_dwordx4 v6, s[20:23], s41 offen offset:0 lds
    buffer_load_dwordx4 v6, s[20:23], s41 offen offset:1024 lds
    buffer_load_dwordx4 v6, s[20:23], s41 offen offset:2048 lds
    buffer_load_dwordx4 v6, s[20:23], s41 offen offset:3072 lds
    s_branch F_C
F_HS:
    s_sub_u32 s37, s32, 4
    v_lshlrev_b32 v5, 2, v4
    v_and_b32 v5, 4, v5
    v_xor_b32 v5, v3, v5
    v_lshlrev_b32 v5, 4, v5
    v_lshl_add_u32 v66, v2, 10, v5
    v_add_u32 v67, 0x2000, v66
    s_lshl_b32 s35, s37, 14
    s_lshl_b32 s40, s96, 16
    s_add_u32 s40, s40, s35
    s_lshl_b32 s41, s97, 7
    s_add_u32 s41, s41, s35
    s_mov_b32 s42, s98
    s_lshl_b32 s61, s37, 11
    s_lshr_b32 s35, s97, 1
    s_cmp_eq_u32 s35, s37
    s_cselect_b32 s44, 157696, s61
    s_cselect_b32 s59, 0, 0x400
    s_cselect_b32 s46, 0, 0x2000
    s_cselect_b32 s50, 0, 0x200000
    s_mov_b32 s51, 0x00020000
    s_mov_b32 s54, 0x80000
    s_mov_b32 s55, 0x00020000
    s_waitcnt lgkmcnt(0)
    s_mov_b32 s48, s4
    s_and_b32 s49, s5, 0xffff
    s_mov_b32 s52, s6
    s_and_b32 s53, s7, 0xffff
    s_mov_b32 s14, s98
    s_mov_b32 s58, s61
    s_lshl_b32 s57, s42, 16
    s_add_u32 m0, s58, 65536
    s_add_u32 s57, s57, s41
    buffer_load_dwordx4 v66, s[52:55], s57 offen lds
    s_add_u32 m0, s58, 66560
    s_add_u32 s42, s42, 1
    buffer_load_dwordx4 v67, s[52:55], s57 offen lds
    s_and_b32 s42, s42, 7
    s_lshl_b32 s57, s42, 16
    s_add_u32 m0, s58, 73728
    s_add_u32 s57, s57, s41
    buffer_load_dwordx4 v66, s[52:55], s57 offen lds
    s_add_u32 m0, s58, 74752
    s_add_u32 s42, s42, 1
    buffer_load_dwordx4 v67, s[52:55], s57 offen lds
    s_and_b32 s42, s42, 7
    s_lshl_b32 s36, s33, 13
    s_mov_b32 s47, 0
    s_mov_b32 s30, 0x1000000
    s_mov_b32 s31, 0x00020000
    s_branch M_H
F_C:
    s_lshl_b32 s36, s33, 13
    s_mov_b32 s47, 0
    s_mov_b32 s30, 0x1000000
    s_mov_b32 s31, 0x00020000
    s_and_b32 s29, s13, 0xffff
    s_mov_b32 s35, 0x254000
    s_load_dword s99, s[12:13], s35
    v_mov_b32 v144, 0x3f803f80
    v_mov_b32 v145, 0x3f803f80
    v_mov_b32 v146, 0x3f803f80
    v_mov_b32 v147, 0x3f803f80
    v_and_b32 v7, 15, v0
    v_bfe_u32 v5, v0, 1, 3
    v_xor_b32 v5, v4, v5
    v_lshlrev_b32 v5, 4, v5
    v_lshl_add_u32 v152, v7, 7, v5
    v_add_u32 v152, s44, v152
    v_xor_b32 v153, 64, v152
    v_bfe_u32 v5, v0, 2, 2
    v_lshl_add_u32 v5, v4, 3, v5
    v_lshlrev_b32 v5, 5, v5
    v_and_b32 v154, 3, v0
    v_lshl_add_u32 v5, v154, 3, v5
    v_add_u32 v154, s46, v5
    v_lshlrev_b32 v155, 3, v7
    v_add_u32 v155, 148480, v155
    v_bfe_u32 v5, v0, 2, 2
    v_cmp_eq_u32 s[4:5], v4, v5
    v_and_b32 v5, 3, v0
    v_cmp_eq_u32 s[6:7], 1, v5
    v_cmp_eq_u32 s[8:9], 2, v5
    v_cmp_eq_u32 s[10:11], 3, v5
    s_lshl_b32 s35, s32, 11
    s_add_u32 s35, s35, 149504
    v_add_u32 v168, s35, v6
    s_lshl_b32 s35, s32, 7
    v_add_u32 v169, s35, v155
    v_mov_b32 v170, -1.0
    ds_write_b32 v169, v170 offset:4
    s_waitcnt lgkmcnt(0)
    s_barrier
    s_lshl_b32 s48, s96, 1
    s_lshr_b32 s35, s42, 1
    s_add_u32 s48, s48, s35
    s_lshl_b32 s48, s48, 11
    s_and_b32 s35, s42, 1
    s_lshl_b32 s35, s35, 8
    s_add_u32 s48, s48, s35
    s_and_b32 s35, s97, 1
    s_lshl_b32 s35, s35, 10
    s_add_u32 s48, s48, s35
    s_add_u32 s48, s48, 0x200000
    s_bitcmp0_b32 s97, 0
    s_cselect_b64 vcc, -1, 0
    v_lshrrev_b32 v5, 5, v0
    v_lshl_add_u32 v5, v5, 5, v7
    v_lshlrev_b32 v5, 4, v5
    v_bfe_u32 v184, v0, 4, 1
    v_lshl_add_u32 v5, v184, 3, v5
    v_bfe_u32 v184, v0, 3, 1
    v_lshlrev_b32 v184, 9, v184
    v_lshl_add_u32 v184, v4, 6, v184
    v_lshl_add_u32 v184, v3, 1, v184
    v_cndmask_b32 v184, v184, v5, vcc
    s_and_b32 s49, s32, 1
    s_lshr_b32 s50, s32, 1
    v_and_b32 v7, 31, v0
    s_lshl_b32 s35, s49, 5
    v_add_u32 v7, s35, v7
    v_lshrrev_b32 v1, 5, v0
    v_bfe_u32 v5, v0, 1, 3
    v_xor_b32 v5, v1, v5
    v_lshlrev_b32 v5, 4, v5
    v_lshl_add_u32 v8, v7, 7, v5
    v_xor_b32 v9, 32, v8
    v_xor_b32 v10, 64, v8
    v_xor_b32 v11, 96, v8
    v_bfe_u32 v5, v0, 2, 2
    v_lshl_add_u32 v13, v1, 3, v5
    v_bfe_u32 v12, v0, 4, 1
    s_lshl_b32 s35, s50, 1
    v_add_u32 v12, s35, v12
    v_and_b32 v5, 2, v5
    v_xor_b32 v12, v12, v5
    v_lshlrev_b32 v12, 5, v12
    v_lshl_add_u32 v12, v13, 7, v12
    v_and_b32 v5, 1, v0
    v_lshl_add_u32 v12, v5, 4, v12
    v_bfe_u32 v5, v0, 1, 1
    v_lshl_add_u32 v12, v5, 3, v12
    v_add_u32 v12, 0x10000, v12
    v_lshlrev_b32 v13, 3, v7
    v_add_u32 v13, 147456, v13
    s_lshl_b32 s35, s50, 7
    s_add_u32 s35, s35, 147968
    v_lshlrev_b32 v14, 5, v1
    v_add_u32 v14, s35, v14
    v_lshrrev_b32 v15, 3, v7
    v_lshlrev_b32 v15, 10, v15
    v_lshl_add_u32 v15, v1, 9, v15
    v_lshl_add_u32 v15, v3, 4, v15
    s_lshl_b32 s35, s50, 8
    v_add_u32 v15, s35, v15
    v_lshlrev_b32 v185, 7, v2
    v_lshl_add_u32 v185, v3, 2, v185
    s_lshl_b32 s51, s32, 10
    s_add_u32 s51, s51, 0x251000
    s_lshl_b32 s52, s96, 7
    s_lshl_b32 s35, s97, 2
    s_add_u32 s52, s52, s35
    v_mov_b32 v160, 0
    v_mov_b32 v161, 0
    v_mov_b32 v162, 0
    v_mov_b32 v163, 0
    s_waitcnt vmcnt(0) lgkmcnt(0)
    s_mul_i32 s99, s99, 0x9e3779b1
    s_add_u32 s99, s99, 0x7f4a7c15
    ds_read_b128 v[16:19], v152 offset:0
    ds_read_b64_tr_b16 v[32:33], v154 offset:0
    ds_read_b64_tr_b16 v[34:35], v154 offset:128
    ds_read_b128 v[20:23], v153 offset:0
    ds_read_b64_tr_b16 v[36:37], v154 offset:1024
    ds_read_b64_tr_b16 v[38:39], v154 offset:1152
    ds_read_b128 v[24:27], v152 offset:8192
    ds_read_b64_tr_b16 v[40:41], v154 offset:2048
    ds_read_b64_tr_b16 v[42:43], v154 offset:2176
    ds_read_b128 v[28:31], v153 offset:8192
    ds_read_b64_tr_b16 v[44:45], v154 offset:3072
    ds_read_b64_tr_b16 v[46:47], v154 offset:3200
    s_waitcnt lgkmcnt(9)
    v_mfma_f32_16x16x32_bf16 v[60:63], v[16:19], v[16:19], 0
    v_mfma_f32_16x16x32_bf16 v[56:59], v[144:147], v[16:19], 0
    v_mfma_f32_16x16x32_bf16 v[48:51], v[32:35], v[16:19], 0
    v_mfma_f32_16x16x32_bf16 v[52:55], v[32:35], v[144:147], 0
    s_waitcnt lgkmcnt(6)
    v_mfma_f32_16x16x32_bf16 v[60:63], v[20:23], v[20:23], v[60:63]
    v_mfma_f32_16x16x32_bf16 v[56:59], v[144:147], v[20:23], v[56:59]
    v_mfma_f32_16x16x32_bf16 v[48:51], v[36:39], v[20:23], v[48:51]
    v_mfma_f32_16x16x32_bf16 v[52:55], v[36:39], v[144:147], v[52:55]
    s_waitcnt lgkmcnt(3)
    v_mfma_f32_16x16x32_bf16 v[60:63], v[24:27], v[24:27], v[60:63]
    v_mfma_f32_16x16x32_bf16 v[56:59], v[144:147], v[24:27], v[56:59]
    v_mfma_f32_16x16x32_bf16 v[48:51], v[40:43], v[24:27], v[48:51]
    v_mfma_f32_16x16x32_bf16 v[52:55], v[40:43], v[144:147], v[52:55]
    s_waitcnt lgkmcnt(0)
    v_mfma_f32_16x16x32_bf16 v[60:63], v[28:31], v[28:31], v[60:63]
    v_mfma_f32_16x16x32_bf16 v[56:59], v[144:147], v[28:31], v[56:59]
    v_mfma_f32_16x16x32_bf16 v[48:51], v[44:47], v[28:31], v[48:51]
    v_mfma_f32_16x16x32_bf16 v[52:55], v[44:47], v[144:147], v[52:55]
    s_nop 4
    v_cndmask_b32 v60, v60, v61, s[6:7]
    v_cndmask_b32 v60, v60, v62, s[8:9]
    v_cndmask_b32 v57, v60, v63, s[10:11]
    ds_write_b128 v168, v[48:51]
    ds_write_b128 v168, v[52:55] offset:1024
    s_mov_b64 exec, s[4:5]
    ds_write_b64 v169, v[56:57]
    s_mov_b64 exec, -1
    s_waitcnt lgkmcnt(0)
    s_cmp_lg_u32 s32, 2
    s_cbranch_scc1 M_H1
    s_getreg_b32 s45, hwreg(HW_REG_XCC_ID, 0, 4)
    s_add_u32 s45, s45, s99
    s_lshl_b32 s35, s33, 2
    s_add_u32 s35, s35, 0x250000
    v_mov_b32 v128, s45
    v_mov_b32 v129, 0
    s_mov_b64 exec, 1
    buffer_store_dword v128, v129, s[28:31], s35 offen sc1
    s_mov_b64 exec, -1
M_H1:
    s_cmp_lg_u32 s32, 0
    s_cbranch_scc1 F_K1
    s_mov_b32 s46, 0
F_KP:
    ds_read2_b64 v[128:131], v155 offset0:0 offset1:16
    ds_read2_b64 v[136:139], v155 offset0:32 offset1:48
    ds_read_b128 v[16:19], v168 offset:0
    ds_read_b128 v[20:23], v168 offset:1024
    ds_read_b128 v[24:27], v168 offset:2048
    ds_read_b128 v[28:31], v168 offset:3072
    ds_read_b128 v[32:35], v168 offset:4096
    ds_read_b128 v[36:39], v168 offset:5120
    ds_read_b128 v[40:43], v168 offset:6144
    ds_read_b128 v[44:47], v168 offset:7168
    s_waitcnt lgkmcnt(0)
    v_min3_f32 v170, v131, v137, v139
    v_cmp_gt_f32 vcc, 0, v170
    s_cbranch_vccz F_KQ
    s_add_u32 s46, s46, 1
    s_cmp_lt_u32 s46, 131072
    s_cbranch_scc1 F_KP
F_KQ:
    v_add_f32 v128, v128, v130
    v_add_f32 v129, v129, v131
    v_add_f32 v136, v136, v138
    v_add_f32 v137, v137, v139
    v_add_f32 v128, v128, v136
    v_add_f32 v129, v129, v137
    v_mul_f32 v130, 0x3b000000, v128
    v_mul_f32 v129, 0x3b000000, v129
    v_fma_f32 v129, -v130, v130, v129
    v_max_f32 v129, 0, v129
    v_add_f32 v129, 0x3727c5ac, v129
    v_rsq_f32 v131, v129
    s_nop 0
    v_add_f32 v16, v16, v24
    v_add_f32 v17, v17, v25
    v_add_f32 v18, v18, v26
    v_add_f32 v19, v19, v27
    v_add_f32 v20, v20, v28
    v_add_f32 v21, v21, v29
    v_add_f32 v22, v22, v30
    v_add_f32 v23, v23, v31
    v_add_f32 v16, v16, v32
    v_add_f32 v17, v17, v33
    v_add_f32 v18, v18, v34
    v_add_f32 v19, v19, v35
    v_add_f32 v20, v20, v36
    v_add_f32 v21, v21, v37
    v_add_f32 v22, v22, v38
    v_add_f32 v23, v23, v39
    v_add_f32 v16, v16, v40
    v_add_f32 v17, v17, v41
    v_add_f32 v18, v18, v42
    v_add_f32 v19, v19, v43
    v_add_f32 v20, v20, v44
    v_add_f32 v21, v21, v45
    v_add_f32 v22, v22, v46
    v_add_f32 v23, v23, v47
    v_fma_f32 v16, -v130, v20, v16
    v_fma_f32 v17, -v130, v21, v17
    v_fma_f32 v18, -v130, v22, v18
    v_fma_f32 v19, -v130, v23, v19
    v_mul_f32 v16, v131, v16
    v_mul_f32 v17, v131, v17
    v_mul_f32 v18, v131, v18
    v_mul_f32 v19, v131, v19
    v_cvt_pk_bf16_f32 v136, v16, v17
    v_cvt_pk_bf16_f32 v137, v18, v19
    s_bitcmp0_b32 s97, 0
    s_cbranch_scc0 F_KV
    buffer_store_dwordx2 v[136:137], v184, s[28:31], s48 offen sc1
    s_branch F_K1
F_KV:
    buffer_store_short v136, v184, s[28:31], s48 offen sc1
    buffer_store_short_d16_hi v136, v184, s[28:31], s48 offen offset:16 sc1
    buffer_store_short v137, v184, s[28:31], s48 offen offset:32 sc1
    buffer_store_short_d16_hi v137, v184, s[28:31], s48 offen offset:48 sc1
F_K1:
    s_cmp_lg_u32 s32, 1
    s_cbranch_scc1 F_P1
    s_mov_b32 s16, s14
    s_and_b32 s17, s15, 0xffff
    s_mov_b32 s18, 0x80000
    s_mov_b32 s19, 0x00020000
    s_mov_b32 s20, s24
    s_and_b32 s21, s25, 0xffff
    s_mov_b32 s22, 0x1c0000
    s_mov_b32 s23, 0x00020000
    v_lshrrev_b32 v164, 3, v0
    v_and_b32 v160, 7, v0
    v_lshlrev_b32 v160, 4, v160
    v_lshl_add_u32 v160, v164, 10, v160
    s_lshl_b32 s40, s43, 7
    s_lshl_b32 s35, s34, 14
    s_add_u32 s35, s35, s40
    s_mov_b32 m0, 158848
    s_add_u32 s41, s35, 0x2000
    buffer_load_dwordx4 v160, s[16:19], s35 offen lds
    s_mov_b32 m0, 159872
    s_lshr_b32 s35, s34, 3
    buffer_load_dwordx4 v160, s[16:19], s41 offen lds
    s_mul_i32 s35, s35, 28
    s_add_u32 s35, s35, s97
    s_add_u32 s35, s35, 20
    s_lshl_b32 s35, s35, 14
    s_add_u32 s35, s35, s40
    s_mov_b32 m0, 160896
    s_add_u32 s41, s35, 0x2000
    buffer_load_dwordx4 v160, s[20:23], s35 offen lds
    s_mov_b32 m0, 161920
    s_lshr_b32 s35, s34, 2
    buffer_load_dwordx4 v160, s[20:23], s41 offen lds
    s_lshl_b32 s35, s35, 2
    s_lshr_b32 s41, s43, 1
    s_add_u32 s35, s35, s41
    s_lshl_b32 s35, s35, 1
    s_bfe_u32 s41, s34, 0x10001
    s_add_u32 s35, s35, s41
    s_lshl_b32 s35, s35, 13
    s_and_b32 s41, s43, 1
    s_lshl_b32 s41, s41, 12
    s_add_u32 s35, s35, s41
    s_and_b32 s41, s34, 1
    s_lshl_b32 s41, s41, 9
    s_add_u32 s35, s35, s41
    s_add_u32 s40, s35, 0x280000
    s_lshl_b32 s41, s33, 11
    s_add_u32 s41, s41, 0x700000
    v_lshrrev_b32 v164, 5, v0
    v_bfe_u32 v160, v0, 4, 1
    v_bfe_u32 v162, v0, 2, 2
    v_lshl_add_u32 v161, v160, 3, v162
    v_lshlrev_b32 v161, 7, v161
    v_lshl_add_u32 v161, v164, 5, v161
    v_and_b32 v163, 3, v0
    v_lshl_add_u32 v161, v163, 3, v161
    v_add_u32 v161, 158848, v161
    v_lshl_add_u32 v162, v164, 3, v162
    v_lshlrev_b32 v162, 7, v162
    v_lshl_add_u32 v162, v160, 5, v162
    v_and_b32 v160, 1, v0
    v_lshl_add_u32 v162, v160, 4, v162
    v_bfe_u32 v160, v0, 1, 1
    v_lshl_add_u32 v162, v160, 3, v162
    v_add_u32 v162, 160896, v162
    v_and_b32 v163, 31, v0
    v_lshlrev_b32 v163, 4, v163
    v_lshl_add_u32 v163, v164, 10, v163
    v_lshlrev_b32 v160, 4, v0
F_P1:
    s_barrier
    ds_read_b64_tr_b16 v[64:65], v12 offset:0
    ds_read_b64_tr_b16 v[66:67], v12 offset:512
    ds_read_b128 v[96:99], v8 offset:0
    ds_read_b64_tr_b16 v[68:69], v12 offset:2048
    ds_read_b64_tr_b16 v[70:71], v12 offset:2560
    ds_read_b128 v[100:103], v9 offset:0
    ds_read_b64_tr_b16 v[72:73], v12 offset:4096
    ds_read_b64_tr_b16 v[74:75], v12 offset:4608
    ds_read_b128 v[104:107], v10 offset:0
    ds_read_b64_tr_b16 v[76:77], v12 offset:6144
    ds_read_b64_tr_b16 v[78:79], v12 offset:6656
    ds_read_b128 v[108:111], v11 offset:0
    s_barrier
    ds_read_b64_tr_b16 v[80:81], v12 offset:8192
    ds_read_b64_tr_b16 v[82:83], v12 offset:8704
    ds_read_b128 v[112:115], v8 offset:8192
    s_waitcnt lgkmcnt(12)
    v_mfma_f32_32x32x16_bf16 v[48:63], v[64:67], v[96:99], 0
    v_and_b32 v187, 0x33, v0
    v_bfe_u32 v176, v0, 2, 1
    v_lshl_add_u32 v187, v176, 3, v187
    ds_read_b64_tr_b16 v[84:85], v12 offset:10240
    ds_read_b64_tr_b16 v[86:87], v12 offset:10752
    ds_read_b128 v[116:119], v9 offset:8192
    s_waitcnt lgkmcnt(12)
    v_mfma_f32_32x32x16_bf16 v[48:63], v[68:71], v[100:103], v[48:63]
    v_bfe_u32 v176, v0, 3, 1
    v_lshl_add_u32 v187, v176, 2, v187
    v_lshlrev_b32 v187, 4, v187
    ds_read_b64_tr_b16 v[88:89], v12 offset:12288
    ds_read_b64_tr_b16 v[90:91], v12 offset:12800
    ds_read_b128 v[120:123], v10 offset:8192
    s_waitcnt lgkmcnt(12)
    v_mfma_f32_32x32x16_bf16 v[48:63], v[72:75], v[104:107], v[48:63]
    v_add_u32 v187, 0x200000, v187
    v_and_b32 v176, 15, v0
    v_cmp_eq_u32 s[58:59], 0, v176
    ds_read_b64_tr_b16 v[92:93], v12 offset:14336
    ds_read_b64_tr_b16 v[94:95], v12 offset:14848
    ds_read_b128 v[124:127], v11 offset:8192
    s_waitcnt lgkmcnt(12)
    v_mfma_f32_32x32x16_bf16 v[48:63], v[76:79], v[108:111], v[48:63]
    s_mul_i32 s53, s32, 2304
    s_add_u32 s53, s53, 75776
    v_cndmask_b32 v176, 0, v144, s[58:59]
    s_barrier
    s_cmp_lg_u32 s32, 0
    s_cbranch_scc1 F_F1
    s_add_u32 s35, s52, 0x251000
    s_waitcnt vmcnt(0)
    v_mov_b32 v128, s99
    v_mov_b32 v129, 0
    s_mov_b64 exec, 1
    buffer_store_dword v128, v129, s[28:31], s35 offen sc1
    s_mov_b64 exec, -1
F_F1:
    ds_read_b64_tr_b16 v[64:65], v12 offset:16384
    ds_read_b64_tr_b16 v[66:67], v12 offset:16896
    ds_read_b128 v[96:99], v8 offset:16384
    s_waitcnt lgkmcnt(12)
    v_mfma_f32_32x32x16_bf16 v[48:63], v[80:83], v[112:115], v[48:63]
    s_mov_b32 s60, 0x07060302
    v_add_u32 v1, s53, v6
    v_add_u32 v2, 150528, v6
    ds_read_b64_tr_b16 v[68:69], v12 offset:18432
    ds_read_b64_tr_b16 v[70:71], v12 offset:18944
    ds_read_b128 v[100:103], v9 offset:16384
    s_waitcnt lgkmcnt(12)
    v_mfma_f32_32x32x16_bf16 v[48:63], v[84:87], v[116:119], v[48:63]
    v_add_u32 v3, 0x200000, v6
    ds_read_b64_tr_b16 v[72:73], v12 offset:20480
    ds_read_b64_tr_b16 v[74:75], v12 offset:20992
    ds_read_b128 v[104:107], v10 offset:16384
    s_waitcnt lgkmcnt(12)
    v_mfma_f32_32x32x16_bf16 v[48:63], v[88:91], v[120:123], v[48:63]
    ds_read_b64_tr_b16 v[76:77], v12 offset:22528
    ds_read_b64_tr_b16 v[78:79], v12 offset:23040
    ds_read_b128 v[108:111], v11 offset:16384
    s_waitcnt lgkmcnt(12)
    v_mfma_f32_32x32x16_bf16 v[48:63], v[92:95], v[124:127], v[48:63]
    s_barrier
    ds_read_b64_tr_b16 v[80:81], v12 offset:24576
    ds_read_b64_tr_b16 v[82:83], v12 offset:25088
    ds_read_b128 v[112:115], v8 offset:24576
    s_waitcnt lgkmcnt(12)
    v_mfma_f32_32x32x16_bf16 v[48:63], v[64:67], v[96:99], v[48:63]
    ds_read_b64_tr_b16 v[84:85], v12 offset:26624
    ds_read_b64_tr_b16 v[86:87], v12 offset:27136
    ds_read_b128 v[116:119], v9 offset:24576
    s_waitcnt lgkmcnt(12)
    v_mfma_f32_32x32x16_bf16 v[48:63], v[68:71], v[100:103], v[48:63]
    ds_read_b64_tr_b16 v[88:89], v12 offset:28672
    ds_read_b64_tr_b16 v[90:91], v12 offset:29184
    ds_read_b128 v[120:123], v10 offset:24576
    s_waitcnt lgkmcnt(12)
    v_mfma_f32_32x32x16_bf16 v[48:63], v[72:75], v[104:107], v[48:63]
    ds_read_b64_tr_b16 v[92:93], v12 offset:30720
    ds_read_b64_tr_b16 v[94:95], v12 offset:31232
    ds_read_b128 v[124:127], v11 offset:24576
    s_waitcnt lgkmcnt(12)
    v_mfma_f32_32x32x16_bf16 v[48:63], v[76:79], v[108:111], v[48:63]
    s_barrier
    ds_read_b64_tr_b16 v[64:65], v12 offset:32768
    ds_read_b64_tr_b16 v[66:67], v12 offset:33280
    ds_read_b128 v[96:99], v8 offset:32768
    s_waitcnt lgkmcnt(12)
    v_mfma_f32_32x32x16_bf16 v[48:63], v[80:83], v[112:115], v[48:63]
    ds_read_b64_tr_b16 v[68:69], v12 offset:34816
    ds_read_b64_tr_b16 v[70:71], v12 offset:35328
    ds_read_b128 v[100:103], v9 offset:32768
    s_waitcnt lgkmcnt(12)
    v_mfma_f32_32x32x16_bf16 v[48:63], v[84:87], v[116:119], v[48:63]
    ds_read_b64_tr_b16 v[72:73], v12 offset:36864
    ds_read_b64_tr_b16 v[74:75], v12 offset:37376
    ds_read_b128 v[104:107], v10 offset:32768
    s_waitcnt lgkmcnt(12)
    v_mfma_f32_32x32x16_bf16 v[48:63], v[88:91], v[120:123], v[48:63]
    ds_read_b64_tr_b16 v[76:77], v12 offset:38912
    ds_read_b64_tr_b16 v[78:79], v12 offset:39424
    ds_read_b128 v[108:111], v11 offset:32768
    s_waitcnt lgkmcnt(12)
    v_mfma_f32_32x32x16_bf16 v[48:63], v[92:95], v[124:127], v[48:63]
    s_barrier
    ds_read_b64_tr_b16 v[80:81], v12 offset:40960
    ds_read_b64_tr_b16 v[82:83], v12 offset:41472
    ds_read_b128 v[112:115], v8 offset:40960
    s_waitcnt lgkmcnt(12)
    v_mfma_f32_32x32x16_bf16 v[48:63], v[64:67], v[96:99], v[48:63]
    ds_read_b64_tr_b16 v[84:85], v12 offset:43008
    ds_read_b64_tr_b16 v[86:87], v12 offset:43520
    ds_read_b128 v[116:119], v9 offset:40960
    s_waitcnt lgkmcnt(12)
    v_mfma_f32_32x32x16_bf16 v[48:63], v[68:71], v[100:103], v[48:63]
    ds_read_b64_tr_b16 v[88:89], v12 offset:45056
    ds_read_b64_tr_b16 v[90:91], v12 offset:45568
    ds_read_b128 v[120:123], v10 offset:40960
    s_waitcnt lgkmcnt(12)
    v_mfma_f32_32x32x16_bf16 v[48:63], v[72:75], v[104:107], v[48:63]
    ds_read_b64_tr_b16 v[92:93], v12 offset:47104
    ds_read_b64_tr_b16 v[94:95], v12 offset:47616
    ds_read_b128 v[124:127], v11 offset:40960
    s_waitcnt lgkmcnt(12)
    v_mfma_f32_32x32x16_bf16 v[48:63], v[76:79], v[108:111], v[48:63]
    s_barrier
    s_cmp_lg_u32 s32, 1
    s_cbranch_scc1 F_P2
    s_waitcnt vmcnt(0)
    ds_read_b64_tr_b16 v[16:17], v161 offset:0
    ds_read_b64_tr_b16 v[18:19], v161 offset:512
    ds_read_b64_tr_b16 v[20:21], v161 offset:64
    ds_read_b64_tr_b16 v[22:23], v161 offset:576
    ds_read_b64_tr_b16 v[24:25], v162 offset:0
    ds_read_b64_tr_b16 v[26:27], v162 offset:512
    ds_read_b64_tr_b16 v[28:29], v162 offset:64
    ds_read_b64_tr_b16 v[30:31], v162 offset:576
    s_waitcnt lgkmcnt(0)
    buffer_store_dwordx4 v[16:19], v163, s[28:31], s40 offen sc1
    buffer_store_dwordx4 v[20:23], v163, s[28:31], s40 offen offset:2048 sc1
    buffer_store_dwordx4 v[24:27], v160, s[28:31], s41 offen sc1
    buffer_store_dwordx4 v[28:31], v160, s[28:31], s41 offen offset:1024 sc1
F_P2:
    ds_read_b64_tr_b16 v[64:65], v12 offset:49152
    ds_read_b64_tr_b16 v[66:67], v12 offset:49664
    ds_read_b128 v[96:99], v8 offset:49152
    s_waitcnt lgkmcnt(12)
    v_mfma_f32_32x32x16_bf16 v[48:63], v[80:83], v[112:115], v[48:63]
    ds_read_b64_tr_b16 v[68:69], v12 offset:51200
    ds_read_b64_tr_b16 v[70:71], v12 offset:51712
    ds_read_b128 v[100:103], v9 offset:49152
    s_waitcnt lgkmcnt(12)
    v_mfma_f32_32x32x16_bf16 v[48:63], v[84:87], v[116:119], v[48:63]
    ds_read_b64_tr_b16 v[72:73], v12 offset:53248
    ds_read_b64_tr_b16 v[74:75], v12 offset:53760
    ds_read_b128 v[104:107], v10 offset:49152
    s_waitcnt lgkmcnt(12)
    v_mfma_f32_32x32x16_bf16 v[48:63], v[88:91], v[120:123], v[48:63]
    ds_read_b64_tr_b16 v[76:77], v12 offset:55296
    ds_read_b64_tr_b16 v[78:79], v12 offset:55808
    ds_read_b128 v[108:111], v11 offset:49152
    s_waitcnt lgkmcnt(12)
    v_mfma_f32_32x32x16_bf16 v[48:63], v[92:95], v[124:127], v[48:63]
    s_barrier
    ds_read_b64_tr_b16 v[80:81], v12 offset:57344
    ds_read_b64_tr_b16 v[82:83], v12 offset:57856
    ds_read_b128 v[112:115], v8 offset:57344
    s_waitcnt lgkmcnt(12)
    v_mfma_f32_32x32x16_bf16 v[48:63], v[64:67], v[96:99], v[48:63]
    ds_read_b64_tr_b16 v[84:85], v12 offset:59392
    ds_read_b64_tr_b16 v[86:87], v12 offset:59904
    ds_read_b128 v[116:119], v9 offset:57344
    s_waitcnt lgkmcnt(12)
    v_mfma_f32_32x32x16_bf16 v[48:63], v[68:71], v[100:103], v[48:63]
    ds_read_b64_tr_b16 v[88:89], v12 offset:61440
    ds_read_b64_tr_b16 v[90:91], v12 offset:61952
    ds_read_b128 v[120:123], v10 offset:57344
    s_waitcnt lgkmcnt(12)
    v_mfma_f32_32x32x16_bf16 v[48:63], v[72:75], v[104:107], v[48:63]
    ds_read_b64_tr_b16 v[92:93], v12 offset:63488
    ds_read_b64_tr_b16 v[94:95], v12 offset:64000
    ds_read_b128 v[124:127], v11 offset:57344
    s_waitcnt lgkmcnt(12)
    v_mfma_f32_32x32x16_bf16 v[48:63], v[76:79], v[108:111], v[48:63]
    s_waitcnt lgkmcnt(9)
    v_mfma_f32_32x32x16_bf16 v[48:63], v[80:83], v[112:115], v[48:63]
    s_waitcnt lgkmcnt(6)
    v_mfma_f32_32x32x16_bf16 v[48:63], v[84:87], v[116:119], v[48:63]
    s_waitcnt lgkmcnt(3)
    v_mfma_f32_32x32x16_bf16 v[48:63], v[88:91], v[120:123], v[48:63]
    s_waitcnt lgkmcnt(0)
    v_mfma_f32_32x32x16_bf16 v[48:63], v[92:95], v[124:127], v[48:63]
    s_lshl_b32 s38, s32, 15
    s_barrier
    buffer_load_dword v186, v185, s[28:31], s51 offen sc1
    ds_read_b64 v[32:33], v13
    ds_read_b128 v[16:19], v14 offset:0
    ds_read_b128 v[20:23], v14 offset:16
    ds_read_b128 v[24:27], v14 offset:64
    ds_read_b128 v[28:31], v14 offset:80
    s_mov_b32 s46, 0
    s_waitcnt lgkmcnt(4)
    v_mul_f32 v35, 0x3b000000, v32
    v_mul_f32 v33, 0x3b000000, v33
    v_fma_f32 v33, -v35, v35, v33
    v_max_f32 v33, 0, v33
    v_add_f32 v33, 0x3727c5ac, v33
    v_rsq_f32 v36, v33
    s_nop 0
    v_mul_f32 v36, 0x3eb8aa3b, v36
    s_waitcnt lgkmcnt(0)
    v_fma_f32 v48, -v35, v16, v48
    v_fma_f32 v49, -v35, v17, v49
    v_fma_f32 v50, -v35, v18, v50
    v_fma_f32 v51, -v35, v19, v51
    v_fma_f32 v52, -v35, v20, v52
    v_fma_f32 v53, -v35, v21, v53
    v_fma_f32 v54, -v35, v22, v54
    v_fma_f32 v55, -v35, v23, v55
    v_pk_mul_f32 v[48:49], v[48:49], v[36:37] op_sel_hi:[1,0]
    v_pk_mul_f32 v[50:51], v[50:51], v[36:37] op_sel_hi:[1,0]
    v_pk_mul_f32 v[52:53], v[52:53], v[36:37] op_sel_hi:[1,0]
    v_pk_mul_f32 v[54:55], v[54:55], v[36:37] op_sel_hi:[1,0]
    v_cvt_pk_bf16_f32 v40, v48, v49
    v_cvt_pk_bf16_f32 v41, v50, v51
    v_cvt_pk_bf16_f32 v42, v52, v53
    v_cvt_pk_bf16_f32 v43, v54, v55
    ds_write_b128 v15, v[40:43] offset:0
    v_fma_f32 v56, -v35, v24, v56
    v_fma_f32 v57, -v35, v25, v57
    v_fma_f32 v58, -v35, v26, v58
    v_fma_f32 v59, -v35, v27, v59
    v_fma_f32 v60, -v35, v28, v60
    v_fma_f32 v61, -v35, v29, v61
    v_fma_f32 v62, -v35, v30, v62
    v_fma_f32 v63, -v35, v31, v63
    v_pk_mul_f32 v[56:57], v[56:57], v[36:37] op_sel_hi:[1,0]
    v_pk_mul_f32 v[58:59], v[58:59], v[36:37] op_sel_hi:[1,0]
    v_pk_mul_f32 v[60:61], v[60:61], v[36:37] op_sel_hi:[1,0]
    v_pk_mul_f32 v[62:63], v[62:63], v[36:37] op_sel_hi:[1,0]
    v_cvt_pk_bf16_f32 v44, v56, v57
    v_cvt_pk_bf16_f32 v45, v58, v59
    v_cvt_pk_bf16_f32 v46, v60, v61
    v_cvt_pk_bf16_f32 v47, v62, v63
    ds_write_b128 v15, v[44:47] offset:128
    s_lshl_b32 s35, s97, 10
    v_add_u32 v8, s35, v6
    s_mov_b32 s35, s53
    v_mov_b32 v0, 0xdddddddd
    s_waitcnt lgkmcnt(0)
    s_barrier
    ds_read_b128 v[4:7], v8
    s_cmp_lg_u32 s46, 0
    s_cbranch_scc1 F_GO
F_PL:
    s_waitcnt vmcnt(0)
    v_cmp_ne_u32 vcc, s99, v186
    s_cbranch_vccz F_PG
    s_sleep 4
    buffer_load_dword v186, v185, s[28:31], s51 offen sc1
    s_add_u32 s46, s46, 1
    s_cmp_lt_u32 s46, 131072
    s_cbranch_scc1 F_PL
    s_waitcnt vmcnt(0)
F_PG:
    buffer_load_dwordx4 v[64:67], v187, s[28:31], s38 offen offset:0 sc1
    v_mov_b32 v132, v176
    v_mov_b32 v133, v176
    v_mov_b32 v134, v176
    v_mov_b32 v135, v176
    v_mov_b32 v140, v176
    v_mov_b32 v141, v176
    v_mov_b32 v142, v176
    buffer_load_dwordx4 v[128:131], v3, s[28:31], s38 offen offset:1024 sc1
    v_mov_b32 v143, v176
    v_mov_b32 v148, v176
    v_mov_b32 v149, v176
    v_mov_b32 v150, v176
    v_mov_b32 v151, v176
    v_mov_b32 v156, v176
    v_mov_b32 v157, v176
    buffer_load_dwordx4 v[68:71], v3, s[28:31], s38 offen offset:2048 sc1
    v_mov_b32 v158, v176
    v_mov_b32 v159, v176
    v_mov_b32 v164, v176
    v_mov_b32 v165, v176
    v_mov_b32 v166, v176
    v_mov_b32 v167, v176
    v_mov_b32 v172, v176
    buffer_load_dwordx4 v[136:139], v3, s[28:31], s38 offen offset:3072 sc1
    s_add_u32 s38, s38, 0x1000
    v_mov_b32 v173, v176
    v_mov_b32 v174, v176
    v_mov_b32 v175, v176
    v_mov_b32 v180, v176
    v_mov_b32 v181, v176
    v_mov_b32 v182, v176
    v_mov_b32 v183, v176
    buffer_load_dwordx4 v[72:75], v3, s[28:31], s38 offen offset:0 sc1
    v_mov_b32 v188, v176
    v_mov_b32 v189, v176
    v_mov_b32 v190, v176
    v_mov_b32 v191, v176
    v_mov_b32 v196, v176
    v_mov_b32 v197, v176
    v_mov_b32 v198, v176
    buffer_load_dwordx4 v[144:147], v3, s[28:31], s38 offen offset:1024 sc1
    v_mov_b32 v199, v176
    v_mov_b32 v204, v176
    v_mov_b32 v205, v176
    v_mov_b32 v206, v176
    v_mov_b32 v207, v176
    v_mov_b32 v212, v176
    v_mov_b32 v213, v176
    buffer_load_dwordx4 v[76:79], v3, s[28:31], s38 offen offset:2048 sc1
    v_mov_b32 v214, v176
    v_mov_b32 v215, v176
    v_mov_b32 v220, v176
    v_mov_b32 v221, v176
    v_mov_b32 v222, v176
    v_mov_b32 v223, v176
    v_mov_b32 v228, v176
    buffer_load_dwordx4 v[152:155], v3, s[28:31], s38 offen offset:3072 sc1
    s_add_u32 s38, s38, 0x1000
    v_mov_b32 v229, v176
    v_mov_b32 v230, v176
    v_mov_b32 v231, v176
    v_mov_b32 v236, v176
    v_mov_b32 v237, v176
    v_mov_b32 v238, v176
    v_mov_b32 v239, v176
    buffer_load_dwordx4 v[80:83], v3, s[28:31], s38 offen offset:0 sc1
    v_mov_b32 v244, v176
    v_mov_b32 v245, v176
    v_mov_b32 v246, v176
    v_mov_b32 v247, v176
    v_mov_b32 v252, v176
    v_mov_b32 v253, v176
    v_mov_b32 v254, v176
    buffer_load_dwordx4 v[160:163], v3, s[28:31], s38 offen offset:1024 sc1
    v_mov_b32 v255, v176
F_GO:
    s_waitcnt vmcnt(9) lgkmcnt(0)
    v_mfma_f32_32x32x16_bf16 v[16:31], v[64:67], v[4:7], 0
    s_cmp_lg_u32 s32, 1
    s_cbranch_scc1 F_F2
    s_add_u32 s45, s52, 0x253000
    v_mov_b32 v8, s99
    v_mov_b32 v9, 0
    s_mov_b64 exec, 1
    buffer_store_dword v8, v9, s[28:31], s45 offen sc1
    s_mov_b64 exec, -1
F_F2:
    buffer_load_dwordx4 v[84:87], v3, s[28:31], s38 offen offset:2048 sc1
    buffer_load_dwordx4 v[168:171], v3, s[28:31], s38 offen offset:3072 sc1
    s_add_u32 s38, s38, 0x1000
    s_nop 9
    v_exp_f32 v16, v16
    v_exp_f32 v17, v17
    v_exp_f32 v18, v18
    v_exp_f32 v19, v19
    v_exp_f32 v20, v20
    s_waitcnt vmcnt(9)
    v_mfma_f32_32x32x16_bf16 v[32:47], v[68:71], v[4:7], 0
    buffer_load_dwordx4 v[88:91], v3, s[28:31], s38 offen offset:0 sc1
    v_permlane16_swap_b32 v128, v132
    v_permlane16_swap_b32 v129, v133
    v_permlane16_swap_b32 v130, v134
    v_permlane16_swap_b32 v131, v135
    v_exp_f32 v21, v21
    v_exp_f32 v22, v22
    v_exp_f32 v23, v23
    v_exp_f32 v24, v24
    v_exp_f32 v25, v25
    v_perm_b32 v8, v17, v16, s60
    v_perm_b32 v9, v19, v18, s60
    v_perm_b32 v10, v21, v20, s60
    v_perm_b32 v11, v23, v22, s60
    v_exp_f32 v26, v26
    v_exp_f32 v27, v27
    buffer_load_dwordx4 v[176:179], v3, s[28:31], s38 offen offset:1024 sc1
    v_exp_f32 v28, v28
    v_exp_f32 v29, v29
    v_exp_f32 v30, v30
    v_exp_f32 v31, v31
    v_perm_b32 v12, v25, v24, s60
    v_perm_b32 v13, v27, v26, s60
    v_perm_b32 v14, v29, v28, s60
    v_perm_b32 v15, v31, v30, s60
    s_waitcnt vmcnt(9)
    v_mfma_f32_32x32x16_bf16 v[16:31], v[72:75], v[4:7], 0
    v_exp_f32 v32, v32
    v_exp_f32 v33, v33
    v_exp_f32 v34, v34
    v_exp_f32 v35, v35
    v_mfma_f32_32x32x16_bf16 v[48:63], v[128:131], v[8:11], 0
    buffer_load_dwordx4 v[92:95], v3, s[28:31], s38 offen offset:2048 sc1
    v_exp_f32 v36, v36
    v_exp_f32 v37, v37
    v_exp_f32 v38, v38
    v_mfma_f32_32x32x16_bf16 v[48:63], v[132:135], v[12:15], v[48:63]
    v_permlane16_swap_b32 v136, v140
    v_permlane16_swap_b32 v137, v141
    v_permlane16_swap_b32 v138, v142
    v_permlane16_swap_b32 v139, v143
    v_exp_f32 v39, v39
    v_exp_f32 v40, v40
    v_exp_f32 v41, v41
    v_exp_f32 v42, v42
    v_smfmac_f32_32x32x32_bf16 v[48:63], v[136:139], v[32:39], v0
    v_exp_f32 v43, v43
    v_exp_f32 v44, v44
    buffer_load_dwordx4 v[184:187], v3, s[28:31], s38 offen offset:3072 sc1
    s_add_u32 s38, s38, 0x1000
    v_exp_f32 v45, v45
    v_exp_f32 v46, v46
    v_exp_f32 v47, v47
    v_exp_f32 v16, v16
    v_exp_f32 v17, v17
    v_smfmac_f32_32x32x32_bf16 v[48:63], v[140:143], v[40:47], v0
    v_exp_f32 v18, v18
    v_exp_f32 v19, v19
    v_exp_f32 v20, v20
    s_waitcnt vmcnt(9)
    v_mfma_f32_32x32x16_bf16 v[32:47], v[76:79], v[4:7], 0
    buffer_load_dwordx4 v[96:99], v3, s[28:31], s38 offen offset:0 sc1
    v_permlane16_swap_b32 v144, v148
    v_permlane16_swap_b32 v145, v149
    v_permlane16_swap_b32 v146, v150
    v_permlane16_swap_b32 v147, v151
    v_exp_f32 v21, v21
    v_exp_f32 v22, v22
    v_exp_f32 v23, v23
    v_exp_f32 v24, v24
    v_exp_f32 v25, v25
    v_exp_f32 v26, v26
    v_smfmac_f32_32x32x32_bf16 v[48:63], v[144:147], v[16:23], v0
    v_exp_f32 v27, v27
    v_exp_f32 v28, v28
    buffer_load_dwordx4 v[192:195], v3, s[28:31], s38 offen offset:1024 sc1
    v_exp_f32 v29, v29
    v_exp_f32 v30, v30
    v_exp_f32 v31, v31
    v_exp_f32 v32, v32
    v_exp_f32 v33, v33
    v_smfmac_f32_32x32x32_bf16 v[48:63], v[148:151], v[24:31], v0
    v_exp_f32 v34, v34
    v_exp_f32 v35, v35
    v_exp_f32 v36, v36
    s_waitcnt vmcnt(9)
    v_mfma_f32_32x32x16_bf16 v[16:31], v[80:83], v[4:7], 0
    buffer_load_dwordx4 v[100:103], v3, s[28:31], s38 offen offset:2048 sc1
    v_permlane16_swap_b32 v152, v156
    v_permlane16_swap_b32 v153, v157
    v_permlane16_swap_b32 v154, v158
    v_permlane16_swap_b32 v155, v159
    v_exp_f32 v37, v37
    v_exp_f32 v38, v38
    v_exp_f32 v39, v39
    v_exp_f32 v40, v40
    v_exp_f32 v41, v41
    v_exp_f32 v42, v42
    v_smfmac_f32_32x32x32_bf16 v[48:63], v[152:155], v[32:39], v0
    v_exp_f32 v43, v43
    v_exp_f32 v44, v44
    buffer_load_dwordx4 v[200:203], v3, s[28:31], s38 offen offset:3072 sc1
    s_add_u32 s38, s38, 0x1000
    v_exp_f32 v45, v45
    v_exp_f32 v46, v46
    v_exp_f32 v47, v47
    v_exp_f32 v16, v16
    v_exp_f32 v17, v17
    v_smfmac_f32_32x32x32_bf16 v[48:63], v[156:159], v[40:47], v0
    v_exp_f32 v18, v18
    v_exp_f32 v19, v19
    v_exp_f32 v20, v20
    s_waitcnt vmcnt(9)
    v_mfma_f32_32x32x16_bf16 v[32:47], v[84:87], v[4:7], 0
    buffer_load_dwordx4 v[104:107], v3, s[28:31], s38 offen offset:0 sc1
    v_permlane16_swap_b32 v160, v164
    v_permlane16_swap_b32 v161, v165
    v_permlane16_swap_b32 v162, v166
    v_permlane16_swap_b32 v163, v167
    v_exp_f32 v21, v21
    v_exp_f32 v22, v22
    v_exp_f32 v23, v23
    v_exp_f32 v24, v24
    v_exp_f32 v25, v25
    v_exp_f32 v26, v26
    v_smfmac_f32_32x32x32_bf16 v[48:63], v[160:163], v[16:23], v0
    v_exp_f32 v27, v27
    v_exp_f32 v28, v28
    buffer_load_dwordx4 v[208:211], v3, s[28:31], s38 offen offset:1024 sc1
    v_exp_f32 v29, v29
    v_exp_f32 v30, v30
    v_exp_f32 v31, v31
    v_exp_f32 v32, v32
    v_exp_f32 v33, v33
    v_smfmac_f32_32x32x32_bf16 v[48:63], v[164:167], v[24:31], v0
    v_exp_f32 v34, v34
    v_exp_f32 v35, v35
    v_exp_f32 v36, v36
    s_waitcnt vmcnt(9)
    v_mfma_f32_32x32x16_bf16 v[16:31], v[88:91], v[4:7], 0
    buffer_load_dwordx4 v[108:111], v3, s[28:31], s38 offen offset:2048 sc1
    v_permlane16_swap_b32 v168, v172
    v_permlane16_swap_b32 v169, v173
    v_permlane16_swap_b32 v170, v174
    v_permlane16_swap_b32 v171, v175
    v_exp_f32 v37, v37
    v_exp_f32 v38, v38
    v_exp_f32 v39, v39
    v_exp_f32 v40, v40
    v_exp_f32 v41, v41
    v_exp_f32 v42, v42
    v_smfmac_f32_32x32x32_bf16 v[48:63], v[168:171], v[32:39], v0
    v_exp_f32 v43, v43
    v_exp_f32 v44, v44
    buffer_load_dwordx4 v[216:219], v3, s[28:31], s38 offen offset:3072 sc1
    s_add_u32 s38, s38, 0x1000
    v_exp_f32 v45, v45
    v_exp_f32 v46, v46
    v_exp_f32 v47, v47
    v_exp_f32 v16, v16
    v_exp_f32 v17, v17
    v_smfmac_f32_32x32x32_bf16 v[48:63], v[172:175], v[40:47], v0
    v_exp_f32 v18, v18
    v_exp_f32 v19, v19
    v_exp_f32 v20, v20
    s_waitcnt vmcnt(9)
    v_mfma_f32_32x32x16_bf16 v[32:47], v[92:95], v[4:7], 0
    buffer_load_dwordx4 v[112:115], v3, s[28:31], s38 offen offset:0 sc1
    v_permlane16_swap_b32 v176, v180
    v_permlane16_swap_b32 v177, v181
    v_permlane16_swap_b32 v178, v182
    v_permlane16_swap_b32 v179, v183
    v_exp_f32 v21, v21
    v_exp_f32 v22, v22
    v_exp_f32 v23, v23
    v_exp_f32 v24, v24
    v_exp_f32 v25, v25
    v_exp_f32 v26, v26
    v_smfmac_f32_32x32x32_bf16 v[48:63], v[176:179], v[16:23], v0
    v_exp_f32 v27, v27
    v_exp_f32 v28, v28
    buffer_load_dwordx4 v[224:227], v3, s[28:31], s38 offen offset:1024 sc1
    v_exp_f32 v29, v29
    v_exp_f32 v30, v30
    v_exp_f32 v31, v31
    v_exp_f32 v32, v32
    v_exp_f32 v33, v33
    v_smfmac_f32_32x32x32_bf16 v[48:63], v[180:183], v[24:31], v0
    v_exp_f32 v34, v34
    v_exp_f32 v35, v35
    v_exp_f32 v36, v36
    s_waitcnt vmcnt(9)
    v_mfma_f32_32x32x16_bf16 v[16:31], v[96:99], v[4:7], 0
    buffer_load_dwordx4 v[116:119], v3, s[28:31], s38 offen offset:2048 sc1
    v_permlane16_swap_b32 v184, v188
    v_permlane16_swap_b32 v185, v189
    v_permlane16_swap_b32 v186, v190
    v_permlane16_swap_b32 v187, v191
    v_exp_f32 v37, v37
    v_exp_f32 v38, v38
    v_exp_f32 v39, v39
    v_exp_f32 v40, v40
    v_exp_f32 v41, v41
    v_exp_f32 v42, v42
    v_smfmac_f32_32x32x32_bf16 v[48:63], v[184:187], v[32:39], v0
    v_exp_f32 v43, v43
    v_exp_f32 v44, v44
    buffer_load_dwordx4 v[232:235], v3, s[28:31], s38 offen offset:3072 sc1
    s_add_u32 s38, s38, 0x1000
    v_exp_f32 v45, v45
    v_exp_f32 v46, v46
    v_exp_f32 v47, v47
    v_exp_f32 v16, v16
    v_exp_f32 v17, v17
    v_smfmac_f32_32x32x32_bf16 v[48:63], v[188:191], v[40:47], v0
    v_exp_f32 v18, v18
    v_exp_f32 v19, v19
    v_exp_f32 v20, v20
    s_waitcnt vmcnt(9)
    v_mfma_f32_32x32x16_bf16 v[32:47], v[100:103], v[4:7], 0
    buffer_load_dwordx4 v[120:123], v3, s[28:31], s38 offen offset:0 sc1
    v_permlane16_swap_b32 v192, v196
    v_permlane16_swap_b32 v193, v197
    v_permlane16_swap_b32 v194, v198
    v_permlane16_swap_b32 v195, v199
    v_exp_f32 v21, v21
    v_exp_f32 v22, v22
    v_exp_f32 v23, v23
    v_exp_f32 v24, v24
    v_exp_f32 v25, v25
    v_exp_f32 v26, v26
    v_smfmac_f32_32x32x32_bf16 v[48:63], v[192:195], v[16:23], v0
    v_exp_f32 v27, v27
    v_exp_f32 v28, v28
    buffer_load_dwordx4 v[240:243], v3, s[28:31], s38 offen offset:1024 sc1
    v_exp_f32 v29, v29
    v_exp_f32 v30, v30
    v_exp_f32 v31, v31
    v_exp_f32 v32, v32
    v_exp_f32 v33, v33
    v_smfmac_f32_32x32x32_bf16 v[48:63], v[196:199], v[24:31], v0
    v_exp_f32 v34, v34
    v_exp_f32 v35, v35
    v_exp_f32 v36, v36
    s_waitcnt vmcnt(9)
    v_mfma_f32_32x32x16_bf16 v[16:31], v[104:107], v[4:7], 0
    buffer_load_dwordx4 v[124:127], v3, s[28:31], s38 offen offset:2048 sc1
    v_permlane16_swap_b32 v200, v204
    v_permlane16_swap_b32 v201, v205
    v_permlane16_swap_b32 v202, v206
    v_permlane16_swap_b32 v203, v207
    v_exp_f32 v37, v37
    v_exp_f32 v38, v38
    v_exp_f32 v39, v39
    v_exp_f32 v40, v40
    v_exp_f32 v41, v41
    v_exp_f32 v42, v42
    v_smfmac_f32_32x32x32_bf16 v[48:63], v[200:203], v[32:39], v0
    v_exp_f32 v43, v43
    v_exp_f32 v44, v44
    buffer_load_dwordx4 v[248:251], v3, s[28:31], s38 offen offset:3072 sc1
    s_add_u32 s38, s38, 0x1000
    v_exp_f32 v45, v45
    v_exp_f32 v46, v46
    v_exp_f32 v47, v47
    v_exp_f32 v16, v16
    v_exp_f32 v17, v17
    v_smfmac_f32_32x32x32_bf16 v[48:63], v[204:207], v[40:47], v0
    v_exp_f32 v18, v18
    v_exp_f32 v19, v19
    v_exp_f32 v20, v20
    s_waitcnt vmcnt(9)
    v_mfma_f32_32x32x16_bf16 v[32:47], v[108:111], v[4:7], 0
    v_permlane16_swap_b32 v208, v212
    v_permlane16_swap_b32 v209, v213
    v_permlane16_swap_b32 v210, v214
    v_permlane16_swap_b32 v211, v215
    v_exp_f32 v21, v21
    v_exp_f32 v22, v22
    v_exp_f32 v23, v23
    v_exp_f32 v24, v24
    v_exp_f32 v25, v25
    v_exp_f32 v26, v26
    v_smfmac_f32_32x32x32_bf16 v[48:63], v[208:211], v[16:23], v0
    v_exp_f32 v27, v27
    v_exp_f32 v28, v28
    v_exp_f32 v29, v29
    v_exp_f32 v30, v30
    v_exp_f32 v31, v31
    v_exp_f32 v32, v32
    v_exp_f32 v33, v33
    v_smfmac_f32_32x32x32_bf16 v[48:63], v[212:215], v[24:31], v0
    v_exp_f32 v34, v34
    v_exp_f32 v35, v35
    v_exp_f32 v36, v36
    s_waitcnt vmcnt(7)
    v_mfma_f32_32x32x16_bf16 v[16:31], v[112:115], v[4:7], 0
    v_permlane16_swap_b32 v216, v220
    v_permlane16_swap_b32 v217, v221
    v_permlane16_swap_b32 v218, v222
    v_permlane16_swap_b32 v219, v223
    v_exp_f32 v37, v37
    v_exp_f32 v38, v38
    v_exp_f32 v39, v39
    v_exp_f32 v40, v40
    v_exp_f32 v41, v41
    v_exp_f32 v42, v42
    v_smfmac_f32_32x32x32_bf16 v[48:63], v[216:219], v[32:39], v0
    v_exp_f32 v43, v43
    v_exp_f32 v44, v44
    v_exp_f32 v45, v45
    v_exp_f32 v46, v46
    v_exp_f32 v47, v47
    v_exp_f32 v16, v16
    v_exp_f32 v17, v17
    v_smfmac_f32_32x32x32_bf16 v[48:63], v[220:223], v[40:47], v0
    v_exp_f32 v18, v18
    v_exp_f32 v19, v19
    v_exp_f32 v20, v20
    s_waitcnt vmcnt(5)
    v_mfma_f32_32x32x16_bf16 v[32:47], v[116:119], v[4:7], 0
    v_permlane16_swap_b32 v224, v228
    v_permlane16_swap_b32 v225, v229
    v_permlane16_swap_b32 v226, v230
    v_permlane16_swap_b32 v227, v231
    v_exp_f32 v21, v21
    v_exp_f32 v22, v22
    v_exp_f32 v23, v23
    v_exp_f32 v24, v24
    v_exp_f32 v25, v25
    v_exp_f32 v26, v26
    v_smfmac_f32_32x32x32_bf16 v[48:63], v[224:227], v[16:23], v0
    v_exp_f32 v27, v27
    v_exp_f32 v28, v28
    v_exp_f32 v29, v29
    v_exp_f32 v30, v30
    v_exp_f32 v31, v31
    v_exp_f32 v32, v32
    v_exp_f32 v33, v33
    v_smfmac_f32_32x32x32_bf16 v[48:63], v[228:231], v[24:31], v0
    v_exp_f32 v34, v34
    v_exp_f32 v35, v35
    v_exp_f32 v36, v36
    s_waitcnt vmcnt(3)
    v_mfma_f32_32x32x16_bf16 v[16:31], v[120:123], v[4:7], 0
    v_permlane16_swap_b32 v232, v236
    v_permlane16_swap_b32 v233, v237
    v_permlane16_swap_b32 v234, v238
    v_permlane16_swap_b32 v235, v239
    v_exp_f32 v37, v37
    v_exp_f32 v38, v38
    v_exp_f32 v39, v39
    v_exp_f32 v40, v40
    v_exp_f32 v41, v41
    v_exp_f32 v42, v42
    v_smfmac_f32_32x32x32_bf16 v[48:63], v[232:235], v[32:39], v0
    v_exp_f32 v43, v43
    v_exp_f32 v44, v44
    v_exp_f32 v45, v45
    v_exp_f32 v46, v46
    v_exp_f32 v47, v47
    v_exp_f32 v16, v16
    v_exp_f32 v17, v17
    v_smfmac_f32_32x32x32_bf16 v[48:63], v[236:239], v[40:47], v0
    v_exp_f32 v18, v18
    v_exp_f32 v19, v19
    v_exp_f32 v20, v20
    s_barrier
    s_waitcnt vmcnt(1)
    v_mfma_f32_32x32x16_bf16 v[32:47], v[124:127], v[4:7], 0
    ds_read_b128 v[4:7], v2
    v_add_u32 v2, 0x400, v2
    v_permlane16_swap_b32 v240, v244
    v_permlane16_swap_b32 v241, v245
    v_permlane16_swap_b32 v242, v246
    v_permlane16_swap_b32 v243, v247
    v_exp_f32 v21, v21
    v_exp_f32 v22, v22
    v_exp_f32 v23, v23
    v_exp_f32 v24, v24
    v_exp_f32 v25, v25
    v_exp_f32 v26, v26
    v_smfmac_f32_32x32x32_bf16 v[48:63], v[240:243], v[16:23], v0
    v_exp_f32 v27, v27
    v_exp_f32 v28, v28
    v_exp_f32 v29, v29
    v_exp_f32 v30, v30
    v_exp_f32 v31, v31
    v_exp_f32 v32, v32
    v_exp_f32 v33, v33
    v_smfmac_f32_32x32x32_bf16 v[48:63], v[244:247], v[24:31], v0
    v_exp_f32 v34, v34
    v_exp_f32 v35, v35
    v_exp_f32 v36, v36
    s_waitcnt lgkmcnt(0)
    s_waitcnt vmcnt(0)
    v_mfma_f32_32x32x16_bf16 v[16:31], v[64:67], v[4:7], 0
    v_bfe_u32 v3, v3, 2, 8
    s_add_u32 s35, s35, 2048
    v_permlane16_swap_b32 v248, v252
    v_permlane16_swap_b32 v249, v253
    v_permlane16_swap_b32 v250, v254
    v_permlane16_swap_b32 v251, v255
    v_exp_f32 v37, v37
    v_exp_f32 v38, v38
    v_exp_f32 v39, v39
    v_exp_f32 v40, v40
    v_exp_f32 v41, v41
    v_exp_f32 v42, v42
    v_smfmac_f32_32x32x32_bf16 v[48:63], v[248:251], v[32:39], v0
    v_exp_f32 v43, v43
    v_exp_f32 v44, v44
    v_add_u32 v3, s35, v3
    v_exp_f32 v45, v45
    v_exp_f32 v46, v46
    v_exp_f32 v47, v47
    s_mov_b32 s61, 6
.p2align 6
M_CLOOP:
    v_exp_f32 v16, v16
    v_exp_f32 v17, v17
    v_smfmac_f32_32x32x32_bf16 v[48:63], v[252:255], v[40:47], v0
    v_exp_f32 v18, v18
    v_exp_f32 v19, v19
    v_exp_f32 v20, v20
    v_mfma_f32_32x32x16_bf16 v[32:47], v[68:71], v[4:7], 0
    v_exp_f32 v21, v21
    v_exp_f32 v22, v22
    v_exp_f32 v23, v23
    v_exp_f32 v24, v24
    v_exp_f32 v25, v25
    v_perm_b32 v8, v17, v16, s60
    v_perm_b32 v9, v19, v18, s60
    v_perm_b32 v10, v21, v20, s60
    ds_write_b128 v1, v[48:51] offset:0
    v_perm_b32 v11, v23, v22, s60
    v_exp_f32 v26, v26
    ds_write_b128 v1, v[52:55] offset:1024
    v_exp_f32 v27, v27
    ds_write_b32 v3, v56 offset:0
    v_exp_f32 v28, v28
    v_exp_f32 v29, v29
    v_exp_f32 v30, v30
    v_exp_f32 v31, v31
    v_perm_b32 v12, v25, v24, s60
    v_perm_b32 v13, v27, v26, s60
    v_perm_b32 v14, v29, v28, s60
    v_perm_b32 v15, v31, v30, s60
    v_add_u32 v1, 9216, v1
    v_add_u32 v3, 9216, v3
    v_mfma_f32_32x32x16_bf16 v[16:31], v[72:75], v[4:7], 0
    v_exp_f32 v32, v32
    v_exp_f32 v33, v33
    v_exp_f32 v34, v34
    v_exp_f32 v35, v35
    s_waitcnt lgkmcnt(0)
    v_mfma_f32_32x32x16_bf16 v[48:63], v[128:131], v[8:11], 0
    v_exp_f32 v36, v36
    v_exp_f32 v37, v37
    v_exp_f32 v38, v38
    v_mfma_f32_32x32x16_bf16 v[48:63], v[132:135], v[12:15], v[48:63]
    v_exp_f32 v39, v39
    v_exp_f32 v40, v40
    v_exp_f32 v41, v41
    v_exp_f32 v42, v42
    v_smfmac_f32_32x32x32_bf16 v[48:63], v[136:139], v[32:39], v0
    v_exp_f32 v43, v43
    v_exp_f32 v44, v44
    v_exp_f32 v45, v45
    v_exp_f32 v46, v46
    v_exp_f32 v47, v47
    v_exp_f32 v16, v16
    v_exp_f32 v17, v17
    v_smfmac_f32_32x32x32_bf16 v[48:63], v[140:143], v[40:47], v0
    v_exp_f32 v18, v18
    v_exp_f32 v19, v19
    v_exp_f32 v20, v20
    v_mfma_f32_32x32x16_bf16 v[32:47], v[76:79], v[4:7], 0
    v_exp_f32 v21, v21
    v_exp_f32 v22, v22
    v_exp_f32 v23, v23
    s_wakeup
    v_exp_f32 v24, v24
    v_exp_f32 v25, v25
    v_exp_f32 v26, v26
    v_smfmac_f32_32x32x32_bf16 v[48:63], v[144:147], v[16:23], v0
    v_exp_f32 v27, v27
    v_exp_f32 v28, v28
    v_exp_f32 v29, v29
    v_exp_f32 v30, v30
    v_exp_f32 v31, v31
    v_exp_f32 v32, v32
    v_exp_f32 v33, v33
    v_smfmac_f32_32x32x32_bf16 v[48:63], v[148:151], v[24:31], v0
    v_exp_f32 v34, v34
    v_exp_f32 v35, v35
    v_exp_f32 v36, v36
    v_mfma_f32_32x32x16_bf16 v[16:31], v[80:83], v[4:7], 0
    v_exp_f32 v37, v37
    v_exp_f32 v38, v38
    v_exp_f32 v39, v39
    v_exp_f32 v40, v40
    v_exp_f32 v41, v41
    v_exp_f32 v42, v42
    v_smfmac_f32_32x32x32_bf16 v[48:63], v[152:155], v[32:39], v0
    v_exp_f32 v43, v43
    v_exp_f32 v44, v44
    v_exp_f32 v45, v45
    v_exp_f32 v46, v46
    v_exp_f32 v47, v47
    v_exp_f32 v16, v16
    v_exp_f32 v17, v17
    v_smfmac_f32_32x32x32_bf16 v[48:63], v[156:159], v[40:47], v0
    v_exp_f32 v18, v18
    v_exp_f32 v19, v19
    v_exp_f32 v20, v20
    v_mfma_f32_32x32x16_bf16 v[32:47], v[84:87], v[4:7], 0
    v_exp_f32 v21, v21
    v_exp_f32 v22, v22
    v_exp_f32 v23, v23
    v_exp_f32 v24, v24
    v_exp_f32 v25, v25
    v_exp_f32 v26, v26
    v_smfmac_f32_32x32x32_bf16 v[48:63], v[160:163], v[16:23], v0
    v_exp_f32 v27, v27
    v_exp_f32 v28, v28
    v_exp_f32 v29, v29
    v_exp_f32 v30, v30
    v_exp_f32 v31, v31
    v_exp_f32 v32, v32
    v_exp_f32 v33, v33
    v_smfmac_f32_32x32x32_bf16 v[48:63], v[164:167], v[24:31], v0
    v_exp_f32 v34, v34
    v_exp_f32 v35, v35
    v_exp_f32 v36, v36
    v_mfma_f32_32x32x16_bf16 v[16:31], v[88:91], v[4:7], 0
    v_exp_f32 v37, v37
    v_exp_f32 v38, v38
    v_exp_f32 v39, v39
    v_exp_f32 v40, v40
    v_exp_f32 v41, v41
    v_exp_f32 v42, v42
    v_smfmac_f32_32x32x32_bf16 v[48:63], v[168:171], v[32:39], v0
    v_exp_f32 v43, v43
    v_exp_f32 v44, v44
    v_exp_f32 v45, v45
    v_exp_f32 v46, v46
    v_exp_f32 v47, v47
    v_exp_f32 v16, v16
    v_exp_f32 v17, v17
    v_smfmac_f32_32x32x32_bf16 v[48:63], v[172:175], v[40:47], v0
    v_exp_f32 v18, v18
    v_exp_f32 v19, v19
    v_exp_f32 v20, v20
    v_mfma_f32_32x32x16_bf16 v[32:47], v[92:95], v[4:7], 0
    v_exp_f32 v21, v21
    v_exp_f32 v22, v22
    v_exp_f32 v23, v23
    v_exp_f32 v24, v24
    v_exp_f32 v25, v25
    v_exp_f32 v26, v26
    v_smfmac_f32_32x32x32_bf16 v[48:63], v[176:179], v[16:23], v0
    v_exp_f32 v27, v27
    v_exp_f32 v28, v28
    v_exp_f32 v29, v29
    v_exp_f32 v30, v30
    v_exp_f32 v31, v31
    v_exp_f32 v32, v32
    v_exp_f32 v33, v33
    v_smfmac_f32_32x32x32_bf16 v[48:63], v[180:183], v[24:31], v0
    v_exp_f32 v34, v34
    v_exp_f32 v35, v35
    v_exp_f32 v36, v36
    v_mfma_f32_32x32x16_bf16 v[16:31], v[96:99], v[4:7], 0
    v_exp_f32 v37, v37
    v_exp_f32 v38, v38
    v_exp_f32 v39, v39
    v_exp_f32 v40, v40
    v_exp_f32 v41, v41
    v_exp_f32 v42, v42
    v_smfmac_f32_32x32x32_bf16 v[48:63], v[184:187], v[32:39], v0
    v_exp_f32 v43, v43
    v_exp_f32 v44, v44
    v_exp_f32 v45, v45
    v_exp_f32 v46, v46
    v_exp_f32 v47, v47
    v_exp_f32 v16, v16
    v_exp_f32 v17, v17
    v_smfmac_f32_32x32x32_bf16 v[48:63], v[188:191], v[40:47], v0
    v_exp_f32 v18, v18
    v_exp_f32 v19, v19
    v_exp_f32 v20, v20
    v_mfma_f32_32x32x16_bf16 v[32:47], v[100:103], v[4:7], 0
    v_exp_f32 v21, v21
    v_exp_f32 v22, v22
    v_exp_f32 v23, v23
    s_sub_u32 s61, s61, 1
    v_exp_f32 v24, v24
    v_exp_f32 v25, v25
    v_exp_f32 v26, v26
    v_smfmac_f32_32x32x32_bf16 v[48:63], v[192:195], v[16:23], v0
    v_exp_f32 v27, v27
    v_exp_f32 v28, v28
    v_exp_f32 v29, v29
    v_exp_f32 v30, v30
    v_exp_f32 v31, v31
    v_exp_f32 v32, v32
    v_exp_f32 v33, v33
    v_smfmac_f32_32x32x32_bf16 v[48:63], v[196:199], v[24:31], v0
    v_exp_f32 v34, v34
    v_exp_f32 v35, v35
    v_exp_f32 v36, v36
    v_mfma_f32_32x32x16_bf16 v[16:31], v[104:107], v[4:7], 0
    v_exp_f32 v37, v37
    v_exp_f32 v38, v38
    v_exp_f32 v39, v39
    v_exp_f32 v40, v40
    v_exp_f32 v41, v41
    v_exp_f32 v42, v42
    v_smfmac_f32_32x32x32_bf16 v[48:63], v[200:203], v[32:39], v0
    v_exp_f32 v43, v43
    v_exp_f32 v44, v44
    v_exp_f32 v45, v45
    v_exp_f32 v46, v46
    v_exp_f32 v47, v47
    v_exp_f32 v16, v16
    v_exp_f32 v17, v17
    v_smfmac_f32_32x32x32_bf16 v[48:63], v[204:207], v[40:47], v0
    v_exp_f32 v18, v18
    v_exp_f32 v19, v19
    v_exp_f32 v20, v20
    v_mfma_f32_32x32x16_bf16 v[32:47], v[108:111], v[4:7], 0
    v_exp_f32 v21, v21
    v_exp_f32 v22, v22
    v_exp_f32 v23, v23
    v_exp_f32 v24, v24
    v_exp_f32 v25, v25
    v_exp_f32 v26, v26
    v_smfmac_f32_32x32x32_bf16 v[48:63], v[208:211], v[16:23], v0
    v_exp_f32 v27, v27
    v_exp_f32 v28, v28
    v_exp_f32 v29, v29
    v_exp_f32 v30, v30
    v_exp_f32 v31, v31
    v_exp_f32 v32, v32
    v_exp_f32 v33, v33
    v_smfmac_f32_32x32x32_bf16 v[48:63], v[212:215], v[24:31], v0
    v_exp_f32 v34, v34
    v_exp_f32 v35, v35
    v_exp_f32 v36, v36
    v_mfma_f32_32x32x16_bf16 v[16:31], v[112:115], v[4:7], 0
    v_exp_f32 v37, v37
    v_exp_f32 v38, v38
    v_exp_f32 v39, v39
    v_exp_f32 v40, v40
    v_exp_f32 v41, v41
    v_exp_f32 v42, v42
    v_smfmac_f32_32x32x32_bf16 v[48:63], v[216:219], v[32:39], v0
    v_exp_f32 v43, v43
    v_exp_f32 v44, v44
    v_exp_f32 v45, v45
    v_exp_f32 v46, v46
    v_exp_f32 v47, v47
    v_exp_f32 v16, v16
    v_exp_f32 v17, v17
    v_smfmac_f32_32x32x32_bf16 v[48:63], v[220:223], v[40:47], v0
    v_exp_f32 v18, v18
    v_exp_f32 v19, v19
    v_exp_f32 v20, v20
    v_mfma_f32_32x32x16_bf16 v[32:47], v[116:119], v[4:7], 0
    v_exp_f32 v21, v21
    v_exp_f32 v22, v22
    v_exp_f32 v23, v23
    v_exp_f32 v24, v24
    v_exp_f32 v25, v25
    v_exp_f32 v26, v26
    v_smfmac_f32_32x32x32_bf16 v[48:63], v[224:227], v[16:23], v0
    v_exp_f32 v27, v27
    v_exp_f32 v28, v28
    v_exp_f32 v29, v29
    v_exp_f32 v30, v30
    v_exp_f32 v31, v31
    v_exp_f32 v32, v32
    v_exp_f32 v33, v33
    v_smfmac_f32_32x32x32_bf16 v[48:63], v[228:231], v[24:31], v0
    v_exp_f32 v34, v34
    v_exp_f32 v35, v35
    v_exp_f32 v36, v36
    v_mfma_f32_32x32x16_bf16 v[16:31], v[120:123], v[4:7], 0
    v_exp_f32 v37, v37
    v_exp_f32 v38, v38
    v_exp_f32 v39, v39
    v_exp_f32 v40, v40
    v_exp_f32 v41, v41
    v_exp_f32 v42, v42
    v_smfmac_f32_32x32x32_bf16 v[48:63], v[232:235], v[32:39], v0
    v_exp_f32 v43, v43
    v_exp_f32 v44, v44
    v_exp_f32 v45, v45
    v_exp_f32 v46, v46
    v_exp_f32 v47, v47
    v_exp_f32 v16, v16
    v_exp_f32 v17, v17
    v_smfmac_f32_32x32x32_bf16 v[48:63], v[236:239], v[40:47], v0
    v_exp_f32 v18, v18
    v_exp_f32 v19, v19
    v_exp_f32 v20, v20
    v_mfma_f32_32x32x16_bf16 v[32:47], v[124:127], v[4:7], 0
    ds_read_b128 v[4:7], v2
    v_add_u32 v2, 0x400, v2
    v_exp_f32 v21, v21
    v_exp_f32 v22, v22
    v_exp_f32 v23, v23
    v_exp_f32 v24, v24
    v_exp_f32 v25, v25
    v_exp_f32 v26, v26
    v_smfmac_f32_32x32x32_bf16 v[48:63], v[240:243], v[16:23], v0
    v_exp_f32 v27, v27
    v_exp_f32 v28, v28
    v_exp_f32 v29, v29
    v_exp_f32 v30, v30
    v_exp_f32 v31, v31
    v_exp_f32 v32, v32
    v_exp_f32 v33, v33
    v_smfmac_f32_32x32x32_bf16 v[48:63], v[244:247], v[24:31], v0
    v_exp_f32 v34, v34
    v_exp_f32 v35, v35
    v_exp_f32 v36, v36
    s_waitcnt lgkmcnt(0)
    v_mfma_f32_32x32x16_bf16 v[16:31], v[64:67], v[4:7], 0
    v_exp_f32 v37, v37
    v_exp_f32 v38, v38
    v_exp_f32 v39, v39
    v_exp_f32 v40, v40
    v_exp_f32 v41, v41
    v_exp_f32 v42, v42
    v_smfmac_f32_32x32x32_bf16 v[48:63], v[248:251], v[32:39], v0
    v_exp_f32 v43, v43
    v_exp_f32 v44, v44
    v_exp_f32 v45, v45
    v_exp_f32 v46, v46
    v_exp_f32 v47, v47
    s_cbranch_scc0 M_CLOOP
    s_nop 1
    v_smfmac_f32_32x32x32_bf16 v[48:63], v[252:255], v[40:47], v0
    s_wakeup
    v_nop
    v_nop
    v_nop
    v_nop
    v_nop
    v_nop
    v_nop
    v_nop
    v_nop
    v_nop
    v_mbcnt_lo_u32_b32 v0, -1, 0
    v_mbcnt_hi_u32_b32 v0, -1, v0
    ds_write_b128 v1, v[48:51] offset:0
    ds_write_b128 v1, v[52:55] offset:1024
    ds_write_b32 v3, v56 offset:0
    s_waitcnt lgkmcnt(0)
    s_wakeup
M_CFIN:
    v_lshlrev_b32 v12, 4, v0
    v_lshrrev_b32 v10, 5, v0
    v_bfe_u32 v11, v0, 2, 2
    v_lshl_add_u32 v10, v10, 3, v11
    v_lshlrev_b32 v10, 7, v10
    v_bfe_u32 v11, v0, 3, 2
    v_lshl_add_u32 v10, v11, 5, v10
    v_bfe_u32 v11, v0, 4, 1
    v_lshl_add_u32 v10, v11, 16, v10
    v_and_b32 v11, 1, v0
    v_lshl_add_u32 v10, v11, 4, v10
    v_bfe_u32 v11, v0, 1, 1
    v_lshl_add_u32 v14, v11, 3, v10
    v_xor_b32 v15, 32, v14
    v_xor_b32 v16, 64, v14
    v_xor_b32 v17, 96, v14
    s_mov_b32 s40, 0x3e60ec05
    s_mov_b32 s41, 0x3e60ec05
    v_mov_b32 v22, 0x409d30fc
    v_mov_b32 v23, 0x409d30fc
    s_lshl_b32 s45, s43, 3
    s_add_u32 s45, s45, s32
    s_lshl_b32 s39, s45, 15
    s_add_u32 s39, s39, 0x500000
    s_mul_i32 s42, s45, 114688
    s_lshl_b32 s35, s34, 12
    s_add_u32 s42, s42, s35
    s_add_u32 s42, s42, 0x800000
    v_bfe_u32 v13, v0, 2, 2
    v_lshlrev_b32 v13, 7, v13
    v_and_b32 v11, 3, v0
    v_lshl_add_u32 v13, v11, 2, v13
    s_lshl_b32 s44, s45, 9
    s_add_u32 s44, s44, 0x240000
    v_and_b32 v10, 31, v0
    v_lshlrev_b32 v10, 2, v10
    s_lshl_b32 s35, s43, 7
    s_add_u32 s35, s35, 0x250000
    buffer_load_dword v11, v10, s[28:31], s35 offen sc1
    s_lshr_b32 s35, s34, 2
    s_lshl_b32 s35, s35, 2
    s_add_u32 s35, s35, s32
    s_lshl_b32 s35, s35, 14
    s_add_u32 s45, s35, 0x700000
    buffer_load_dwordx4 v[192:195], v12, s[28:31], s45 offen offset:0 sc1
    buffer_load_dwordx4 v[196:199], v12, s[28:31], s45 offen offset:1024 sc1
    buffer_load_dwordx4 v[200:203], v12, s[28:31], s45 offen offset:2048 sc1
    buffer_load_dwordx4 v[204:207], v12, s[28:31], s45 offen offset:3072 sc1
    s_add_u32 s45, s35, 0x701000
    buffer_load_dwordx4 v[208:211], v12, s[28:31], s45 offen offset:0 sc1
    buffer_load_dwordx4 v[212:215], v12, s[28:31], s45 offen offset:1024 sc1
    buffer_load_dwordx4 v[216:219], v12, s[28:31], s45 offen offset:2048 sc1
    buffer_load_dwordx4 v[220:223], v12, s[28:31], s45 offen offset:3072 sc1
    s_add_u32 s45, s35, 0x702000
    buffer_load_dwordx4 v[224:227], v12, s[28:31], s45 offen offset:0 sc1
    buffer_load_dwordx4 v[228:231], v12, s[28:31], s45 offen offset:1024 sc1
    buffer_load_dwordx4 v[232:235], v12, s[28:31], s45 offen offset:2048 sc1
    buffer_load_dwordx4 v[236:239], v12, s[28:31], s45 offen offset:3072 sc1
    s_add_u32 s45, s35, 0x703000
    buffer_load_dwordx4 v[240:243], v12, s[28:31], s45 offen offset:0 sc1
    buffer_load_dwordx4 v[244:247], v12, s[28:31], s45 offen offset:1024 sc1
    buffer_load_dwordx4 v[248:251], v12, s[28:31], s45 offen offset:2048 sc1
    buffer_load_dwordx4 v[252:255], v12, s[28:31], s45 offen offset:3072 sc1
    s_waitcnt vmcnt(16)
    s_getreg_b32 s23, hwreg(HW_REG_XCC_ID, 0, 4)
    s_add_u32 s23, s23, s99
    v_cmp_ne_u32 vcc, s23, v11
    s_cmp_eq_u64 vcc, 0
    s_cselect_b32 s3, 1, 0
    s_mov_b32 s56, s24
    s_and_b32 s57, s25, 0xffff
    s_mov_b32 s58, 0x1c0000
    s_mov_b32 s59, 0x00020000
    v_lshrrev_b32 v5, 3, v0
    v_bfe_u32 v6, v0, 4, 1
    v_lshlrev_b32 v6, 2, v6
    v_and_b32 v7, 7, v0
    v_xor_b32 v7, v7, v6
    v_lshlrev_b32 v7, 4, v7
    v_lshl_add_u32 v9, v5, 10, v7
    s_mul_i32 s22, s32, 458752
    s_lshr_b32 s35, s34, 2
    s_lshl_b32 s35, s35, 7
    s_add_u32 s22, s22, s35
    s_lshr_b32 s20, s32, 1
    s_lshl_b32 s20, s20, 16
    s_and_b32 s21, s32, 1
    s_lshl_b32 s21, s21, 13
    s_add_u32 s20, s20, s21
    s_lshl_b32 s21, s32, 13
    s_add_u32 s21, s21, 0x20000
    s_add_u32 s35, s21, 0x1fe0
    v_mov_b32 v8, s35
    v_and_b32 v4, 3, v0
    v_lshlrev_b32 v4, 13, v4
    s_lshl_b32 s35, s32, 2
    s_add_u32 s35, s35, 0x21fe0
    v_add_u32 v4, s35, v4
    v_mov_b32 v5, 32
    v_add_u32 v10, -16, v8
    s_barrier
    ds_read_b32 v11, v10
    s_waitcnt lgkmcnt(0)
    v_cmp_ne_u32 vcc, 0, v11
    s_cbranch_vccnz M_CSLOW
    s_cmp_ge_u32 s34, 28
    s_cbranch_scc1 M_CD0
    s_mov_b32 s46, 0
M_PLA:
    buffer_load_dword v10, v13, s[28:31], s44 offen sc1
    s_waitcnt vmcnt(0)
    v_cmp_ne_u32 vcc, s99, v10
    s_cbranch_vccz M_PGA
    s_add_u32 s46, s46, 1
    s_sleep 2
    s_cmp_lt_u32 s46, 131072
    s_cbranch_scc1 M_PLA
M_PGA:
    s_setprio 3
    buffer_load_dwordx4 v[128:131], v12, s[28:31], s39 offen offset:0 sc1
    buffer_load_dwordx4 v[132:135], v12, s[28:31], s39 offen offset:1024 sc1
    buffer_load_dwordx4 v[136:139], v12, s[28:31], s39 offen offset:2048 sc1
    buffer_load_dwordx4 v[140:143], v12, s[28:31], s39 offen offset:3072 sc1
    s_add_u32 s39, s39, 0x1000
    buffer_load_dwordx4 v[144:147], v12, s[28:31], s39 offen offset:0 sc1
    buffer_load_dwordx4 v[148:151], v12, s[28:31], s39 offen offset:1024 sc1
    buffer_load_dwordx4 v[152:155], v12, s[28:31], s39 offen offset:2048 sc1
    buffer_load_dwordx4 v[156:159], v12, s[28:31], s39 offen offset:3072 sc1
    s_add_u32 s39, s39, 0x1000
    buffer_load_dwordx4 v[160:163], v12, s[28:31], s39 offen offset:0 sc1
    buffer_load_dwordx4 v[164:167], v12, s[28:31], s39 offen offset:1024 sc1
    ds_read_b64_tr_b16 v[32:33], v14 offset:0
    ds_read_b64_tr_b16 v[34:35], v14 offset:512
    ds_read_b64_tr_b16 v[36:37], v15 offset:0
    ds_read_b64_tr_b16 v[38:39], v15 offset:512
    ds_read_b64_tr_b16 v[40:41], v16 offset:0
    ds_read_b64_tr_b16 v[42:43], v16 offset:512
    ds_read_b64_tr_b16 v[44:45], v17 offset:0
    ds_read_b64_tr_b16 v[46:47], v17 offset:512
    ds_read_b64_tr_b16 v[48:49], v14 offset:2048
    ds_read_b64_tr_b16 v[50:51], v14 offset:2560
    ds_read_b64_tr_b16 v[52:53], v15 offset:2048
    ds_read_b64_tr_b16 v[54:55], v15 offset:2560
    ds_read_b64_tr_b16 v[56:57], v16 offset:2048
    ds_read_b64_tr_b16 v[58:59], v16 offset:2560
    s_waitcnt vmcnt(9) lgkmcnt(10)
    v_mfma_f32_32x32x16_bf16 v[64:79], v[32:35], v[128:131], 0
    ds_read_b64_tr_b16 v[60:61], v17 offset:2048
    ds_read_b64_tr_b16 v[62:63], v17 offset:2560
    v_mfma_f32_32x32x16_bf16 v[80:95], v[36:39], v[128:131], 0
    buffer_load_dwordx4 v[168:171], v12, s[28:31], s39 offen offset:2048 sc1
    ds_read_b64_tr_b16 v[32:33], v14 offset:4096
    ds_read_b64_tr_b16 v[34:35], v14 offset:4608
    s_waitcnt lgkmcnt(10)
    v_mfma_f32_32x32x16_bf16 v[96:111], v[40:43], v[128:131], 0
    ds_read_b64_tr_b16 v[36:37], v15 offset:4096
    ds_read_b64_tr_b16 v[38:39], v15 offset:4608
    v_mfma_f32_32x32x16_bf16 v[112:127], v[44:47], v[128:131], 0
    ds_read_b64_tr_b16 v[40:41], v16 offset:4096
    ds_read_b64_tr_b16 v[42:43], v16 offset:4608
    s_waitcnt vmcnt(9) lgkmcnt(10)
    v_mfma_f32_32x32x16_bf16 v[64:79], v[48:51], v[132:135], v[64:79]
    ds_read_b64_tr_b16 v[44:45], v17 offset:4096
    ds_read_b64_tr_b16 v[46:47], v17 offset:4608
    v_mfma_f32_32x32x16_bf16 v[80:95], v[52:55], v[132:135], v[80:95]
    buffer_load_dwordx4 v[172:175], v12, s[28:31], s39 offen offset:3072 sc1
    ds_read_b64_tr_b16 v[48:49], v14 offset:6144
    ds_read_b64_tr_b16 v[50:51], v14 offset:6656
    s_waitcnt lgkmcnt(10)
    v_mfma_f32_32x32x16_bf16 v[96:111], v[56:59], v[132:135], v[96:111]
    ds_read_b64_tr_b16 v[52:53], v15 offset:6144
    ds_read_b64_tr_b16 v[54:55], v15 offset:6656
    v_mfma_f32_32x32x16_bf16 v[112:127], v[60:63], v[132:135], v[112:127]
    ds_read_b64_tr_b16 v[56:57], v16 offset:6144
    ds_read_b64_tr_b16 v[58:59], v16 offset:6656
    s_waitcnt vmcnt(9) lgkmcnt(10)
    v_mfma_f32_32x32x16_bf16 v[64:79], v[32:35], v[136:139], v[64:79]
    ds_read_b64_tr_b16 v[60:61], v17 offset:6144
    ds_read_b64_tr_b16 v[62:63], v17 offset:6656
    v_mfma_f32_32x32x16_bf16 v[80:95], v[36:39], v[136:139], v[80:95]
    s_add_u32 s39, s39, 0x1000
    buffer_load_dwordx4 v[176:179], v12, s[28:31], s39 offen offset:0 sc1
    ds_read_b64_tr_b16 v[32:33], v14 offset:8192
    ds_read_b64_tr_b16 v[34:35], v14 offset:8704
    s_waitcnt lgkmcnt(10)
    v_mfma_f32_32x32x16_bf16 v[96:111], v[40:43], v[136:139], v[96:111]
    ds_read_b64_tr_b16 v[36:37], v15 offset:8192
    ds_read_b64_tr_b16 v[38:39], v15 offset:8704
    v_mfma_f32_32x32x16_bf16 v[112:127], v[44:47], v[136:139], v[112:127]
    ds_read_b64_tr_b16 v[40:41], v16 offset:8192
    ds_read_b64_tr_b16 v[42:43], v16 offset:8704
    s_waitcnt vmcnt(9) lgkmcnt(10)
    v_mfma_f32_32x32x16_bf16 v[64:79], v[48:51], v[140:143], v[64:79]
    ds_read_b64_tr_b16 v[44:45], v17 offset:8192
    ds_read_b64_tr_b16 v[46:47], v17 offset:8704
    v_mfma_f32_32x32x16_bf16 v[80:95], v[52:55], v[140:143], v[80:95]
    buffer_load_dwordx4 v[180:183], v12, s[28:31], s39 offen offset:1024 sc1
    ds_read_b64_tr_b16 v[48:49], v14 offset:10240
    ds_read_b64_tr_b16 v[50:51], v14 offset:10752
    s_waitcnt lgkmcnt(10)
    v_mfma_f32_32x32x16_bf16 v[96:111], v[56:59], v[140:143], v[96:111]
    ds_read_b64_tr_b16 v[52:53], v15 offset:10240
    ds_read_b64_tr_b16 v[54:55], v15 offset:10752
    v_mfma_f32_32x32x16_bf16 v[112:127], v[60:63], v[140:143], v[112:127]
    ds_read_b64_tr_b16 v[56:57], v16 offset:10240
    ds_read_b64_tr_b16 v[58:59], v16 offset:10752
    s_waitcnt vmcnt(9) lgkmcnt(10)
    v_mfma_f32_32x32x16_bf16 v[64:79], v[32:35], v[144:147], v[64:79]
    ds_read_b64_tr_b16 v[60:61], v17 offset:10240
    ds_read_b64_tr_b16 v[62:63], v17 offset:10752
    v_mfma_f32_32x32x16_bf16 v[80:95], v[36:39], v[144:147], v[80:95]
    buffer_load_dwordx4 v[184:187], v12, s[28:31], s39 offen offset:2048 sc1
    ds_read_b64_tr_b16 v[32:33], v14 offset:12288
    ds_read_b64_tr_b16 v[34:35], v14 offset:12800
    s_waitcnt lgkmcnt(10)
    v_mfma_f32_32x32x16_bf16 v[96:111], v[40:43], v[144:147], v[96:111]
    ds_read_b64_tr_b16 v[36:37], v15 offset:12288
    ds_read_b64_tr_b16 v[38:39], v15 offset:12800
    v_mfma_f32_32x32x16_bf16 v[112:127], v[44:47], v[144:147], v[112:127]
    ds_read_b64_tr_b16 v[40:41], v16 offset:12288
    ds_read_b64_tr_b16 v[42:43], v16 offset:12800
    s_waitcnt vmcnt(9) lgkmcnt(10)
    v_mfma_f32_32x32x16_bf16 v[64:79], v[48:51], v[148:151], v[64:79]
    ds_read_b64_tr_b16 v[44:45], v17 offset:12288
    ds_read_b64_tr_b16 v[46:47], v17 offset:12800
    v_mfma_f32_32x32x16_bf16 v[80:95], v[52:55], v[148:151], v[80:95]
    buffer_load_dwordx4 v[188:191], v12, s[28:31], s39 offen offset:3072 sc1
    ds_read_b64_tr_b16 v[48:49], v14 offset:14336
    ds_read_b64_tr_b16 v[50:51], v14 offset:14848
    s_waitcnt lgkmcnt(10)
    v_mfma_f32_32x32x16_bf16 v[96:111], v[56:59], v[148:151], v[96:111]
    ds_read_b64_tr_b16 v[52:53], v15 offset:14336
    ds_read_b64_tr_b16 v[54:55], v15 offset:14848
    v_mfma_f32_32x32x16_bf16 v[112:127], v[60:63], v[148:151], v[112:127]
    ds_read_b64_tr_b16 v[56:57], v16 offset:14336
    ds_read_b64_tr_b16 v[58:59], v16 offset:14848
    s_waitcnt vmcnt(9) lgkmcnt(10)
    v_mfma_f32_32x32x16_bf16 v[64:79], v[32:35], v[152:155], v[64:79]
    ds_read_b64_tr_b16 v[60:61], v17 offset:14336
    ds_read_b64_tr_b16 v[62:63], v17 offset:14848
    v_mfma_f32_32x32x16_bf16 v[80:95], v[36:39], v[152:155], v[80:95]
    s_add_u32 s39, s39, 0x1000
    buffer_load_dwordx4 v[128:131], v12, s[28:31], s39 offen offset:0 sc1
    ds_read_b64_tr_b16 v[32:33], v14 offset:16384
    ds_read_b64_tr_b16 v[34:35], v14 offset:16896
    s_waitcnt lgkmcnt(10)
    v_mfma_f32_32x32x16_bf16 v[96:111], v[40:43], v[152:155], v[96:111]
    ds_read_b64_tr_b16 v[36:37], v15 offset:16384
    ds_read_b64_tr_b16 v[38:39], v15 offset:16896
    v_mfma_f32_32x32x16_bf16 v[112:127], v[44:47], v[152:155], v[112:127]
    ds_read_b64_tr_b16 v[40:41], v16 offset:16384
    ds_read_b64_tr_b16 v[42:43], v16 offset:16896
    s_waitcnt vmcnt(9) lgkmcnt(10)
    v_mfma_f32_32x32x16_bf16 v[64:79], v[48:51], v[156:159], v[64:79]
    ds_read_b64_tr_b16 v[44:45], v17 offset:16384
    ds_read_b64_tr_b16 v[46:47], v17 offset:16896
    v_mfma_f32_32x32x16_bf16 v[80:95], v[52:55], v[156:159], v[80:95]
    buffer_load_dwordx4 v[132:135], v12, s[28:31], s39 offen offset:1024 sc1
    ds_read_b64_tr_b16 v[48:49], v14 offset:18432
    ds_read_b64_tr_b16 v[50:51], v14 offset:18944
    s_waitcnt lgkmcnt(10)
    v_mfma_f32_32x32x16_bf16 v[96:111], v[56:59], v[156:159], v[96:111]
    ds_read_b64_tr_b16 v[52:53], v15 offset:18432
    ds_read_b64_tr_b16 v[54:55], v15 offset:18944
    v_mfma_f32_32x32x16_bf16 v[112:127], v[60:63], v[156:159], v[112:127]
    ds_read_b64_tr_b16 v[56:57], v16 offset:18432
    ds_read_b64_tr_b16 v[58:59], v16 offset:18944
    s_waitcnt vmcnt(9) lgkmcnt(10)
    v_mfma_f32_32x32x16_bf16 v[64:79], v[32:35], v[160:163], v[64:79]
    ds_read_b64_tr_b16 v[60:61], v17 offset:18432
    ds_read_b64_tr_b16 v[62:63], v17 offset:18944
    v_mfma_f32_32x32x16_bf16 v[80:95], v[36:39], v[160:163], v[80:95]
    buffer_load_dwordx4 v[136:139], v12, s[28:31], s39 offen offset:2048 sc1
    ds_read_b64_tr_b16 v[32:33], v14 offset:20480
    ds_read_b64_tr_b16 v[34:35], v14 offset:20992
    s_waitcnt lgkmcnt(10)
    v_mfma_f32_32x32x16_bf16 v[96:111], v[40:43], v[160:163], v[96:111]
    ds_read_b64_tr_b16 v[36:37], v15 offset:20480
    ds_read_b64_tr_b16 v[38:39], v15 offset:20992
    v_mfma_f32_32x32x16_bf16 v[112:127], v[44:47], v[160:163], v[112:127]
    ds_read_b64_tr_b16 v[40:41], v16 offset:20480
    ds_read_b64_tr_b16 v[42:43], v16 offset:20992
    s_waitcnt vmcnt(9) lgkmcnt(10)
    v_mfma_f32_32x32x16_bf16 v[64:79], v[48:51], v[164:167], v[64:79]
    ds_read_b64_tr_b16 v[44:45], v17 offset:20480
    ds_read_b64_tr_b16 v[46:47], v17 offset:20992
    v_mfma_f32_32x32x16_bf16 v[80:95], v[52:55], v[164:167], v[80:95]
    buffer_load_dwordx4 v[140:143], v12, s[28:31], s39 offen offset:3072 sc1
    ds_read_b64_tr_b16 v[48:49], v14 offset:22528
    ds_read_b64_tr_b16 v[50:51], v14 offset:23040
    s_waitcnt lgkmcnt(10)
    v_mfma_f32_32x32x16_bf16 v[96:111], v[56:59], v[164:167], v[96:111]
    ds_read_b64_tr_b16 v[52:53], v15 offset:22528
    ds_read_b64_tr_b16 v[54:55], v15 offset:23040
    v_mfma_f32_32x32x16_bf16 v[112:127], v[60:63], v[164:167], v[112:127]
    ds_read_b64_tr_b16 v[56:57], v16 offset:22528
    ds_read_b64_tr_b16 v[58:59], v16 offset:23040
    s_waitcnt vmcnt(9) lgkmcnt(10)
    v_mfma_f32_32x32x16_bf16 v[64:79], v[32:35], v[168:171], v[64:79]
    ds_read_b64_tr_b16 v[60:61], v17 offset:22528
    ds_read_b64_tr_b16 v[62:63], v17 offset:23040
    v_mfma_f32_32x32x16_bf16 v[80:95], v[36:39], v[168:171], v[80:95]
    s_add_u32 s39, s39, 0x1000
    buffer_load_dwordx4 v[144:147], v12, s[28:31], s39 offen offset:0 sc1
    ds_read_b64_tr_b16 v[32:33], v14 offset:24576
    ds_read_b64_tr_b16 v[34:35], v14 offset:25088
    s_waitcnt lgkmcnt(10)
    v_mfma_f32_32x32x16_bf16 v[96:111], v[40:43], v[168:171], v[96:111]
    ds_read_b64_tr_b16 v[36:37], v15 offset:24576
    ds_read_b64_tr_b16 v[38:39], v15 offset:25088
    v_mfma_f32_32x32x16_bf16 v[112:127], v[44:47], v[168:171], v[112:127]
    ds_read_b64_tr_b16 v[40:41], v16 offset:24576
    ds_read_b64_tr_b16 v[42:43], v16 offset:25088
    s_waitcnt vmcnt(9) lgkmcnt(10)
    v_mfma_f32_32x32x16_bf16 v[64:79], v[48:51], v[172:175], v[64:79]
    ds_read_b64_tr_b16 v[44:45], v17 offset:24576
    ds_read_b64_tr_b16 v[46:47], v17 offset:25088
    v_mfma_f32_32x32x16_bf16 v[80:95], v[52:55], v[172:175], v[80:95]
    buffer_load_dwordx4 v[148:151], v12, s[28:31], s39 offen offset:1024 sc1
    ds_read_b64_tr_b16 v[48:49], v14 offset:26624
    ds_read_b64_tr_b16 v[50:51], v14 offset:27136
    s_waitcnt lgkmcnt(10)
    v_mfma_f32_32x32x16_bf16 v[96:111], v[56:59], v[172:175], v[96:111]
    ds_read_b64_tr_b16 v[52:53], v15 offset:26624
    ds_read_b64_tr_b16 v[54:55], v15 offset:27136
    v_mfma_f32_32x32x16_bf16 v[112:127], v[60:63], v[172:175], v[112:127]
    ds_read_b64_tr_b16 v[56:57], v16 offset:26624
    ds_read_b64_tr_b16 v[58:59], v16 offset:27136
    s_waitcnt vmcnt(9) lgkmcnt(10)
    v_mfma_f32_32x32x16_bf16 v[64:79], v[32:35], v[176:179], v[64:79]
    ds_read_b64_tr_b16 v[60:61], v17 offset:26624
    ds_read_b64_tr_b16 v[62:63], v17 offset:27136
    v_mfma_f32_32x32x16_bf16 v[80:95], v[36:39], v[176:179], v[80:95]
    buffer_load_dwordx4 v[152:155], v12, s[28:31], s39 offen offset:2048 sc1
    ds_read_b64_tr_b16 v[32:33], v14 offset:28672
    ds_read_b64_tr_b16 v[34:35], v14 offset:29184
    s_waitcnt lgkmcnt(10)
    v_mfma_f32_32x32x16_bf16 v[96:111], v[40:43], v[176:179], v[96:111]
    ds_read_b64_tr_b16 v[36:37], v15 offset:28672
    ds_read_b64_tr_b16 v[38:39], v15 offset:29184
    v_mfma_f32_32x32x16_bf16 v[112:127], v[44:47], v[176:179], v[112:127]
    ds_read_b64_tr_b16 v[40:41], v16 offset:28672
    ds_read_b64_tr_b16 v[42:43], v16 offset:29184
    s_waitcnt vmcnt(9) lgkmcnt(10)
    v_mfma_f32_32x32x16_bf16 v[64:79], v[48:51], v[180:183], v[64:79]
    ds_read_b64_tr_b16 v[44:45], v17 offset:28672
    ds_read_b64_tr_b16 v[46:47], v17 offset:29184
    v_mfma_f32_32x32x16_bf16 v[80:95], v[52:55], v[180:183], v[80:95]
    buffer_load_dwordx4 v[156:159], v12, s[28:31], s39 offen offset:3072 sc1
    ds_read_b64_tr_b16 v[48:49], v14 offset:30720
    ds_read_b64_tr_b16 v[50:51], v14 offset:31232
    s_waitcnt lgkmcnt(10)
    v_mfma_f32_32x32x16_bf16 v[96:111], v[56:59], v[180:183], v[96:111]
    ds_read_b64_tr_b16 v[52:53], v15 offset:30720
    ds_read_b64_tr_b16 v[54:55], v15 offset:31232
    v_mfma_f32_32x32x16_bf16 v[112:127], v[60:63], v[180:183], v[112:127]
    ds_read_b64_tr_b16 v[56:57], v16 offset:30720
    ds_read_b64_tr_b16 v[58:59], v16 offset:31232
    s_waitcnt vmcnt(9) lgkmcnt(10)
    v_mfma_f32_32x32x16_bf16 v[64:79], v[32:35], v[184:187], v[64:79]
    ds_read_b64_tr_b16 v[60:61], v17 offset:30720
    ds_read_b64_tr_b16 v[62:63], v17 offset:31232
    v_mfma_f32_32x32x16_bf16 v[80:95], v[36:39], v[184:187], v[80:95]
    s_add_u32 s39, s39, 0x1000
    buffer_load_dwordx4 v[160:163], v12, s[28:31], s39 offen offset:0 sc1
    ds_read_b64_tr_b16 v[32:33], v14 offset:32768
    ds_read_b64_tr_b16 v[34:35], v14 offset:33280
    s_waitcnt lgkmcnt(10)
    v_mfma_f32_32x32x16_bf16 v[96:111], v[40:43], v[184:187], v[96:111]
    ds_read_b64_tr_b16 v[36:37], v15 offset:32768
    ds_read_b64_tr_b16 v[38:39], v15 offset:33280
    v_mfma_f32_32x32x16_bf16 v[112:127], v[44:47], v[184:187], v[112:127]
    ds_read_b64_tr_b16 v[40:41], v16 offset:32768
    ds_read_b64_tr_b16 v[42:43], v16 offset:33280
    s_waitcnt vmcnt(9) lgkmcnt(10)
    v_mfma_f32_32x32x16_bf16 v[64:79], v[48:51], v[188:191], v[64:79]
    ds_read_b64_tr_b16 v[44:45], v17 offset:32768
    ds_read_b64_tr_b16 v[46:47], v17 offset:33280
    v_mfma_f32_32x32x16_bf16 v[80:95], v[52:55], v[188:191], v[80:95]
    buffer_load_dwordx4 v[164:167], v12, s[28:31], s39 offen offset:1024 sc1
    ds_read_b64_tr_b16 v[48:49], v14 offset:34816
    ds_read_b64_tr_b16 v[50:51], v14 offset:35328
    s_waitcnt lgkmcnt(10)
    v_mfma_f32_32x32x16_bf16 v[96:111], v[56:59], v[188:191], v[96:111]
    ds_read_b64_tr_b16 v[52:53], v15 offset:34816
    ds_read_b64_tr_b16 v[54:55], v15 offset:35328
    v_mfma_f32_32x32x16_bf16 v[112:127], v[60:63], v[188:191], v[112:127]
    ds_read_b64_tr_b16 v[56:57], v16 offset:34816
    ds_read_b64_tr_b16 v[58:59], v16 offset:35328
    s_waitcnt vmcnt(9) lgkmcnt(10)
    v_mfma_f32_32x32x16_bf16 v[64:79], v[32:35], v[128:131], v[64:79]
    ds_read_b64_tr_b16 v[60:61], v17 offset:34816
    ds_read_b64_tr_b16 v[62:63], v17 offset:35328
    v_mfma_f32_32x32x16_bf16 v[80:95], v[36:39], v[128:131], v[80:95]
    buffer_load_dwordx4 v[168:171], v12, s[28:31], s39 offen offset:2048 sc1
    ds_read_b64_tr_b16 v[32:33], v14 offset:36864
    ds_read_b64_tr_b16 v[34:35], v14 offset:37376
    s_waitcnt lgkmcnt(10)
    v_mfma_f32_32x32x16_bf16 v[96:111], v[40:43], v[128:131], v[96:111]
    ds_read_b64_tr_b16 v[36:37], v15 offset:36864
    ds_read_b64_tr_b16 v[38:39], v15 offset:37376
    v_mfma_f32_32x32x16_bf16 v[112:127], v[44:47], v[128:131], v[112:127]
    ds_read_b64_tr_b16 v[40:41], v16 offset:36864
    ds_read_b64_tr_b16 v[42:43], v16 offset:37376
    s_waitcnt vmcnt(9) lgkmcnt(10)
    v_mfma_f32_32x32x16_bf16 v[64:79], v[48:51], v[132:135], v[64:79]
    ds_read_b64_tr_b16 v[44:45], v17 offset:36864
    ds_read_b64_tr_b16 v[46:47], v17 offset:37376
    v_mfma_f32_32x32x16_bf16 v[80:95], v[52:55], v[132:135], v[80:95]
    buffer_load_dwordx4 v[172:175], v12, s[28:31], s39 offen offset:3072 sc1
    ds_read_b64_tr_b16 v[48:49], v14 offset:38912
    ds_read_b64_tr_b16 v[50:51], v14 offset:39424
    s_waitcnt lgkmcnt(10)
    v_mfma_f32_32x32x16_bf16 v[96:111], v[56:59], v[132:135], v[96:111]
    ds_read_b64_tr_b16 v[52:53], v15 offset:38912
    ds_read_b64_tr_b16 v[54:55], v15 offset:39424
    v_mfma_f32_32x32x16_bf16 v[112:127], v[60:63], v[132:135], v[112:127]
    ds_read_b64_tr_b16 v[56:57], v16 offset:38912
    ds_read_b64_tr_b16 v[58:59], v16 offset:39424
    s_waitcnt vmcnt(9) lgkmcnt(10)
    v_mfma_f32_32x32x16_bf16 v[64:79], v[32:35], v[136:139], v[64:79]
    ds_read_b64_tr_b16 v[60:61], v17 offset:38912
    ds_read_b64_tr_b16 v[62:63], v17 offset:39424
    v_mfma_f32_32x32x16_bf16 v[80:95], v[36:39], v[136:139], v[80:95]
    s_add_u32 s39, s39, 0x1000
    buffer_load_dwordx4 v[176:179], v12, s[28:31], s39 offen offset:0 sc1
    ds_read_b64_tr_b16 v[32:33], v14 offset:40960
    ds_read_b64_tr_b16 v[34:35], v14 offset:41472
    s_waitcnt lgkmcnt(10)
    v_mfma_f32_32x32x16_bf16 v[96:111], v[40:43], v[136:139], v[96:111]
    ds_read_b64_tr_b16 v[36:37], v15 offset:40960
    ds_read_b64_tr_b16 v[38:39], v15 offset:41472
    v_mfma_f32_32x32x16_bf16 v[112:127], v[44:47], v[136:139], v[112:127]
    ds_read_b64_tr_b16 v[40:41], v16 offset:40960
    ds_read_b64_tr_b16 v[42:43], v16 offset:41472
    s_waitcnt vmcnt(9) lgkmcnt(10)
    v_mfma_f32_32x32x16_bf16 v[64:79], v[48:51], v[140:143], v[64:79]
    ds_read_b64_tr_b16 v[44:45], v17 offset:40960
    ds_read_b64_tr_b16 v[46:47], v17 offset:41472
    v_mfma_f32_32x32x16_bf16 v[80:95], v[52:55], v[140:143], v[80:95]
    buffer_load_dwordx4 v[180:183], v12, s[28:31], s39 offen offset:1024 sc1
    ds_read_b64_tr_b16 v[48:49], v14 offset:43008
    ds_read_b64_tr_b16 v[50:51], v14 offset:43520
    s_waitcnt lgkmcnt(10)
    v_mfma_f32_32x32x16_bf16 v[96:111], v[56:59], v[140:143], v[96:111]
    ds_read_b64_tr_b16 v[52:53], v15 offset:43008
    ds_read_b64_tr_b16 v[54:55], v15 offset:43520
    v_mfma_f32_32x32x16_bf16 v[112:127], v[60:63], v[140:143], v[112:127]
    ds_read_b64_tr_b16 v[56:57], v16 offset:43008
    ds_read_b64_tr_b16 v[58:59], v16 offset:43520
    s_waitcnt vmcnt(9) lgkmcnt(10)
    v_mfma_f32_32x32x16_bf16 v[64:79], v[32:35], v[144:147], v[64:79]
    ds_read_b64_tr_b16 v[60:61], v17 offset:43008
    ds_read_b64_tr_b16 v[62:63], v17 offset:43520
    v_mfma_f32_32x32x16_bf16 v[80:95], v[36:39], v[144:147], v[80:95]
    buffer_load_dwordx4 v[184:187], v12, s[28:31], s39 offen offset:2048 sc1
    ds_read_b64_tr_b16 v[32:33], v14 offset:45056
    ds_read_b64_tr_b16 v[34:35], v14 offset:45568
    s_waitcnt lgkmcnt(10)
    v_mfma_f32_32x32x16_bf16 v[96:111], v[40:43], v[144:147], v[96:111]
    ds_read_b64_tr_b16 v[36:37], v15 offset:45056
    ds_read_b64_tr_b16 v[38:39], v15 offset:45568
    v_mfma_f32_32x32x16_bf16 v[112:127], v[44:47], v[144:147], v[112:127]
    ds_read_b64_tr_b16 v[40:41], v16 offset:45056
    ds_read_b64_tr_b16 v[42:43], v16 offset:45568
    s_waitcnt vmcnt(9) lgkmcnt(10)
    v_mfma_f32_32x32x16_bf16 v[64:79], v[48:51], v[148:151], v[64:79]
    ds_read_b64_tr_b16 v[44:45], v17 offset:45056
    ds_read_b64_tr_b16 v[46:47], v17 offset:45568
    v_mfma_f32_32x32x16_bf16 v[80:95], v[52:55], v[148:151], v[80:95]
    buffer_load_dwordx4 v[188:191], v12, s[28:31], s39 offen offset:3072 sc1
    ds_read_b64_tr_b16 v[48:49], v14 offset:47104
    ds_read_b64_tr_b16 v[50:51], v14 offset:47616
    s_waitcnt lgkmcnt(10)
    v_mfma_f32_32x32x16_bf16 v[96:111], v[56:59], v[148:151], v[96:111]
    ds_read_b64_tr_b16 v[52:53], v15 offset:47104
    ds_read_b64_tr_b16 v[54:55], v15 offset:47616
    v_mfma_f32_32x32x16_bf16 v[112:127], v[60:63], v[148:151], v[112:127]
    ds_read_b64_tr_b16 v[56:57], v16 offset:47104
    ds_read_b64_tr_b16 v[58:59], v16 offset:47616
    s_waitcnt vmcnt(9) lgkmcnt(10)
    v_mfma_f32_32x32x16_bf16 v[64:79], v[32:35], v[152:155], v[64:79]
    ds_read_b64_tr_b16 v[60:61], v17 offset:47104
    ds_read_b64_tr_b16 v[62:63], v17 offset:47616
    v_mfma_f32_32x32x16_bf16 v[80:95], v[36:39], v[152:155], v[80:95]
    s_add_u32 m0, s21, 0
    s_add_u32 s45, s22, 0
    buffer_load_dwordx4 v9, s[56:59], s45 offen lds
    ds_read_b64_tr_b16 v[32:33], v14 offset:49152
    ds_read_b64_tr_b16 v[34:35], v14 offset:49664
    s_waitcnt lgkmcnt(10)
    v_mfma_f32_32x32x16_bf16 v[96:111], v[40:43], v[152:155], v[96:111]
    ds_read_b64_tr_b16 v[36:37], v15 offset:49152
    ds_read_b64_tr_b16 v[38:39], v15 offset:49664
    v_mfma_f32_32x32x16_bf16 v[112:127], v[44:47], v[152:155], v[112:127]
    ds_read_b64_tr_b16 v[40:41], v16 offset:49152
    ds_read_b64_tr_b16 v[42:43], v16 offset:49664
    s_waitcnt vmcnt(9) lgkmcnt(10)
    v_mfma_f32_32x32x16_bf16 v[64:79], v[48:51], v[156:159], v[64:79]
    ds_read_b64_tr_b16 v[44:45], v17 offset:49152
    ds_read_b64_tr_b16 v[46:47], v17 offset:49664
    v_mfma_f32_32x32x16_bf16 v[80:95], v[52:55], v[156:159], v[80:95]
    s_add_u32 m0, s21, 1024
    s_add_u32 s45, s22, 8192
    buffer_load_dwordx4 v9, s[56:59], s45 offen lds
    ds_read_b64_tr_b16 v[48:49], v14 offset:51200
    ds_read_b64_tr_b16 v[50:51], v14 offset:51712
    s_waitcnt lgkmcnt(10)
    v_mfma_f32_32x32x16_bf16 v[96:111], v[56:59], v[156:159], v[96:111]
    ds_read_b64_tr_b16 v[52:53], v15 offset:51200
    ds_read_b64_tr_b16 v[54:55], v15 offset:51712
    v_mfma_f32_32x32x16_bf16 v[112:127], v[60:63], v[156:159], v[112:127]
    ds_read_b64_tr_b16 v[56:57], v16 offset:51200
    ds_read_b64_tr_b16 v[58:59], v16 offset:51712
    s_waitcnt vmcnt(9) lgkmcnt(10)
    v_mfma_f32_32x32x16_bf16 v[64:79], v[32:35], v[160:163], v[64:79]
    ds_read_b64_tr_b16 v[60:61], v17 offset:51200
    ds_read_b64_tr_b16 v[62:63], v17 offset:51712
    v_mfma_f32_32x32x16_bf16 v[80:95], v[36:39], v[160:163], v[80:95]
    s_add_u32 m0, s21, 2048
    s_add_u32 s45, s22, 16384
    buffer_load_dwordx4 v9, s[56:59], s45 offen lds
    ds_read_b64_tr_b16 v[32:33], v14 offset:53248
    ds_read_b64_tr_b16 v[34:35], v14 offset:53760
    s_waitcnt lgkmcnt(10)
    v_mfma_f32_32x32x16_bf16 v[96:111], v[40:43], v[160:163], v[96:111]
    ds_read_b64_tr_b16 v[36:37], v15 offset:53248
    ds_read_b64_tr_b16 v[38:39], v15 offset:53760
    v_mfma_f32_32x32x16_bf16 v[112:127], v[44:47], v[160:163], v[112:127]
    ds_read_b64_tr_b16 v[40:41], v16 offset:53248
    ds_read_b64_tr_b16 v[42:43], v16 offset:53760
    s_waitcnt vmcnt(9) lgkmcnt(10)
    v_mfma_f32_32x32x16_bf16 v[64:79], v[48:51], v[164:167], v[64:79]
    ds_read_b64_tr_b16 v[44:45], v17 offset:53248
    ds_read_b64_tr_b16 v[46:47], v17 offset:53760
    v_mfma_f32_32x32x16_bf16 v[80:95], v[52:55], v[164:167], v[80:95]
    s_add_u32 m0, s21, 3072
    s_add_u32 s45, s22, 24576
    buffer_load_dwordx4 v9, s[56:59], s45 offen lds
    ds_read_b64_tr_b16 v[48:49], v14 offset:55296
    ds_read_b64_tr_b16 v[50:51], v14 offset:55808
    s_waitcnt lgkmcnt(10)
    v_mfma_f32_32x32x16_bf16 v[96:111], v[56:59], v[164:167], v[96:111]
    ds_read_b64_tr_b16 v[52:53], v15 offset:55296
    ds_read_b64_tr_b16 v[54:55], v15 offset:55808
    v_mfma_f32_32x32x16_bf16 v[112:127], v[60:63], v[164:167], v[112:127]
    ds_read_b64_tr_b16 v[56:57], v16 offset:55296
    ds_read_b64_tr_b16 v[58:59], v16 offset:55808
    s_waitcnt vmcnt(9) lgkmcnt(10)
    v_mfma_f32_32x32x16_bf16 v[64:79], v[32:35], v[168:171], v[64:79]
    ds_read_b64_tr_b16 v[60:61], v17 offset:55296
    ds_read_b64_tr_b16 v[62:63], v17 offset:55808
    v_mfma_f32_32x32x16_bf16 v[80:95], v[36:39], v[168:171], v[80:95]
    s_add_u32 m0, s21, 4096
    s_add_u32 s45, s22, 32768
    buffer_load_dwordx4 v9, s[56:59], s45 offen lds
    ds_read_b64_tr_b16 v[32:33], v14 offset:57344
    ds_read_b64_tr_b16 v[34:35], v14 offset:57856
    s_waitcnt lgkmcnt(10)
    v_mfma_f32_32x32x16_bf16 v[96:111], v[40:43], v[168:171], v[96:111]
    ds_read_b64_tr_b16 v[36:37], v15 offset:57344
    ds_read_b64_tr_b16 v[38:39], v15 offset:57856
    v_mfma_f32_32x32x16_bf16 v[112:127], v[44:47], v[168:171], v[112:127]
    ds_read_b64_tr_b16 v[40:41], v16 offset:57344
    ds_read_b64_tr_b16 v[42:43], v16 offset:57856
    s_waitcnt vmcnt(9) lgkmcnt(10)
    v_mfma_f32_32x32x16_bf16 v[64:79], v[48:51], v[172:175], v[64:79]
    ds_read_b64_tr_b16 v[44:45], v17 offset:57344
    ds_read_b64_tr_b16 v[46:47], v17 offset:57856
    v_mfma_f32_32x32x16_bf16 v[80:95], v[52:55], v[172:175], v[80:95]
    s_add_u32 m0, s21, 5120
    s_add_u32 s45, s22, 40960
    buffer_load_dwordx4 v9, s[56:59], s45 offen lds
    ds_read_b64_tr_b16 v[48:49], v14 offset:59392
    ds_read_b64_tr_b16 v[50:51], v14 offset:59904
    s_waitcnt lgkmcnt(10)
    v_mfma_f32_32x32x16_bf16 v[96:111], v[56:59], v[172:175], v[96:111]
    ds_read_b64_tr_b16 v[52:53], v15 offset:59392
    ds_read_b64_tr_b16 v[54:55], v15 offset:59904
    v_mfma_f32_32x32x16_bf16 v[112:127], v[60:63], v[172:175], v[112:127]
    ds_read_b64_tr_b16 v[56:57], v16 offset:59392
    ds_read_b64_tr_b16 v[58:59], v16 offset:59904
    s_waitcnt vmcnt(9) lgkmcnt(10)
    v_mfma_f32_32x32x16_bf16 v[64:79], v[32:35], v[176:179], v[64:79]
    ds_read_b64_tr_b16 v[60:61], v17 offset:59392
    ds_read_b64_tr_b16 v[62:63], v17 offset:59904
    v_mfma_f32_32x32x16_bf16 v[80:95], v[36:39], v[176:179], v[80:95]
    s_add_u32 m0, s21, 6144
    s_add_u32 s45, s22, 49152
    buffer_load_dwordx4 v9, s[56:59], s45 offen lds
    ds_read_b64_tr_b16 v[32:33], v14 offset:61440
    ds_read_b64_tr_b16 v[34:35], v14 offset:61952
    s_waitcnt lgkmcnt(10)
    v_mfma_f32_32x32x16_bf16 v[96:111], v[40:43], v[176:179], v[96:111]
    ds_read_b64_tr_b16 v[36:37], v15 offset:61440
    ds_read_b64_tr_b16 v[38:39], v15 offset:61952
    v_mfma_f32_32x32x16_bf16 v[112:127], v[44:47], v[176:179], v[112:127]
    ds_read_b64_tr_b16 v[40:41], v16 offset:61440
    ds_read_b64_tr_b16 v[42:43], v16 offset:61952
    s_waitcnt vmcnt(9) lgkmcnt(10)
    v_mfma_f32_32x32x16_bf16 v[64:79], v[48:51], v[180:183], v[64:79]
    ds_read_b64_tr_b16 v[44:45], v17 offset:61440
    ds_read_b64_tr_b16 v[46:47], v17 offset:61952
    v_mfma_f32_32x32x16_bf16 v[80:95], v[52:55], v[180:183], v[80:95]
    ds_read_b64_tr_b16 v[48:49], v14 offset:63488
    ds_read_b64_tr_b16 v[50:51], v14 offset:64000
    s_waitcnt lgkmcnt(10)
    v_mfma_f32_32x32x16_bf16 v[96:111], v[56:59], v[180:183], v[96:111]
    ds_read_b64_tr_b16 v[52:53], v15 offset:63488
    ds_read_b64_tr_b16 v[54:55], v15 offset:64000
    v_mfma_f32_32x32x16_bf16 v[112:127], v[60:63], v[180:183], v[112:127]
    ds_read_b64_tr_b16 v[56:57], v16 offset:63488
    ds_read_b64_tr_b16 v[58:59], v16 offset:64000
    s_waitcnt vmcnt(8) lgkmcnt(10)
    v_mfma_f32_32x32x16_bf16 v[64:79], v[32:35], v[184:187], v[64:79]
    ds_read_b64_tr_b16 v[60:61], v17 offset:63488
    ds_read_b64_tr_b16 v[62:63], v17 offset:64000
    v_mfma_f32_32x32x16_bf16 v[80:95], v[36:39], v[184:187], v[80:95]
    s_waitcnt lgkmcnt(8)
    v_mfma_f32_32x32x16_bf16 v[96:111], v[40:43], v[184:187], v[96:111]
    v_mfma_f32_32x32x16_bf16 v[112:127], v[44:47], v[184:187], v[112:127]
    s_waitcnt vmcnt(7) lgkmcnt(4)
    v_mfma_f32_32x32x16_bf16 v[64:79], v[48:51], v[188:191], v[64:79]
    v_mfma_f32_32x32x16_bf16 v[80:95], v[52:55], v[188:191], v[80:95]
    s_waitcnt lgkmcnt(0)
    v_mfma_f32_32x32x16_bf16 v[96:111], v[56:59], v[188:191], v[96:111]
    v_mfma_f32_32x32x16_bf16 v[112:127], v[60:63], v[188:191], v[112:127]
    ds_write_b32 v4, v5
    s_setprio 0
    s_nop 6
    v_fma_f32 v24, v64, v64, v22
    v_fma_f32 v25, v65, v65, v22
    v_fma_f32 v26, v66, v66, v22
    v_fma_f32 v27, v67, v67, v22
    v_fma_f32 v28, v68, v68, v22
    v_fma_f32 v29, v69, v69, v22
    v_fma_f32 v30, v70, v70, v22
    v_fma_f32 v31, v71, v71, v22
    v_mul_f32 v24, v24, v64
    v_mul_f32 v25, v25, v65
    v_mul_f32 v26, v26, v66
    v_mul_f32 v27, v27, v67
    v_mul_f32 v28, v28, v68
    v_mul_f32 v29, v29, v69
    v_mul_f32 v30, v30, v70
    v_mul_f32 v31, v31, v71
    v_exp_f32 v24, -v24
    v_exp_f32 v25, -v25
    v_exp_f32 v26, -v26
    v_exp_f32 v27, -v27
    v_exp_f32 v28, -v28
    v_exp_f32 v29, -v29
    v_exp_f32 v30, -v30
    v_exp_f32 v31, -v31
    v_mul_f32 v64, v64, v72
    v_mul_f32 v65, v65, v73
    v_mul_f32 v66, v66, v74
    v_mul_f32 v67, v67, v75
    v_mul_f32 v68, v68, v76
    v_mul_f32 v69, v69, v77
    v_mul_f32 v70, v70, v78
    v_mul_f32 v71, v71, v79
    v_fma_f32 v24, v24, s40, s40
    v_fma_f32 v25, v25, s40, s40
    v_fma_f32 v26, v26, s40, s40
    v_fma_f32 v27, v27, s40, s40
    v_fma_f32 v28, v28, s40, s40
    v_fma_f32 v29, v29, s40, s40
    v_fma_f32 v30, v30, s40, s40
    v_fma_f32 v31, v31, s40, s40
    v_rcp_f32 v24, v24
    v_rcp_f32 v25, v25
    v_rcp_f32 v26, v26
    v_rcp_f32 v27, v27
    v_rcp_f32 v28, v28
    v_rcp_f32 v29, v29
    v_rcp_f32 v30, v30
    v_rcp_f32 v31, v31
    v_mul_f32 v64, v64, v24
    v_mul_f32 v65, v65, v25
    v_mul_f32 v66, v66, v26
    v_mul_f32 v67, v67, v27
    v_mul_f32 v68, v68, v28
    v_mul_f32 v69, v69, v29
    v_mul_f32 v70, v70, v30
    v_mul_f32 v71, v71, v31
    v_cvt_pk_bf16_f32 v32, v64, v65
    v_cvt_pk_bf16_f32 v33, v66, v67
    v_cvt_pk_bf16_f32 v34, v68, v69
    v_cvt_pk_bf16_f32 v35, v70, v71
    buffer_store_dwordx4 v[32:35], v12, s[28:31], s42 offen offset:0 sc1
    v_fma_f32 v24, v80, v80, v22
    v_fma_f32 v25, v81, v81, v22
    v_fma_f32 v26, v82, v82, v22
    v_fma_f32 v27, v83, v83, v22
    v_fma_f32 v28, v84, v84, v22
    v_fma_f32 v29, v85, v85, v22
    v_fma_f32 v30, v86, v86, v22
    v_fma_f32 v31, v87, v87, v22
    v_mul_f32 v24, v24, v80
    v_mul_f32 v25, v25, v81
    v_mul_f32 v26, v26, v82
    v_mul_f32 v27, v27, v83
    v_mul_f32 v28, v28, v84
    v_mul_f32 v29, v29, v85
    v_mul_f32 v30, v30, v86
    v_mul_f32 v31, v31, v87
    v_exp_f32 v24, -v24
    v_exp_f32 v25, -v25
    v_exp_f32 v26, -v26
    v_exp_f32 v27, -v27
    v_exp_f32 v28, -v28
    v_exp_f32 v29, -v29
    v_exp_f32 v30, -v30
    v_exp_f32 v31, -v31
    v_mul_f32 v80, v80, v88
    v_mul_f32 v81, v81, v89
    v_mul_f32 v82, v82, v90
    v_mul_f32 v83, v83, v91
    v_mul_f32 v84, v84, v92
    v_mul_f32 v85, v85, v93
    v_mul_f32 v86, v86, v94
    v_mul_f32 v87, v87, v95
    v_fma_f32 v24, v24, s40, s40
    v_fma_f32 v25, v25, s40, s40
    v_fma_f32 v26, v26, s40, s40
    v_fma_f32 v27, v27, s40, s40
    v_fma_f32 v28, v28, s40, s40
    v_fma_f32 v29, v29, s40, s40
    v_fma_f32 v30, v30, s40, s40
    v_fma_f32 v31, v31, s40, s40
    v_rcp_f32 v24, v24
    v_rcp_f32 v25, v25
    v_rcp_f32 v26, v26
    v_rcp_f32 v27, v27
    v_rcp_f32 v28, v28
    v_rcp_f32 v29, v29
    v_rcp_f32 v30, v30
    v_rcp_f32 v31, v31
    v_mul_f32 v80, v80, v24
    v_mul_f32 v81, v81, v25
    v_mul_f32 v82, v82, v26
    v_mul_f32 v83, v83, v27
    v_mul_f32 v84, v84, v28
    v_mul_f32 v85, v85, v29
    v_mul_f32 v86, v86, v30
    v_mul_f32 v87, v87, v31
    v_cvt_pk_bf16_f32 v36, v80, v81
    v_cvt_pk_bf16_f32 v37, v82, v83
    v_cvt_pk_bf16_f32 v38, v84, v85
    v_cvt_pk_bf16_f32 v39, v86, v87
    buffer_store_dwordx4 v[36:39], v12, s[28:31], s42 offen offset:1024 sc1
    v_fma_f32 v24, v96, v96, v22
    v_fma_f32 v25, v97, v97, v22
    v_fma_f32 v26, v98, v98, v22
    v_fma_f32 v27, v99, v99, v22
    v_fma_f32 v28, v100, v100, v22
    v_fma_f32 v29, v101, v101, v22
    v_fma_f32 v30, v102, v102, v22
    v_fma_f32 v31, v103, v103, v22
    v_mul_f32 v24, v24, v96
    v_mul_f32 v25, v25, v97
    v_mul_f32 v26, v26, v98
    v_mul_f32 v27, v27, v99
    v_mul_f32 v28, v28, v100
    v_mul_f32 v29, v29, v101
    v_mul_f32 v30, v30, v102
    v_mul_f32 v31, v31, v103
    v_exp_f32 v24, -v24
    v_exp_f32 v25, -v25
    v_exp_f32 v26, -v26
    v_exp_f32 v27, -v27
    v_exp_f32 v28, -v28
    v_exp_f32 v29, -v29
    v_exp_f32 v30, -v30
    v_exp_f32 v31, -v31
    v_mul_f32 v96, v96, v104
    v_mul_f32 v97, v97, v105
    v_mul_f32 v98, v98, v106
    v_mul_f32 v99, v99, v107
    v_mul_f32 v100, v100, v108
    v_mul_f32 v101, v101, v109
    v_mul_f32 v102, v102, v110
    v_mul_f32 v103, v103, v111
    v_fma_f32 v24, v24, s40, s40
    v_fma_f32 v25, v25, s40, s40
    v_fma_f32 v26, v26, s40, s40
    v_fma_f32 v27, v27, s40, s40
    v_fma_f32 v28, v28, s40, s40
    v_fma_f32 v29, v29, s40, s40
    v_fma_f32 v30, v30, s40, s40
    v_fma_f32 v31, v31, s40, s40
    v_rcp_f32 v24, v24
    v_rcp_f32 v25, v25
    v_rcp_f32 v26, v26
    v_rcp_f32 v27, v27
    v_rcp_f32 v28, v28
    v_rcp_f32 v29, v29
    v_rcp_f32 v30, v30
    v_rcp_f32 v31, v31
    v_mul_f32 v96, v96, v24
    v_mul_f32 v97, v97, v25
    v_mul_f32 v98, v98, v26
    v_mul_f32 v99, v99, v27
    v_mul_f32 v100, v100, v28
    v_mul_f32 v101, v101, v29
    v_mul_f32 v102, v102, v30
    v_mul_f32 v103, v103, v31
    v_cvt_pk_bf16_f32 v40, v96, v97
    v_cvt_pk_bf16_f32 v41, v98, v99
    v_cvt_pk_bf16_f32 v42, v100, v101
    v_cvt_pk_bf16_f32 v43, v102, v103
    buffer_store_dwordx4 v[40:43], v12, s[28:31], s42 offen offset:2048 sc1
    v_fma_f32 v24, v112, v112, v22
    v_fma_f32 v25, v113, v113, v22
    v_fma_f32 v26, v114, v114, v22
    v_fma_f32 v27, v115, v115, v22
    v_fma_f32 v28, v116, v116, v22
    v_fma_f32 v29, v117, v117, v22
    v_fma_f32 v30, v118, v118, v22
    v_fma_f32 v31, v119, v119, v22
    v_mul_f32 v24, v24, v112
    v_mul_f32 v25, v25, v113
    v_mul_f32 v26, v26, v114
    v_mul_f32 v27, v27, v115
    v_mul_f32 v28, v28, v116
    v_mul_f32 v29, v29, v117
    v_mul_f32 v30, v30, v118
    v_mul_f32 v31, v31, v119
    v_exp_f32 v24, -v24
    v_exp_f32 v25, -v25
    v_exp_f32 v26, -v26
    v_exp_f32 v27, -v27
    v_exp_f32 v28, -v28
    v_exp_f32 v29, -v29
    v_exp_f32 v30, -v30
    v_exp_f32 v31, -v31
    v_mul_f32 v112, v112, v120
    v_mul_f32 v113, v113, v121
    v_mul_f32 v114, v114, v122
    v_mul_f32 v115, v115, v123
    v_mul_f32 v116, v116, v124
    v_mul_f32 v117, v117, v125
    v_mul_f32 v118, v118, v126
    v_mul_f32 v119, v119, v127
    v_fma_f32 v24, v24, s40, s40
    v_fma_f32 v25, v25, s40, s40
    v_fma_f32 v26, v26, s40, s40
    v_fma_f32 v27, v27, s40, s40
    v_fma_f32 v28, v28, s40, s40
    v_fma_f32 v29, v29, s40, s40
    v_fma_f32 v30, v30, s40, s40
    v_fma_f32 v31, v31, s40, s40
    v_rcp_f32 v24, v24
    v_rcp_f32 v25, v25
    v_rcp_f32 v26, v26
    v_rcp_f32 v27, v27
    v_rcp_f32 v28, v28
    v_rcp_f32 v29, v29
    v_rcp_f32 v30, v30
    v_rcp_f32 v31, v31
    v_mul_f32 v112, v112, v24
    v_mul_f32 v113, v113, v25
    v_mul_f32 v114, v114, v26
    v_mul_f32 v115, v115, v27
    v_mul_f32 v116, v116, v28
    v_mul_f32 v117, v117, v29
    v_mul_f32 v118, v118, v30
    v_mul_f32 v119, v119, v31
    v_cvt_pk_bf16_f32 v44, v112, v113
    v_cvt_pk_bf16_f32 v45, v114, v115
    v_cvt_pk_bf16_f32 v46, v116, v117
    v_cvt_pk_bf16_f32 v47, v118, v119
    buffer_store_dwordx4 v[44:47], v12, s[28:31], s42 offen offset:3072 sc1
    s_setprio 0
    s_branch M_CD
M_CD0:
    s_mul_i32 s35, s32, 458752
    s_sub_u32 s45, s34, 28
    s_lshl_b32 s45, s45, 14
    s_add_u32 s35, s35, s45
    v_lshlrev_b32 v10, 7, v0
    s_add_u32 m0, s21, 0
    s_add_u32 s45, s22, 0
    buffer_load_dwordx4 v9, s[56:59], s45 offen lds
    s_add_u32 m0, s21, 1024
    s_add_u32 s45, s22, 8192
    buffer_load_dwordx4 v9, s[56:59], s45 offen lds
    s_add_u32 m0, s21, 2048
    s_add_u32 s45, s22, 16384
    buffer_load_dwordx4 v9, s[56:59], s45 offen lds
    s_add_u32 m0, s21, 3072
    s_add_u32 s45, s22, 24576
    buffer_load_dwordx4 v9, s[56:59], s45 offen lds
    s_add_u32 m0, s21, 4096
    s_add_u32 s45, s22, 32768
    buffer_load_dwordx4 v9, s[56:59], s45 offen lds
    s_add_u32 m0, s21, 5120
    s_add_u32 s45, s22, 40960
    buffer_load_dwordx4 v9, s[56:59], s45 offen lds
    s_add_u32 m0, s21, 6144
    s_add_u32 s45, s22, 49152
    buffer_load_dwordx4 v9, s[56:59], s45 offen lds
    s_waitcnt vmcnt(0)
M_CD:
    s_and_b32 s37, s32, 3
    s_lshr_b32 s38, s34, 2
    v_lshlrev_b32 v12, 4, v0
    v_lshrrev_b32 v2, 5, v0
    v_bfe_u32 v3, v0, 2, 2
    v_lshl_add_u32 v1, v2, 3, v3
    v_lshlrev_b32 v1, 7, v1
    v_bfe_u32 v13, v0, 4, 1
    v_and_b32 v3, 2, v3
    v_xor_b32 v13, v13, v3
    v_lshl_add_u32 v1, v13, 5, v1
    v_and_b32 v3, 1, v0
    v_lshl_add_u32 v1, v3, 4, v1
    v_bfe_u32 v3, v0, 1, 1
    v_lshl_add_u32 v1, v3, 3, v1
    s_lshr_b32 s20, s37, 1
    s_lshl_b32 s20, s20, 16
    s_and_b32 s21, s37, 1
    s_lshl_b32 s21, s21, 13
    s_add_u32 s20, s20, s21
    s_lshl_b32 s21, s37, 13
    s_add_u32 s21, s21, 0x20000
    v_add_u32 v4, s20, v1
    v_xor_b32 v5, 64, v4
    v_add_u32 v6, s21, v1
    v_xor_b32 v7, 64, v6
    v_lshrrev_b32 v13, 3, v0
    v_and_b32 v1, 7, v0
    v_lshlrev_b32 v3, 4, v1
    v_lshl_add_u32 v3, v13, 10, v3
    v_lshlrev_b32 v1, 9, v1
    v_lshl_add_u32 v1, v13, 4, v1
    s_and_b32 s39, s34, 3
    s_lshl_b32 s35, s43, 3
    s_add_u32 s35, s35, s39
    s_mul_i32 s40, s35, 114688
    s_mul_i32 s41, s37, 28672
    s_add_u32 s40, s40, s41
    s_add_u32 s40, s40, 0x800000
    s_lshl_b32 s35, s35, 15
    s_lshl_b32 s42, s38, 7
    s_add_u32 s42, s42, s35
    s_add_u32 s42, s42, s21
    s_sub_u32 s42, s42, 0x20000
    s_lshl_b32 s41, s38, 12
    s_add_u32 s41, s41, s35
    s_lshl_b32 s35, s37, 7
    s_add_u32 s41, s41, s35
    s_add_u32 s41, s41, 0x300000
    v_min_u32 v13, 6, v0
    v_lshlrev_b32 v13, 7, v13
    s_lshl_b32 s44, s43, 12
    s_mul_i32 s35, s37, 896
    s_add_u32 s44, s44, s35
    s_lshl_b32 s39, s39, 2
    s_add_u32 s44, s44, s39
    s_add_u32 s44, s44, 0x248000
    s_mov_b32 s16, s26
    s_and_b32 s17, s27, 0xffff
    s_mov_b32 s18, 0x200000
    s_mov_b32 s19, 0x00020000
    v_mov_b32 v14, v9
    v_mov_b32 v15, v8
    s_cmp_ge_u32 s34, 28
    s_cbranch_scc1 M_CD1
    s_waitcnt vmcnt(0)
    s_lshl_b32 s35, s33, 7
    s_lshl_b32 s45, s32, 2
    s_add_u32 s35, s35, s45
    s_add_u32 s35, s35, 0x248000
    v_mov_b32 v10, s99
    v_mov_b32 v11, 0
    s_mov_b64 exec, 1
    s_cmp_eq_u32 s3, 1
    s_cbranch_scc0 M_SF0
    buffer_store_dword v10, v11, s[28:31], s35 offen
M_SE0:
    s_mov_b64 exec, -1
M_CD1:
    s_mov_b32 s46, 0
M_PR1:
    ds_read_b128 v[16:19], v15
    ds_read_b128 v[20:23], v15 offset:16
    s_waitcnt lgkmcnt(0)
    v_min3_u32 v16, v16, v17, v18
    v_min3_u32 v16, v16, v19, v20
    v_min3_u32 v16, v16, v21, v22
    v_min_u32 v16, v16, v23
    v_cmp_gt_u32 vcc, 8, v16
    s_cbranch_vccz M_PS1
    s_add_u32 s46, s46, 1
    s_sleep 1
    s_cmp_lt_u32 s46, 524288
    s_cbranch_scc1 M_PR1
M_PS1:
    s_add_u32 m0, s20, 0
    s_add_u32 s45, s22, 65536
    buffer_load_dwordx4 v14, s[56:59], s45 offen lds
    s_add_u32 m0, s20, 1024
    s_add_u32 s45, s22, 73728
    buffer_load_dwordx4 v14, s[56:59], s45 offen lds
    s_add_u32 m0, s20, 2048
    s_add_u32 s45, s22, 81920
    buffer_load_dwordx4 v14, s[56:59], s45 offen lds
    s_add_u32 m0, s20, 3072
    s_add_u32 s45, s22, 90112
    buffer_load_dwordx4 v14, s[56:59], s45 offen lds
    s_add_u32 m0, s20, 4096
    s_add_u32 s45, s22, 98304
    buffer_load_dwordx4 v14, s[56:59], s45 offen lds
    s_add_u32 m0, s20, 5120
    s_add_u32 s45, s22, 106496
    buffer_load_dwordx4 v14, s[56:59], s45 offen lds
    s_add_u32 m0, s20, 6144
    s_add_u32 s45, s22, 114688
    buffer_load_dwordx4 v14, s[56:59], s45 offen lds
    s_add_u32 m0, s20, 7168
    s_add_u32 s45, s22, 122880
    buffer_load_dwordx4 v14, s[56:59], s45 offen lds
    s_mov_b32 s46, 0
M_PR2:
    ds_read_b128 v[16:19], v15
    ds_read_b128 v[20:23], v15 offset:16
    s_waitcnt lgkmcnt(0)
    v_min3_u32 v16, v16, v17, v18
    v_min3_u32 v16, v16, v19, v20
    v_min3_u32 v16, v16, v21, v22
    v_min_u32 v16, v16, v23
    v_cmp_gt_u32 vcc, 16, v16
    s_cbranch_vccz M_PS2
    s_add_u32 s46, s46, 1
    s_sleep 1
    s_cmp_lt_u32 s46, 524288
    s_cbranch_scc1 M_PR2
M_PS2:
    s_mov_b32 s46, 0
    buffer_load_dword v20, v13, s[28:31], s44 offen sc1
    s_add_u32 m0, s20, 16384
    s_add_u32 s45, s22, 131072
    buffer_load_dwordx4 v14, s[56:59], s45 offen lds
    s_add_u32 m0, s20, 17408
    s_add_u32 s45, s22, 139264
    buffer_load_dwordx4 v14, s[56:59], s45 offen lds
    s_add_u32 m0, s20, 18432
    s_add_u32 s45, s22, 147456
    buffer_load_dwordx4 v14, s[56:59], s45 offen lds
    s_add_u32 m0, s20, 19456
    s_add_u32 s45, s22, 155648
    buffer_load_dwordx4 v14, s[56:59], s45 offen lds
    s_add_u32 m0, s20, 20480
    s_add_u32 s45, s22, 163840
    buffer_load_dwordx4 v14, s[56:59], s45 offen lds
    s_add_u32 m0, s20, 21504
    s_add_u32 s45, s22, 172032
    buffer_load_dwordx4 v14, s[56:59], s45 offen lds
    s_add_u32 m0, s20, 22528
    s_add_u32 s45, s22, 180224
    buffer_load_dwordx4 v14, s[56:59], s45 offen lds
    s_add_u32 m0, s20, 23552
    s_add_u32 s45, s22, 188416
    buffer_load_dwordx4 v14, s[56:59], s45 offen lds
    s_waitcnt vmcnt(8)
    v_cmp_ne_u32 vcc, s99, v20
    s_cbranch_vccz M_PGC
M_PLC:
    buffer_load_dword v20, v13, s[28:31], s44 offen sc1
    s_waitcnt vmcnt(0)
    v_cmp_ne_u32 vcc, s99, v20
    s_cbranch_vccz M_PGC
    s_add_u32 s46, s46, 1
    s_sleep 2
    s_cmp_lt_u32 s46, 131072
    s_cbranch_scc1 M_PLC
M_PGC:
    s_add_u32 s39, s40, 20480
    buffer_load_dwordx4 v[144:147], v12, s[28:31], s39 offen offset:0 sc1
    buffer_load_dwordx4 v[148:151], v12, s[28:31], s39 offen offset:1024 sc1
    buffer_load_dwordx4 v[152:155], v12, s[28:31], s39 offen offset:2048 sc1
    buffer_load_dwordx4 v[156:159], v12, s[28:31], s39 offen offset:3072 sc1
    s_add_u32 s39, s40, 24576
    buffer_load_dwordx4 v[160:163], v12, s[28:31], s39 offen offset:0 sc1
    buffer_load_dwordx4 v[164:167], v12, s[28:31], s39 offen offset:1024 sc1
    buffer_load_dwordx4 v[168:171], v12, s[28:31], s39 offen offset:2048 sc1
    buffer_load_dwordx4 v[172:175], v12, s[28:31], s39 offen offset:3072 sc1
    s_add_u32 s39, s40, 4096
    buffer_load_dwordx4 v[80:83], v12, s[28:31], s39 offen offset:0 sc1
    buffer_load_dwordx4 v[84:87], v12, s[28:31], s39 offen offset:1024 sc1
    buffer_load_dwordx4 v[88:91], v12, s[28:31], s39 offen offset:2048 sc1
    buffer_load_dwordx4 v[92:95], v12, s[28:31], s39 offen offset:3072 sc1
    s_add_u32 s39, s40, 8192
    buffer_load_dwordx4 v[96:99], v12, s[28:31], s39 offen offset:0 sc1
    buffer_load_dwordx4 v[100:103], v12, s[28:31], s39 offen offset:1024 sc1
    buffer_load_dwordx4 v[104:107], v12, s[28:31], s39 offen offset:2048 sc1
    buffer_load_dwordx4 v[108:111], v12, s[28:31], s39 offen offset:3072 sc1
    s_mov_b32 s46, 0
M_PR3:
    ds_read_b128 v[16:19], v15
    ds_read_b128 v[20:23], v15 offset:16
    s_waitcnt lgkmcnt(0)
    v_min3_u32 v16, v16, v17, v18
    v_min3_u32 v16, v16, v19, v20
    v_min3_u32 v16, v16, v21, v22
    v_min_u32 v16, v16, v23
    v_cmp_gt_u32 vcc, 24, v16
    s_cbranch_vccz M_PS3
    s_add_u32 s46, s46, 1
    s_sleep 1
    s_cmp_lt_u32 s46, 524288
    s_cbranch_scc1 M_PR3
M_PS3:
    s_add_u32 m0, s20, 32768
    s_add_u32 s45, s22, 196608
    buffer_load_dwordx4 v14, s[56:59], s45 offen lds
    s_add_u32 m0, s20, 33792
    s_add_u32 s45, s22, 204800
    buffer_load_dwordx4 v14, s[56:59], s45 offen lds
    s_add_u32 m0, s20, 34816
    s_add_u32 s45, s22, 212992
    buffer_load_dwordx4 v14, s[56:59], s45 offen lds
    s_add_u32 m0, s20, 35840
    s_add_u32 s45, s22, 221184
    buffer_load_dwordx4 v14, s[56:59], s45 offen lds
    s_add_u32 m0, s20, 36864
    s_add_u32 s45, s22, 229376
    buffer_load_dwordx4 v14, s[56:59], s45 offen lds
    s_add_u32 m0, s20, 37888
    s_add_u32 s45, s22, 237568
    buffer_load_dwordx4 v14, s[56:59], s45 offen lds
    s_add_u32 m0, s20, 38912
    s_add_u32 s45, s22, 245760
    buffer_load_dwordx4 v14, s[56:59], s45 offen lds
    s_add_u32 m0, s20, 39936
    s_add_u32 s45, s22, 253952
    buffer_load_dwordx4 v14, s[56:59], s45 offen lds
    s_add_u32 s39, s40, 12288
    buffer_load_dwordx4 v[112:115], v12, s[28:31], s39 offen offset:0 sc1
    buffer_load_dwordx4 v[116:119], v12, s[28:31], s39 offen offset:1024 sc1
    buffer_load_dwordx4 v[120:123], v12, s[28:31], s39 offen offset:2048 sc1
    buffer_load_dwordx4 v[124:127], v12, s[28:31], s39 offen offset:3072 sc1
    s_mov_b32 s46, 0
M_PR4:
    ds_read_b128 v[16:19], v15
    ds_read_b128 v[20:23], v15 offset:16
    s_waitcnt lgkmcnt(0)
    v_min3_u32 v16, v16, v17, v18
    v_min3_u32 v16, v16, v19, v20
    v_min3_u32 v16, v16, v21, v22
    v_min_u32 v16, v16, v23
    v_cmp_gt_u32 vcc, 32, v16
    s_cbranch_vccz M_PS4
    s_add_u32 s46, s46, 1
    s_sleep 1
    s_cmp_lt_u32 s46, 524288
    s_cbranch_scc1 M_PR4
M_PS4:
    s_waitcnt vmcnt(27)
    v_mfma_f32_32x32x16_bf16 v[32:47], v[192:195], v[144:147], 0
    v_mfma_f32_32x32x16_bf16 v[48:63], v[196:199], v[144:147], 0
    s_add_u32 m0, s20, 49152
    s_add_u32 s45, s22, 262144
    buffer_load_dwordx4 v14, s[56:59], s45 offen lds
    s_add_u32 m0, s20, 50176
    s_add_u32 s45, s22, 270336
    buffer_load_dwordx4 v14, s[56:59], s45 offen lds
    s_waitcnt vmcnt(28)
    v_mfma_f32_32x32x16_bf16 v[32:47], v[200:203], v[148:151], v[32:47]
    v_mfma_f32_32x32x16_bf16 v[48:63], v[204:207], v[148:151], v[48:63]
    s_add_u32 m0, s20, 51200
    s_add_u32 s45, s22, 278528
    buffer_load_dwordx4 v14, s[56:59], s45 offen lds
    s_add_u32 m0, s20, 52224
    s_add_u32 s45, s22, 286720
    buffer_load_dwordx4 v14, s[56:59], s45 offen lds
    s_waitcnt vmcnt(29)
    v_mfma_f32_32x32x16_bf16 v[32:47], v[208:211], v[152:155], v[32:47]
    v_mfma_f32_32x32x16_bf16 v[48:63], v[212:215], v[152:155], v[48:63]
    s_add_u32 m0, s20, 53248
    s_add_u32 s45, s22, 294912
    buffer_load_dwordx4 v14, s[56:59], s45 offen lds
    s_add_u32 m0, s20, 54272
    s_add_u32 s45, s22, 303104
    buffer_load_dwordx4 v14, s[56:59], s45 offen lds
    s_waitcnt vmcnt(30)
    v_mfma_f32_32x32x16_bf16 v[32:47], v[216:219], v[156:159], v[32:47]
    v_mfma_f32_32x32x16_bf16 v[48:63], v[220:223], v[156:159], v[48:63]
    s_add_u32 m0, s20, 55296
    s_add_u32 s45, s22, 311296
    buffer_load_dwordx4 v14, s[56:59], s45 offen lds
    s_add_u32 m0, s20, 56320
    s_add_u32 s45, s22, 319488
    buffer_load_dwordx4 v14, s[56:59], s45 offen lds
    s_waitcnt vmcnt(31)
    v_mfma_f32_32x32x16_bf16 v[32:47], v[224:227], v[160:163], v[32:47]
    v_mfma_f32_32x32x16_bf16 v[48:63], v[228:231], v[160:163], v[48:63]
    s_add_u32 m0, s21, 7168
    s_add_u32 s45, s22, 57344
    buffer_load_dwordx4 v14, s[56:59], s45 offen lds
    s_add_u32 s39, s40, 16384
    buffer_load_dwordx4 v[128:131], v12, s[28:31], s39 offen offset:0 sc1
    s_waitcnt vmcnt(32)
    v_mfma_f32_32x32x16_bf16 v[32:47], v[232:235], v[164:167], v[32:47]
    v_mfma_f32_32x32x16_bf16 v[48:63], v[236:239], v[164:167], v[48:63]
    buffer_load_dwordx4 v[132:135], v12, s[28:31], s39 offen offset:1024 sc1
    buffer_load_dwordx4 v[136:139], v12, s[28:31], s39 offen offset:2048 sc1
    ds_read_b64_tr_b16 v[16:17], v4 offset:0
    ds_read_b64_tr_b16 v[18:19], v4 offset:512
    s_waitcnt vmcnt(33)
    v_mfma_f32_32x32x16_bf16 v[32:47], v[240:243], v[168:171], v[32:47]
    ds_read_b64_tr_b16 v[20:21], v5 offset:0
    ds_read_b64_tr_b16 v[22:23], v5 offset:512
    v_mfma_f32_32x32x16_bf16 v[48:63], v[244:247], v[168:171], v[48:63]
    buffer_load_dwordx4 v[140:143], v12, s[28:31], s39 offen offset:3072 sc1
    s_add_u32 s39, s40, 0
    buffer_load_dwordx4 v[64:67], v12, s[28:31], s39 offen offset:0 sc1
    ds_read_b64_tr_b16 v[24:25], v4 offset:2048
    ds_read_b64_tr_b16 v[26:27], v4 offset:2560
    s_waitcnt vmcnt(34)
    v_mfma_f32_32x32x16_bf16 v[32:47], v[248:251], v[172:175], v[32:47]
    ds_read_b64_tr_b16 v[28:29], v5 offset:2048
    ds_read_b64_tr_b16 v[30:31], v5 offset:2560
    v_mfma_f32_32x32x16_bf16 v[48:63], v[252:255], v[172:175], v[48:63]
    buffer_load_dwordx4 v[68:71], v12, s[28:31], s39 offen offset:1024 sc1
    buffer_load_dwordx4 v[72:75], v12, s[28:31], s39 offen offset:2048 sc1
    ds_read_b64_tr_b16 v[176:177], v4 offset:4096
    ds_read_b64_tr_b16 v[178:179], v4 offset:4608
    s_waitcnt vmcnt(35) lgkmcnt(6)
    v_mfma_f32_32x32x16_bf16 v[32:47], v[16:19], v[80:83], v[32:47]
    ds_read_b64_tr_b16 v[180:181], v5 offset:4096
    ds_read_b64_tr_b16 v[182:183], v5 offset:4608
    v_mfma_f32_32x32x16_bf16 v[48:63], v[20:23], v[80:83], v[48:63]
    buffer_load_dwordx4 v[76:79], v12, s[28:31], s39 offen offset:3072 sc1
    buffer_load_dwordx4 v[8:11], v1, s[28:31], s41 offen sc1
    ds_read_b64_tr_b16 v[184:185], v4 offset:6144
    ds_read_b64_tr_b16 v[186:187], v4 offset:6656
    s_waitcnt vmcnt(36) lgkmcnt(6)
    v_mfma_f32_32x32x16_bf16 v[32:47], v[24:27], v[84:87], v[32:47]
    ds_read_b64_tr_b16 v[188:189], v5 offset:6144
    ds_read_b64_tr_b16 v[190:191], v5 offset:6656
    v_mfma_f32_32x32x16_bf16 v[48:63], v[28:31], v[84:87], v[48:63]
    ds_read_b64_tr_b16 v[16:17], v4 offset:16384
    ds_read_b64_tr_b16 v[18:19], v4 offset:16896
    s_waitcnt vmcnt(35) lgkmcnt(6)
    v_mfma_f32_32x32x16_bf16 v[32:47], v[176:179], v[88:91], v[32:47]
    ds_read_b64_tr_b16 v[20:21], v5 offset:16384
    ds_read_b64_tr_b16 v[22:23], v5 offset:16896
    v_mfma_f32_32x32x16_bf16 v[48:63], v[180:183], v[88:91], v[48:63]
    ds_read_b64_tr_b16 v[24:25], v4 offset:18432
    ds_read_b64_tr_b16 v[26:27], v4 offset:18944
    s_waitcnt vmcnt(34) lgkmcnt(6)
    v_mfma_f32_32x32x16_bf16 v[32:47], v[184:187], v[92:95], v[32:47]
    ds_read_b64_tr_b16 v[28:29], v5 offset:18432
    ds_read_b64_tr_b16 v[30:31], v5 offset:18944
    v_mfma_f32_32x32x16_bf16 v[48:63], v[188:191], v[92:95], v[48:63]
    ds_read_b64_tr_b16 v[176:177], v4 offset:20480
    ds_read_b64_tr_b16 v[178:179], v4 offset:20992
    s_waitcnt vmcnt(33) lgkmcnt(6)
    v_mfma_f32_32x32x16_bf16 v[32:47], v[16:19], v[96:99], v[32:47]
    ds_read_b64_tr_b16 v[180:181], v5 offset:20480
    ds_read_b64_tr_b16 v[182:183], v5 offset:20992
    v_mfma_f32_32x32x16_bf16 v[48:63], v[20:23], v[96:99], v[48:63]
    ds_read_b64_tr_b16 v[184:185], v4 offset:22528
    ds_read_b64_tr_b16 v[186:187], v4 offset:23040
    s_waitcnt vmcnt(32) lgkmcnt(6)
    v_mfma_f32_32x32x16_bf16 v[32:47], v[24:27], v[100:103], v[32:47]
    ds_read_b64_tr_b16 v[188:189], v5 offset:22528
    ds_read_b64_tr_b16 v[190:191], v5 offset:23040
    v_mfma_f32_32x32x16_bf16 v[48:63], v[28:31], v[100:103], v[48:63]
    s_waitcnt vmcnt(22)
    ds_read_b64_tr_b16 v[16:17], v4 offset:32768
    ds_read_b64_tr_b16 v[18:19], v4 offset:33280
    s_waitcnt lgkmcnt(6)
    v_mfma_f32_32x32x16_bf16 v[32:47], v[176:179], v[104:107], v[32:47]
    ds_read_b64_tr_b16 v[20:21], v5 offset:32768
    ds_read_b64_tr_b16 v[22:23], v5 offset:33280
    v_mfma_f32_32x32x16_bf16 v[48:63], v[180:183], v[104:107], v[48:63]
    ds_read_b64_tr_b16 v[24:25], v4 offset:34816
    ds_read_b64_tr_b16 v[26:27], v4 offset:35328
    s_waitcnt lgkmcnt(6)
    v_mfma_f32_32x32x16_bf16 v[32:47], v[184:187], v[108:111], v[32:47]
    ds_read_b64_tr_b16 v[28:29], v5 offset:34816
    ds_read_b64_tr_b16 v[30:31], v5 offset:35328
    v_mfma_f32_32x32x16_bf16 v[48:63], v[188:191], v[108:111], v[48:63]
    ds_read_b64_tr_b16 v[176:177], v4 offset:36864
    ds_read_b64_tr_b16 v[178:179], v4 offset:37376
    s_waitcnt vmcnt(21) lgkmcnt(6)
    v_mfma_f32_32x32x16_bf16 v[32:47], v[16:19], v[112:115], v[32:47]
    ds_read_b64_tr_b16 v[180:181], v5 offset:36864
    ds_read_b64_tr_b16 v[182:183], v5 offset:37376
    v_mfma_f32_32x32x16_bf16 v[48:63], v[20:23], v[112:115], v[48:63]
    ds_read_b64_tr_b16 v[184:185], v4 offset:38912
    ds_read_b64_tr_b16 v[186:187], v4 offset:39424
    s_waitcnt vmcnt(20) lgkmcnt(6)
    v_mfma_f32_32x32x16_bf16 v[32:47], v[24:27], v[116:119], v[32:47]
    ds_read_b64_tr_b16 v[188:189], v5 offset:38912
    ds_read_b64_tr_b16 v[190:191], v5 offset:39424
    v_mfma_f32_32x32x16_bf16 v[48:63], v[28:31], v[116:119], v[48:63]
    s_waitcnt vmcnt(10)
    ds_read_b64_tr_b16 v[16:17], v4 offset:49152
    ds_read_b64_tr_b16 v[18:19], v4 offset:49664
    s_waitcnt lgkmcnt(6)
    v_mfma_f32_32x32x16_bf16 v[32:47], v[176:179], v[120:123], v[32:47]
    ds_read_b64_tr_b16 v[20:21], v5 offset:49152
    ds_read_b64_tr_b16 v[22:23], v5 offset:49664
    v_mfma_f32_32x32x16_bf16 v[48:63], v[180:183], v[120:123], v[48:63]
    ds_read_b64_tr_b16 v[24:25], v4 offset:51200
    ds_read_b64_tr_b16 v[26:27], v4 offset:51712
    s_waitcnt lgkmcnt(6)
    v_mfma_f32_32x32x16_bf16 v[32:47], v[184:187], v[124:127], v[32:47]
    ds_read_b64_tr_b16 v[28:29], v5 offset:51200
    ds_read_b64_tr_b16 v[30:31], v5 offset:51712
    v_mfma_f32_32x32x16_bf16 v[48:63], v[188:191], v[124:127], v[48:63]
    ds_read_b64_tr_b16 v[176:177], v4 offset:53248
    ds_read_b64_tr_b16 v[178:179], v4 offset:53760
    s_waitcnt vmcnt(8) lgkmcnt(6)
    v_mfma_f32_32x32x16_bf16 v[32:47], v[16:19], v[128:131], v[32:47]
    ds_read_b64_tr_b16 v[180:181], v5 offset:53248
    ds_read_b64_tr_b16 v[182:183], v5 offset:53760
    v_mfma_f32_32x32x16_bf16 v[48:63], v[20:23], v[128:131], v[48:63]
    ds_read_b64_tr_b16 v[184:185], v4 offset:55296
    ds_read_b64_tr_b16 v[186:187], v4 offset:55808
    s_waitcnt vmcnt(7) lgkmcnt(6)
    v_mfma_f32_32x32x16_bf16 v[32:47], v[24:27], v[132:135], v[32:47]
    ds_read_b64_tr_b16 v[188:189], v5 offset:55296
    ds_read_b64_tr_b16 v[190:191], v5 offset:55808
    v_mfma_f32_32x32x16_bf16 v[48:63], v[28:31], v[132:135], v[48:63]
    ds_read_b64_tr_b16 v[16:17], v6 offset:0
    ds_read_b64_tr_b16 v[18:19], v6 offset:512
    s_waitcnt vmcnt(6) lgkmcnt(6)
    v_mfma_f32_32x32x16_bf16 v[32:47], v[176:179], v[136:139], v[32:47]
    ds_read_b64_tr_b16 v[20:21], v7 offset:0
    ds_read_b64_tr_b16 v[22:23], v7 offset:512
    v_mfma_f32_32x32x16_bf16 v[48:63], v[180:183], v[136:139], v[48:63]
    ds_read_b64_tr_b16 v[24:25], v6 offset:2048
    ds_read_b64_tr_b16 v[26:27], v6 offset:2560
    s_waitcnt vmcnt(5) lgkmcnt(6)
    v_mfma_f32_32x32x16_bf16 v[32:47], v[184:187], v[140:143], v[32:47]
    ds_read_b64_tr_b16 v[28:29], v7 offset:2048
    ds_read_b64_tr_b16 v[30:31], v7 offset:2560
    v_mfma_f32_32x32x16_bf16 v[48:63], v[188:191], v[140:143], v[48:63]
    ds_read_b64_tr_b16 v[176:177], v6 offset:4096
    ds_read_b64_tr_b16 v[178:179], v6 offset:4608
    s_waitcnt vmcnt(4) lgkmcnt(6)
    v_mfma_f32_32x32x16_bf16 v[32:47], v[16:19], v[64:67], v[32:47]
    ds_read_b64_tr_b16 v[180:181], v7 offset:4096
    ds_read_b64_tr_b16 v[182:183], v7 offset:4608
    v_mfma_f32_32x32x16_bf16 v[48:63], v[20:23], v[64:67], v[48:63]
    ds_read_b64_tr_b16 v[184:185], v6 offset:6144
    ds_read_b64_tr_b16 v[186:187], v6 offset:6656
    s_waitcnt vmcnt(3) lgkmcnt(6)
    v_mfma_f32_32x32x16_bf16 v[32:47], v[24:27], v[68:71], v[32:47]
    ds_read_b64_tr_b16 v[188:189], v7 offset:6144
    ds_read_b64_tr_b16 v[190:191], v7 offset:6656
    v_mfma_f32_32x32x16_bf16 v[48:63], v[28:31], v[68:71], v[48:63]
    s_waitcnt vmcnt(2) lgkmcnt(4)
    v_mfma_f32_32x32x16_bf16 v[32:47], v[176:179], v[72:75], v[32:47]
    v_mfma_f32_32x32x16_bf16 v[48:63], v[180:183], v[72:75], v[48:63]
    s_waitcnt vmcnt(1) lgkmcnt(0)
    v_mfma_f32_32x32x16_bf16 v[32:47], v[184:187], v[76:79], v[32:47]
    v_mfma_f32_32x32x16_bf16 v[48:63], v[188:191], v[76:79], v[48:63]
    v_lshrrev_b32 v13, 5, v0
    v_lshlrev_b32 v13, 5, v13
    v_xor_b32 v13, v13, v12
    v_add_u32 v4, s20, v13
    v_xor_b32 v5, 64, v4
    v_xor_b32 v6, 128, v4
    v_xor_b32 v7, 192, v4
    s_barrier
    s_barrier
    s_nop 2
    ds_write_b128 v4, v[32:35] offset:0
    ds_write_b128 v4, v[36:39] offset:1024
    ds_write_b128 v5, v[40:43] offset:2048
    ds_write_b128 v5, v[44:47] offset:3072
    ds_write_b128 v6, v[48:51] offset:4096
    ds_write_b128 v6, v[52:55] offset:5120
    ds_write_b128 v7, v[56:59] offset:6144
    ds_write_b128 v7, v[60:63] offset:7168
    v_and_b32 v13, 7, v0
    v_lshrrev_b32 v14, 3, v0
    s_lshl_b32 s35, s37, 3
    v_add_u32 v14, s35, v14
    v_lshlrev_b32 v15, 1, v13
    v_xor_b32 v14, v14, v15
    v_lshlrev_b32 v14, 4, v14
    v_and_b32 v15, 1, v13
    v_lshl_add_u32 v14, v15, 9, v14
    v_lshrrev_b32 v15, 1, v13
    v_lshl_add_u32 v15, v15, 11, v14
    v_add_u32 v13, 0x10000, v15
    s_waitcnt vmcnt(0)
    v_lshlrev_b32 v16, 16, v8
    v_and_b32 v17, 0xffff0000, v8
    v_lshlrev_b32 v18, 16, v9
    v_and_b32 v19, 0xffff0000, v9
    v_lshlrev_b32 v20, 16, v10
    v_and_b32 v21, 0xffff0000, v10
    v_lshlrev_b32 v22, 16, v11
    v_and_b32 v23, 0xffff0000, v11
    s_waitcnt lgkmcnt(0)
    s_barrier
    ds_read_b128 v[192:195], v15 offset:0
    ds_read_b128 v[196:199], v15 offset:1024
    ds_read_b128 v[200:203], v15 offset:8192
    ds_read_b128 v[204:207], v15 offset:9216
    ds_read_b128 v[208:211], v13 offset:0
    ds_read_b128 v[212:215], v13 offset:1024
    ds_read_b128 v[216:219], v13 offset:8192
    ds_read_b128 v[220:223], v13 offset:9216
    s_waitcnt lgkmcnt(6)
    s_waitcnt lgkmcnt(4)
    v_pk_add_f32 v[192:193], v[192:193], v[200:201]
    v_pk_add_f32 v[194:195], v[194:195], v[202:203]
    v_pk_add_f32 v[196:197], v[196:197], v[204:205]
    v_pk_add_f32 v[198:199], v[198:199], v[206:207]
    s_waitcnt lgkmcnt(2)
    v_pk_add_f32 v[192:193], v[192:193], v[208:209]
    v_pk_add_f32 v[194:195], v[194:195], v[210:211]
    v_pk_add_f32 v[196:197], v[196:197], v[212:213]
    v_pk_add_f32 v[198:199], v[198:199], v[214:215]
    s_waitcnt lgkmcnt(0)
    v_pk_add_f32 v[192:193], v[192:193], v[216:217]
    v_pk_add_f32 v[194:195], v[194:195], v[218:219]
    v_pk_add_f32 v[196:197], v[196:197], v[220:221]
    v_pk_add_f32 v[198:199], v[198:199], v[222:223]
    v_pk_add_f32 v[192:193], v[192:193], v[16:17]
    v_pk_add_f32 v[194:195], v[194:195], v[18:19]
    v_pk_add_f32 v[196:197], v[196:197], v[20:21]
    v_pk_add_f32 v[198:199], v[198:199], v[22:23]
    v_cvt_pk_bf16_f32 v8, v192, v193
    v_cvt_pk_bf16_f32 v9, v194, v195
    v_cvt_pk_bf16_f32 v10, v196, v197
    v_cvt_pk_bf16_f32 v11, v198, v199
    buffer_store_dwordx4 v[8:11], v3, s[16:19], s42 offen nt
    s_endpgm
M_CSLOW:
    s_mov_b32 s47, 1
    s_mov_b32 s61, 0
    v_lshlrev_b32 v2, 4, v0
    s_waitcnt vmcnt(0)
    v_and_b32 v8, 15, v0
    v_cmp_eq_u32 vcc, 0, v8
    v_mov_b32 v8, 0x3f803f80
    s_lshl_b32 s38, s32, 15
    v_cndmask_b32 v8, 0, v8, vcc
    s_add_u32 s38, s38, 0x200000
    v_and_b32 v16, 0x33, v0
    v_bfe_u32 v17, v0, 2, 1
    v_lshl_add_u32 v16, v17, 3, v16
    v_bfe_u32 v17, v0, 3, 1
    v_lshl_add_u32 v16, v17, 2, v16
    v_lshlrev_b32 v16, 4, v16
    buffer_load_dwordx4 v[64:67], v16, s[28:31], s38 offen sc1
    buffer_load_dwordx4 v[128:131], v2, s[28:31], s38 offen offset:1024 sc1
    s_add_u32 s38, s38, 0x800
    v_mov_b32 v132, v8
    v_mov_b32 v133, v8
    v_mov_b32 v134, v8
    v_mov_b32 v135, v8
    buffer_load_dwordx4 v[68:71], v16, s[28:31], s38 offen sc1
    buffer_load_dwordx4 v[136:139], v2, s[28:31], s38 offen offset:1024 sc1
    s_add_u32 s38, s38, 0x800
    v_mov_b32 v140, v8
    v_mov_b32 v141, v8
    v_mov_b32 v142, v8
    v_mov_b32 v143, v8
    buffer_load_dwordx4 v[72:75], v16, s[28:31], s38 offen sc1
    buffer_load_dwordx4 v[144:147], v2, s[28:31], s38 offen offset:1024 sc1
    s_add_u32 s38, s38, 0x800
    v_mov_b32 v148, v8
    v_mov_b32 v149, v8
    v_mov_b32 v150, v8
    v_mov_b32 v151, v8
    buffer_load_dwordx4 v[76:79], v16, s[28:31], s38 offen sc1
    buffer_load_dwordx4 v[152:155], v2, s[28:31], s38 offen offset:1024 sc1
    s_add_u32 s38, s38, 0x800
    v_mov_b32 v156, v8
    v_mov_b32 v157, v8
    v_mov_b32 v158, v8
    v_mov_b32 v159, v8
    buffer_load_dwordx4 v[80:83], v16, s[28:31], s38 offen sc1
    buffer_load_dwordx4 v[160:163], v2, s[28:31], s38 offen offset:1024 sc1
    s_add_u32 s38, s38, 0x800
    v_mov_b32 v164, v8
    v_mov_b32 v165, v8
    v_mov_b32 v166, v8
    v_mov_b32 v167, v8
    buffer_load_dwordx4 v[84:87], v16, s[28:31], s38 offen sc1
    buffer_load_dwordx4 v[168:171], v2, s[28:31], s38 offen offset:1024 sc1
    s_add_u32 s38, s38, 0x800
    v_mov_b32 v172, v8
    v_mov_b32 v173, v8
    v_mov_b32 v174, v8
    v_mov_b32 v175, v8
    buffer_load_dwordx4 v[88:91], v16, s[28:31], s38 offen sc1
    buffer_load_dwordx4 v[176:179], v2, s[28:31], s38 offen offset:1024 sc1
    s_add_u32 s38, s38, 0x800
    v_mov_b32 v180, v8
    v_mov_b32 v181, v8
    v_mov_b32 v182, v8
    v_mov_b32 v183, v8
    buffer_load_dwordx4 v[92:95], v16, s[28:31], s38 offen sc1
    buffer_load_dwordx4 v[184:187], v2, s[28:31], s38 offen offset:1024 sc1
    s_add_u32 s38, s38, 0x800
    v_mov_b32 v188, v8
    v_mov_b32 v189, v8
    v_mov_b32 v190, v8
    v_mov_b32 v191, v8
    buffer_load_dwordx4 v[96:99], v16, s[28:31], s38 offen sc1
    buffer_load_dwordx4 v[192:195], v2, s[28:31], s38 offen offset:1024 sc1
    s_add_u32 s38, s38, 0x800
    v_mov_b32 v196, v8
    v_mov_b32 v197, v8
    v_mov_b32 v198, v8
    v_mov_b32 v199, v8
    buffer_load_dwordx4 v[100:103], v16, s[28:31], s38 offen sc1
    buffer_load_dwordx4 v[200:203], v2, s[28:31], s38 offen offset:1024 sc1
    s_add_u32 s38, s38, 0x800
    v_mov_b32 v204, v8
    v_mov_b32 v205, v8
    v_mov_b32 v206, v8
    v_mov_b32 v207, v8
    buffer_load_dwordx4 v[104:107], v16, s[28:31], s38 offen sc1
    buffer_load_dwordx4 v[208:211], v2, s[28:31], s38 offen offset:1024 sc1
    s_add_u32 s38, s38, 0x800
    v_mov_b32 v212, v8
    v_mov_b32 v213, v8
    v_mov_b32 v214, v8
    v_mov_b32 v215, v8
    buffer_load_dwordx4 v[108:111], v16, s[28:31], s38 offen sc1
    buffer_load_dwordx4 v[216:219], v2, s[28:31], s38 offen offset:1024 sc1
    s_add_u32 s38, s38, 0x800
    v_mov_b32 v220, v8
    v_mov_b32 v221, v8
    v_mov_b32 v222, v8
    v_mov_b32 v223, v8
    buffer_load_dwordx4 v[112:115], v16, s[28:31], s38 offen sc1
    buffer_load_dwordx4 v[224:227], v2, s[28:31], s38 offen offset:1024 sc1
    s_add_u32 s38, s38, 0x800
    v_mov_b32 v228, v8
    v_mov_b32 v229, v8
    v_mov_b32 v230, v8
    v_mov_b32 v231, v8
    buffer_load_dwordx4 v[116:119], v16, s[28:31], s38 offen sc1
    buffer_load_dwordx4 v[232:235], v2, s[28:31], s38 offen offset:1024 sc1
    s_add_u32 s38, s38, 0x800
    v_mov_b32 v236, v8
    v_mov_b32 v237, v8
    v_mov_b32 v238, v8
    v_mov_b32 v239, v8
    buffer_load_dwordx4 v[120:123], v16, s[28:31], s38 offen sc1
    buffer_load_dwordx4 v[240:243], v2, s[28:31], s38 offen offset:1024 sc1
    s_add_u32 s38, s38, 0x800
    v_mov_b32 v244, v8
    v_mov_b32 v245, v8
    v_mov_b32 v246, v8
    v_mov_b32 v247, v8
    buffer_load_dwordx4 v[124:127], v16, s[28:31], s38 offen sc1
    buffer_load_dwordx4 v[248:251], v2, s[28:31], s38 offen offset:1024 sc1
    s_add_u32 s38, s38, 0x800
    v_mov_b32 v252, v8
    v_mov_b32 v253, v8
    v_mov_b32 v254, v8
    v_mov_b32 v255, v8
    s_waitcnt vmcnt(0)
    v_permlane16_swap_b32 v128, v132
    v_permlane16_swap_b32 v129, v133
    v_permlane16_swap_b32 v130, v134
    v_permlane16_swap_b32 v131, v135
    v_permlane16_swap_b32 v136, v140
    v_permlane16_swap_b32 v137, v141
    v_permlane16_swap_b32 v138, v142
    v_permlane16_swap_b32 v139, v143
    v_permlane16_swap_b32 v144, v148
    v_permlane16_swap_b32 v145, v149
    v_permlane16_swap_b32 v146, v150
    v_permlane16_swap_b32 v147, v151
    v_permlane16_swap_b32 v152, v156
    v_permlane16_swap_b32 v153, v157
    v_permlane16_swap_b32 v154, v158
    v_permlane16_swap_b32 v155, v159
    v_permlane16_swap_b32 v160, v164
    v_permlane16_swap_b32 v161, v165
    v_permlane16_swap_b32 v162, v166
    v_permlane16_swap_b32 v163, v167
    v_permlane16_swap_b32 v168, v172
    v_permlane16_swap_b32 v169, v173
    v_permlane16_swap_b32 v170, v174
    v_permlane16_swap_b32 v171, v175
    v_permlane16_swap_b32 v176, v180
    v_permlane16_swap_b32 v177, v181
    v_permlane16_swap_b32 v178, v182
    v_permlane16_swap_b32 v179, v183
    v_permlane16_swap_b32 v184, v188
    v_permlane16_swap_b32 v185, v189
    v_permlane16_swap_b32 v186, v190
    v_permlane16_swap_b32 v187, v191
    v_permlane16_swap_b32 v192, v196
    v_permlane16_swap_b32 v193, v197
    v_permlane16_swap_b32 v194, v198
    v_permlane16_swap_b32 v195, v199
    v_permlane16_swap_b32 v200, v204
    v_permlane16_swap_b32 v201, v205
    v_permlane16_swap_b32 v202, v206
    v_permlane16_swap_b32 v203, v207
    v_permlane16_swap_b32 v208, v212
    v_permlane16_swap_b32 v209, v213
    v_permlane16_swap_b32 v210, v214
    v_permlane16_swap_b32 v211, v215
    v_permlane16_swap_b32 v216, v220
    v_permlane16_swap_b32 v217, v221
    v_permlane16_swap_b32 v218, v222
    v_permlane16_swap_b32 v219, v223
    v_permlane16_swap_b32 v224, v228
    v_permlane16_swap_b32 v225, v229
    v_permlane16_swap_b32 v226, v230
    v_permlane16_swap_b32 v227, v231
    v_permlane16_swap_b32 v232, v236
    v_permlane16_swap_b32 v233, v237
    v_permlane16_swap_b32 v234, v238
    v_permlane16_swap_b32 v235, v239
    v_permlane16_swap_b32 v240, v244
    v_permlane16_swap_b32 v241, v245
    v_permlane16_swap_b32 v242, v246
    v_permlane16_swap_b32 v243, v247
    v_permlane16_swap_b32 v248, v252
    v_permlane16_swap_b32 v249, v253
    v_permlane16_swap_b32 v250, v254
    v_permlane16_swap_b32 v251, v255
    s_lshl_b32 s35, s32, 7
    s_add_u32 s35, s35, 158336
M_CSLOOP:
    s_add_u32 s38, s36, s61
    buffer_load_dwordx4 v[4:7], v2, s[28:31], s38 offen sc1
    v_mov_b32 v8, 0xff800000
    s_waitcnt vmcnt(0)
    v_mfma_f32_32x32x16_bf16 v[16:31], v[64:67], v[4:7], 0
    s_nop 11
    v_max3_f32 v8, v8, v16, v17
    v_max3_f32 v8, v8, v18, v19
    v_max3_f32 v8, v8, v20, v21
    v_max3_f32 v8, v8, v22, v23
    v_max3_f32 v8, v8, v24, v25
    v_max3_f32 v8, v8, v26, v27
    v_max3_f32 v8, v8, v28, v29
    v_max3_f32 v8, v8, v30, v31
    v_mfma_f32_32x32x16_bf16 v[16:31], v[68:71], v[4:7], 0
    s_nop 11
    v_max3_f32 v8, v8, v16, v17
    v_max3_f32 v8, v8, v18, v19
    v_max3_f32 v8, v8, v20, v21
    v_max3_f32 v8, v8, v22, v23
    v_max3_f32 v8, v8, v24, v25
    v_max3_f32 v8, v8, v26, v27
    v_max3_f32 v8, v8, v28, v29
    v_max3_f32 v8, v8, v30, v31
    v_mfma_f32_32x32x16_bf16 v[16:31], v[72:75], v[4:7], 0
    s_nop 11
    v_max3_f32 v8, v8, v16, v17
    v_max3_f32 v8, v8, v18, v19
    v_max3_f32 v8, v8, v20, v21
    v_max3_f32 v8, v8, v22, v23
    v_max3_f32 v8, v8, v24, v25
    v_max3_f32 v8, v8, v26, v27
    v_max3_f32 v8, v8, v28, v29
    v_max3_f32 v8, v8, v30, v31
    v_mfma_f32_32x32x16_bf16 v[16:31], v[76:79], v[4:7], 0
    s_nop 11
    v_max3_f32 v8, v8, v16, v17
    v_max3_f32 v8, v8, v18, v19
    v_max3_f32 v8, v8, v20, v21
    v_max3_f32 v8, v8, v22, v23
    v_max3_f32 v8, v8, v24, v25
    v_max3_f32 v8, v8, v26, v27
    v_max3_f32 v8, v8, v28, v29
    v_max3_f32 v8, v8, v30, v31
    v_mfma_f32_32x32x16_bf16 v[16:31], v[80:83], v[4:7], 0
    s_nop 11
    v_max3_f32 v8, v8, v16, v17
    v_max3_f32 v8, v8, v18, v19
    v_max3_f32 v8, v8, v20, v21
    v_max3_f32 v8, v8, v22, v23
    v_max3_f32 v8, v8, v24, v25
    v_max3_f32 v8, v8, v26, v27
    v_max3_f32 v8, v8, v28, v29
    v_max3_f32 v8, v8, v30, v31
    v_mfma_f32_32x32x16_bf16 v[16:31], v[84:87], v[4:7], 0
    s_nop 11
    v_max3_f32 v8, v8, v16, v17
    v_max3_f32 v8, v8, v18, v19
    v_max3_f32 v8, v8, v20, v21
    v_max3_f32 v8, v8, v22, v23
    v_max3_f32 v8, v8, v24, v25
    v_max3_f32 v8, v8, v26, v27
    v_max3_f32 v8, v8, v28, v29
    v_max3_f32 v8, v8, v30, v31
    v_mfma_f32_32x32x16_bf16 v[16:31], v[88:91], v[4:7], 0
    s_nop 11
    v_max3_f32 v8, v8, v16, v17
    v_max3_f32 v8, v8, v18, v19
    v_max3_f32 v8, v8, v20, v21
    v_max3_f32 v8, v8, v22, v23
    v_max3_f32 v8, v8, v24, v25
    v_max3_f32 v8, v8, v26, v27
    v_max3_f32 v8, v8, v28, v29
    v_max3_f32 v8, v8, v30, v31
    v_mfma_f32_32x32x16_bf16 v[16:31], v[92:95], v[4:7], 0
    s_nop 11
    v_max3_f32 v8, v8, v16, v17
    v_max3_f32 v8, v8, v18, v19
    v_max3_f32 v8, v8, v20, v21
    v_max3_f32 v8, v8, v22, v23
    v_max3_f32 v8, v8, v24, v25
    v_max3_f32 v8, v8, v26, v27
    v_max3_f32 v8, v8, v28, v29
    v_max3_f32 v8, v8, v30, v31
    v_mfma_f32_32x32x16_bf16 v[16:31], v[96:99], v[4:7], 0
    s_nop 11
    v_max3_f32 v8, v8, v16, v17
    v_max3_f32 v8, v8, v18, v19
    v_max3_f32 v8, v8, v20, v21
    v_max3_f32 v8, v8, v22, v23
    v_max3_f32 v8, v8, v24, v25
    v_max3_f32 v8, v8, v26, v27
    v_max3_f32 v8, v8, v28, v29
    v_max3_f32 v8, v8, v30, v31
    v_mfma_f32_32x32x16_bf16 v[16:31], v[100:103], v[4:7], 0
    s_nop 11
    v_max3_f32 v8, v8, v16, v17
    v_max3_f32 v8, v8, v18, v19
    v_max3_f32 v8, v8, v20, v21
    v_max3_f32 v8, v8, v22, v23
    v_max3_f32 v8, v8, v24, v25
    v_max3_f32 v8, v8, v26, v27
    v_max3_f32 v8, v8, v28, v29
    v_max3_f32 v8, v8, v30, v31
    v_mfma_f32_32x32x16_bf16 v[16:31], v[104:107], v[4:7], 0
    s_nop 11
    v_max3_f32 v8, v8, v16, v17
    v_max3_f32 v8, v8, v18, v19
    v_max3_f32 v8, v8, v20, v21
    v_max3_f32 v8, v8, v22, v23
    v_max3_f32 v8, v8, v24, v25
    v_max3_f32 v8, v8, v26, v27
    v_max3_f32 v8, v8, v28, v29
    v_max3_f32 v8, v8, v30, v31
    v_mfma_f32_32x32x16_bf16 v[16:31], v[108:111], v[4:7], 0
    s_nop 11
    v_max3_f32 v8, v8, v16, v17
    v_max3_f32 v8, v8, v18, v19
    v_max3_f32 v8, v8, v20, v21
    v_max3_f32 v8, v8, v22, v23
    v_max3_f32 v8, v8, v24, v25
    v_max3_f32 v8, v8, v26, v27
    v_max3_f32 v8, v8, v28, v29
    v_max3_f32 v8, v8, v30, v31
    v_mfma_f32_32x32x16_bf16 v[16:31], v[112:115], v[4:7], 0
    s_nop 11
    v_max3_f32 v8, v8, v16, v17
    v_max3_f32 v8, v8, v18, v19
    v_max3_f32 v8, v8, v20, v21
    v_max3_f32 v8, v8, v22, v23
    v_max3_f32 v8, v8, v24, v25
    v_max3_f32 v8, v8, v26, v27
    v_max3_f32 v8, v8, v28, v29
    v_max3_f32 v8, v8, v30, v31
    v_mfma_f32_32x32x16_bf16 v[16:31], v[116:119], v[4:7], 0
    s_nop 11
    v_max3_f32 v8, v8, v16, v17
    v_max3_f32 v8, v8, v18, v19
    v_max3_f32 v8, v8, v20, v21
    v_max3_f32 v8, v8, v22, v23
    v_max3_f32 v8, v8, v24, v25
    v_max3_f32 v8, v8, v26, v27
    v_max3_f32 v8, v8, v28, v29
    v_max3_f32 v8, v8, v30, v31
    v_mfma_f32_32x32x16_bf16 v[16:31], v[120:123], v[4:7], 0
    s_nop 11
    v_max3_f32 v8, v8, v16, v17
    v_max3_f32 v8, v8, v18, v19
    v_max3_f32 v8, v8, v20, v21
    v_max3_f32 v8, v8, v22, v23
    v_max3_f32 v8, v8, v24, v25
    v_max3_f32 v8, v8, v26, v27
    v_max3_f32 v8, v8, v28, v29
    v_max3_f32 v8, v8, v30, v31
    v_mfma_f32_32x32x16_bf16 v[16:31], v[124:127], v[4:7], 0
    s_nop 11
    v_max3_f32 v8, v8, v16, v17
    v_max3_f32 v8, v8, v18, v19
    v_max3_f32 v8, v8, v20, v21
    v_max3_f32 v8, v8, v22, v23
    v_max3_f32 v8, v8, v24, v25
    v_max3_f32 v8, v8, v26, v27
    v_max3_f32 v8, v8, v28, v29
    v_max3_f32 v8, v8, v30, v31
    v_mov_b32 v9, v8
    v_and_b32 v10, 31, v0
    v_lshlrev_b32 v10, 2, v10
    v_permlane32_swap_b32 v8, v9
    v_add_u32 v11, s35, v10
    v_max_f32 v8, v8, v9
    ds_write_b32 v11, v8
    s_waitcnt lgkmcnt(0)
    s_barrier
    v_add_u32 v10, 158336, v10
    ds_read2_b32 v[12:13], v10 offset0:0 offset1:32
    ds_read2_b32 v[14:15], v10 offset0:64 offset1:96
    s_waitcnt lgkmcnt(0)
    v_max3_f32 v8, v8, v12, v13
    v_max3_f32 v8, v8, v14, v15
    v_sub_f32 v32, 0, v8
    v_sub_f32 v33, 0, v8
    v_sub_f32 v34, 0, v8
    v_sub_f32 v35, 0, v8
    v_sub_f32 v36, 0, v8
    v_sub_f32 v37, 0, v8
    v_sub_f32 v38, 0, v8
    v_sub_f32 v39, 0, v8
    v_sub_f32 v40, 0, v8
    v_sub_f32 v41, 0, v8
    v_sub_f32 v42, 0, v8
    v_sub_f32 v43, 0, v8
    v_sub_f32 v44, 0, v8
    v_sub_f32 v45, 0, v8
    v_sub_f32 v46, 0, v8
    v_sub_f32 v47, 0, v8
    s_nop 1
    v_mfma_f32_32x32x16_bf16 v[16:31], v[64:67], v[4:7], v[32:47]
    s_nop 11
    v_exp_f32 v16, v16
    v_exp_f32 v17, v17
    v_exp_f32 v18, v18
    v_exp_f32 v19, v19
    v_exp_f32 v20, v20
    v_exp_f32 v21, v21
    v_exp_f32 v22, v22
    v_exp_f32 v23, v23
    v_exp_f32 v24, v24
    v_exp_f32 v25, v25
    v_exp_f32 v26, v26
    v_exp_f32 v27, v27
    v_exp_f32 v28, v28
    v_exp_f32 v29, v29
    v_exp_f32 v30, v30
    v_exp_f32 v31, v31
    s_nop 0
    v_cvt_pk_bf16_f32 v8, v16, v17
    v_cvt_pk_bf16_f32 v9, v18, v19
    v_cvt_pk_bf16_f32 v10, v20, v21
    v_cvt_pk_bf16_f32 v11, v22, v23
    v_cvt_pk_bf16_f32 v12, v24, v25
    v_cvt_pk_bf16_f32 v13, v26, v27
    v_cvt_pk_bf16_f32 v14, v28, v29
    v_cvt_pk_bf16_f32 v15, v30, v31
    s_nop 1
    v_mfma_f32_32x32x16_bf16 v[48:63], v[128:131], v[8:11], 0
    v_mfma_f32_32x32x16_bf16 v[48:63], v[132:135], v[12:15], v[48:63]
    v_mfma_f32_32x32x16_bf16 v[16:31], v[68:71], v[4:7], v[32:47]
    s_nop 11
    v_exp_f32 v16, v16
    v_exp_f32 v17, v17
    v_exp_f32 v18, v18
    v_exp_f32 v19, v19
    v_exp_f32 v20, v20
    v_exp_f32 v21, v21
    v_exp_f32 v22, v22
    v_exp_f32 v23, v23
    v_exp_f32 v24, v24
    v_exp_f32 v25, v25
    v_exp_f32 v26, v26
    v_exp_f32 v27, v27
    v_exp_f32 v28, v28
    v_exp_f32 v29, v29
    v_exp_f32 v30, v30
    v_exp_f32 v31, v31
    s_nop 0
    v_cvt_pk_bf16_f32 v8, v16, v17
    v_cvt_pk_bf16_f32 v9, v18, v19
    v_cvt_pk_bf16_f32 v10, v20, v21
    v_cvt_pk_bf16_f32 v11, v22, v23
    v_cvt_pk_bf16_f32 v12, v24, v25
    v_cvt_pk_bf16_f32 v13, v26, v27
    v_cvt_pk_bf16_f32 v14, v28, v29
    v_cvt_pk_bf16_f32 v15, v30, v31
    s_nop 1
    v_mfma_f32_32x32x16_bf16 v[48:63], v[136:139], v[8:11], v[48:63]
    v_mfma_f32_32x32x16_bf16 v[48:63], v[140:143], v[12:15], v[48:63]
    v_mfma_f32_32x32x16_bf16 v[16:31], v[72:75], v[4:7], v[32:47]
    s_nop 11
    v_exp_f32 v16, v16
    v_exp_f32 v17, v17
    v_exp_f32 v18, v18
    v_exp_f32 v19, v19
    v_exp_f32 v20, v20
    v_exp_f32 v21, v21
    v_exp_f32 v22, v22
    v_exp_f32 v23, v23
    v_exp_f32 v24, v24
    v_exp_f32 v25, v25
    v_exp_f32 v26, v26
    v_exp_f32 v27, v27
    v_exp_f32 v28, v28
    v_exp_f32 v29, v29
    v_exp_f32 v30, v30
    v_exp_f32 v31, v31
    s_nop 0
    v_cvt_pk_bf16_f32 v8, v16, v17
    v_cvt_pk_bf16_f32 v9, v18, v19
    v_cvt_pk_bf16_f32 v10, v20, v21
    v_cvt_pk_bf16_f32 v11, v22, v23
    v_cvt_pk_bf16_f32 v12, v24, v25
    v_cvt_pk_bf16_f32 v13, v26, v27
    v_cvt_pk_bf16_f32 v14, v28, v29
    v_cvt_pk_bf16_f32 v15, v30, v31
    s_nop 1
    v_mfma_f32_32x32x16_bf16 v[48:63], v[144:147], v[8:11], v[48:63]
    v_mfma_f32_32x32x16_bf16 v[48:63], v[148:151], v[12:15], v[48:63]
    v_mfma_f32_32x32x16_bf16 v[16:31], v[76:79], v[4:7], v[32:47]
    s_nop 11
    v_exp_f32 v16, v16
    v_exp_f32 v17, v17
    v_exp_f32 v18, v18
    v_exp_f32 v19, v19
    v_exp_f32 v20, v20
    v_exp_f32 v21, v21
    v_exp_f32 v22, v22
    v_exp_f32 v23, v23
    v_exp_f32 v24, v24
    v_exp_f32 v25, v25
    v_exp_f32 v26, v26
    v_exp_f32 v27, v27
    v_exp_f32 v28, v28
    v_exp_f32 v29, v29
    v_exp_f32 v30, v30
    v_exp_f32 v31, v31
    s_nop 0
    v_cvt_pk_bf16_f32 v8, v16, v17
    v_cvt_pk_bf16_f32 v9, v18, v19
    v_cvt_pk_bf16_f32 v10, v20, v21
    v_cvt_pk_bf16_f32 v11, v22, v23
    v_cvt_pk_bf16_f32 v12, v24, v25
    v_cvt_pk_bf16_f32 v13, v26, v27
    v_cvt_pk_bf16_f32 v14, v28, v29
    v_cvt_pk_bf16_f32 v15, v30, v31
    s_nop 1
    v_mfma_f32_32x32x16_bf16 v[48:63], v[152:155], v[8:11], v[48:63]
    v_mfma_f32_32x32x16_bf16 v[48:63], v[156:159], v[12:15], v[48:63]
    v_mfma_f32_32x32x16_bf16 v[16:31], v[80:83], v[4:7], v[32:47]
    s_nop 11
    v_exp_f32 v16, v16
    v_exp_f32 v17, v17
    v_exp_f32 v18, v18
    v_exp_f32 v19, v19
    v_exp_f32 v20, v20
    v_exp_f32 v21, v21
    v_exp_f32 v22, v22
    v_exp_f32 v23, v23
    v_exp_f32 v24, v24
    v_exp_f32 v25, v25
    v_exp_f32 v26, v26
    v_exp_f32 v27, v27
    v_exp_f32 v28, v28
    v_exp_f32 v29, v29
    v_exp_f32 v30, v30
    v_exp_f32 v31, v31
    s_nop 0
    v_cvt_pk_bf16_f32 v8, v16, v17
    v_cvt_pk_bf16_f32 v9, v18, v19
    v_cvt_pk_bf16_f32 v10, v20, v21
    v_cvt_pk_bf16_f32 v11, v22, v23
    v_cvt_pk_bf16_f32 v12, v24, v25
    v_cvt_pk_bf16_f32 v13, v26, v27
    v_cvt_pk_bf16_f32 v14, v28, v29
    v_cvt_pk_bf16_f32 v15, v30, v31
    s_nop 1
    v_mfma_f32_32x32x16_bf16 v[48:63], v[160:163], v[8:11], v[48:63]
    v_mfma_f32_32x32x16_bf16 v[48:63], v[164:167], v[12:15], v[48:63]
    v_mfma_f32_32x32x16_bf16 v[16:31], v[84:87], v[4:7], v[32:47]
    s_nop 11
    v_exp_f32 v16, v16
    v_exp_f32 v17, v17
    v_exp_f32 v18, v18
    v_exp_f32 v19, v19
    v_exp_f32 v20, v20
    v_exp_f32 v21, v21
    v_exp_f32 v22, v22
    v_exp_f32 v23, v23
    v_exp_f32 v24, v24
    v_exp_f32 v25, v25
    v_exp_f32 v26, v26
    v_exp_f32 v27, v27
    v_exp_f32 v28, v28
    v_exp_f32 v29, v29
    v_exp_f32 v30, v30
    v_exp_f32 v31, v31
    s_nop 0
    v_cvt_pk_bf16_f32 v8, v16, v17
    v_cvt_pk_bf16_f32 v9, v18, v19
    v_cvt_pk_bf16_f32 v10, v20, v21
    v_cvt_pk_bf16_f32 v11, v22, v23
    v_cvt_pk_bf16_f32 v12, v24, v25
    v_cvt_pk_bf16_f32 v13, v26, v27
    v_cvt_pk_bf16_f32 v14, v28, v29
    v_cvt_pk_bf16_f32 v15, v30, v31
    s_nop 1
    v_mfma_f32_32x32x16_bf16 v[48:63], v[168:171], v[8:11], v[48:63]
    v_mfma_f32_32x32x16_bf16 v[48:63], v[172:175], v[12:15], v[48:63]
    v_mfma_f32_32x32x16_bf16 v[16:31], v[88:91], v[4:7], v[32:47]
    s_nop 11
    v_exp_f32 v16, v16
    v_exp_f32 v17, v17
    v_exp_f32 v18, v18
    v_exp_f32 v19, v19
    v_exp_f32 v20, v20
    v_exp_f32 v21, v21
    v_exp_f32 v22, v22
    v_exp_f32 v23, v23
    v_exp_f32 v24, v24
    v_exp_f32 v25, v25
    v_exp_f32 v26, v26
    v_exp_f32 v27, v27
    v_exp_f32 v28, v28
    v_exp_f32 v29, v29
    v_exp_f32 v30, v30
    v_exp_f32 v31, v31
    s_nop 0
    v_cvt_pk_bf16_f32 v8, v16, v17
    v_cvt_pk_bf16_f32 v9, v18, v19
    v_cvt_pk_bf16_f32 v10, v20, v21
    v_cvt_pk_bf16_f32 v11, v22, v23
    v_cvt_pk_bf16_f32 v12, v24, v25
    v_cvt_pk_bf16_f32 v13, v26, v27
    v_cvt_pk_bf16_f32 v14, v28, v29
    v_cvt_pk_bf16_f32 v15, v30, v31
    s_nop 1
    v_mfma_f32_32x32x16_bf16 v[48:63], v[176:179], v[8:11], v[48:63]
    v_mfma_f32_32x32x16_bf16 v[48:63], v[180:183], v[12:15], v[48:63]
    v_mfma_f32_32x32x16_bf16 v[16:31], v[92:95], v[4:7], v[32:47]
    s_nop 11
    v_exp_f32 v16, v16
    v_exp_f32 v17, v17
    v_exp_f32 v18, v18
    v_exp_f32 v19, v19
    v_exp_f32 v20, v20
    v_exp_f32 v21, v21
    v_exp_f32 v22, v22
    v_exp_f32 v23, v23
    v_exp_f32 v24, v24
    v_exp_f32 v25, v25
    v_exp_f32 v26, v26
    v_exp_f32 v27, v27
    v_exp_f32 v28, v28
    v_exp_f32 v29, v29
    v_exp_f32 v30, v30
    v_exp_f32 v31, v31
    s_nop 0
    v_cvt_pk_bf16_f32 v8, v16, v17
    v_cvt_pk_bf16_f32 v9, v18, v19
    v_cvt_pk_bf16_f32 v10, v20, v21
    v_cvt_pk_bf16_f32 v11, v22, v23
    v_cvt_pk_bf16_f32 v12, v24, v25
    v_cvt_pk_bf16_f32 v13, v26, v27
    v_cvt_pk_bf16_f32 v14, v28, v29
    v_cvt_pk_bf16_f32 v15, v30, v31
    s_nop 1
    v_mfma_f32_32x32x16_bf16 v[48:63], v[184:187], v[8:11], v[48:63]
    v_mfma_f32_32x32x16_bf16 v[48:63], v[188:191], v[12:15], v[48:63]
    v_mfma_f32_32x32x16_bf16 v[16:31], v[96:99], v[4:7], v[32:47]
    s_nop 11
    v_exp_f32 v16, v16
    v_exp_f32 v17, v17
    v_exp_f32 v18, v18
    v_exp_f32 v19, v19
    v_exp_f32 v20, v20
    v_exp_f32 v21, v21
    v_exp_f32 v22, v22
    v_exp_f32 v23, v23
    v_exp_f32 v24, v24
    v_exp_f32 v25, v25
    v_exp_f32 v26, v26
    v_exp_f32 v27, v27
    v_exp_f32 v28, v28
    v_exp_f32 v29, v29
    v_exp_f32 v30, v30
    v_exp_f32 v31, v31
    s_nop 0
    v_cvt_pk_bf16_f32 v8, v16, v17
    v_cvt_pk_bf16_f32 v9, v18, v19
    v_cvt_pk_bf16_f32 v10, v20, v21
    v_cvt_pk_bf16_f32 v11, v22, v23
    v_cvt_pk_bf16_f32 v12, v24, v25
    v_cvt_pk_bf16_f32 v13, v26, v27
    v_cvt_pk_bf16_f32 v14, v28, v29
    v_cvt_pk_bf16_f32 v15, v30, v31
    s_nop 1
    v_mfma_f32_32x32x16_bf16 v[48:63], v[192:195], v[8:11], v[48:63]
    v_mfma_f32_32x32x16_bf16 v[48:63], v[196:199], v[12:15], v[48:63]
    v_mfma_f32_32x32x16_bf16 v[16:31], v[100:103], v[4:7], v[32:47]
    s_nop 11
    v_exp_f32 v16, v16
    v_exp_f32 v17, v17
    v_exp_f32 v18, v18
    v_exp_f32 v19, v19
    v_exp_f32 v20, v20
    v_exp_f32 v21, v21
    v_exp_f32 v22, v22
    v_exp_f32 v23, v23
    v_exp_f32 v24, v24
    v_exp_f32 v25, v25
    v_exp_f32 v26, v26
    v_exp_f32 v27, v27
    v_exp_f32 v28, v28
    v_exp_f32 v29, v29
    v_exp_f32 v30, v30
    v_exp_f32 v31, v31
    s_nop 0
    v_cvt_pk_bf16_f32 v8, v16, v17
    v_cvt_pk_bf16_f32 v9, v18, v19
    v_cvt_pk_bf16_f32 v10, v20, v21
    v_cvt_pk_bf16_f32 v11, v22, v23
    v_cvt_pk_bf16_f32 v12, v24, v25
    v_cvt_pk_bf16_f32 v13, v26, v27
    v_cvt_pk_bf16_f32 v14, v28, v29
    v_cvt_pk_bf16_f32 v15, v30, v31
    s_nop 1
    v_mfma_f32_32x32x16_bf16 v[48:63], v[200:203], v[8:11], v[48:63]
    v_mfma_f32_32x32x16_bf16 v[48:63], v[204:207], v[12:15], v[48:63]
    v_mfma_f32_32x32x16_bf16 v[16:31], v[104:107], v[4:7], v[32:47]
    s_nop 11
    v_exp_f32 v16, v16
    v_exp_f32 v17, v17
    v_exp_f32 v18, v18
    v_exp_f32 v19, v19
    v_exp_f32 v20, v20
    v_exp_f32 v21, v21
    v_exp_f32 v22, v22
    v_exp_f32 v23, v23
    v_exp_f32 v24, v24
    v_exp_f32 v25, v25
    v_exp_f32 v26, v26
    v_exp_f32 v27, v27
    v_exp_f32 v28, v28
    v_exp_f32 v29, v29
    v_exp_f32 v30, v30
    v_exp_f32 v31, v31
    s_nop 0
    v_cvt_pk_bf16_f32 v8, v16, v17
    v_cvt_pk_bf16_f32 v9, v18, v19
    v_cvt_pk_bf16_f32 v10, v20, v21
    v_cvt_pk_bf16_f32 v11, v22, v23
    v_cvt_pk_bf16_f32 v12, v24, v25
    v_cvt_pk_bf16_f32 v13, v26, v27
    v_cvt_pk_bf16_f32 v14, v28, v29
    v_cvt_pk_bf16_f32 v15, v30, v31
    s_nop 1
    v_mfma_f32_32x32x16_bf16 v[48:63], v[208:211], v[8:11], v[48:63]
    v_mfma_f32_32x32x16_bf16 v[48:63], v[212:215], v[12:15], v[48:63]
    v_mfma_f32_32x32x16_bf16 v[16:31], v[108:111], v[4:7], v[32:47]
    s_nop 11
    v_exp_f32 v16, v16
    v_exp_f32 v17, v17
    v_exp_f32 v18, v18
    v_exp_f32 v19, v19
    v_exp_f32 v20, v20
    v_exp_f32 v21, v21
    v_exp_f32 v22, v22
    v_exp_f32 v23, v23
    v_exp_f32 v24, v24
    v_exp_f32 v25, v25
    v_exp_f32 v26, v26
    v_exp_f32 v27, v27
    v_exp_f32 v28, v28
    v_exp_f32 v29, v29
    v_exp_f32 v30, v30
    v_exp_f32 v31, v31
    s_nop 0
    v_cvt_pk_bf16_f32 v8, v16, v17
    v_cvt_pk_bf16_f32 v9, v18, v19
    v_cvt_pk_bf16_f32 v10, v20, v21
    v_cvt_pk_bf16_f32 v11, v22, v23
    v_cvt_pk_bf16_f32 v12, v24, v25
    v_cvt_pk_bf16_f32 v13, v26, v27
    v_cvt_pk_bf16_f32 v14, v28, v29
    v_cvt_pk_bf16_f32 v15, v30, v31
    s_nop 1
    v_mfma_f32_32x32x16_bf16 v[48:63], v[216:219], v[8:11], v[48:63]
    v_mfma_f32_32x32x16_bf16 v[48:63], v[220:223], v[12:15], v[48:63]
    v_mfma_f32_32x32x16_bf16 v[16:31], v[112:115], v[4:7], v[32:47]
    s_nop 11
    v_exp_f32 v16, v16
    v_exp_f32 v17, v17
    v_exp_f32 v18, v18
    v_exp_f32 v19, v19
    v_exp_f32 v20, v20
    v_exp_f32 v21, v21
    v_exp_f32 v22, v22
    v_exp_f32 v23, v23
    v_exp_f32 v24, v24
    v_exp_f32 v25, v25
    v_exp_f32 v26, v26
    v_exp_f32 v27, v27
    v_exp_f32 v28, v28
    v_exp_f32 v29, v29
    v_exp_f32 v30, v30
    v_exp_f32 v31, v31
    s_nop 0
    v_cvt_pk_bf16_f32 v8, v16, v17
    v_cvt_pk_bf16_f32 v9, v18, v19
    v_cvt_pk_bf16_f32 v10, v20, v21
    v_cvt_pk_bf16_f32 v11, v22, v23
    v_cvt_pk_bf16_f32 v12, v24, v25
    v_cvt_pk_bf16_f32 v13, v26, v27
    v_cvt_pk_bf16_f32 v14, v28, v29
    v_cvt_pk_bf16_f32 v15, v30, v31
    s_nop 1
    v_mfma_f32_32x32x16_bf16 v[48:63], v[224:227], v[8:11], v[48:63]
    v_mfma_f32_32x32x16_bf16 v[48:63], v[228:231], v[12:15], v[48:63]
    v_mfma_f32_32x32x16_bf16 v[16:31], v[116:119], v[4:7], v[32:47]
    s_nop 11
    v_exp_f32 v16, v16
    v_exp_f32 v17, v17
    v_exp_f32 v18, v18
    v_exp_f32 v19, v19
    v_exp_f32 v20, v20
    v_exp_f32 v21, v21
    v_exp_f32 v22, v22
    v_exp_f32 v23, v23
    v_exp_f32 v24, v24
    v_exp_f32 v25, v25
    v_exp_f32 v26, v26
    v_exp_f32 v27, v27
    v_exp_f32 v28, v28
    v_exp_f32 v29, v29
    v_exp_f32 v30, v30
    v_exp_f32 v31, v31
    s_nop 0
    v_cvt_pk_bf16_f32 v8, v16, v17
    v_cvt_pk_bf16_f32 v9, v18, v19
    v_cvt_pk_bf16_f32 v10, v20, v21
    v_cvt_pk_bf16_f32 v11, v22, v23
    v_cvt_pk_bf16_f32 v12, v24, v25
    v_cvt_pk_bf16_f32 v13, v26, v27
    v_cvt_pk_bf16_f32 v14, v28, v29
    v_cvt_pk_bf16_f32 v15, v30, v31
    s_nop 1
    v_mfma_f32_32x32x16_bf16 v[48:63], v[232:235], v[8:11], v[48:63]
    v_mfma_f32_32x32x16_bf16 v[48:63], v[236:239], v[12:15], v[48:63]
    v_mfma_f32_32x32x16_bf16 v[16:31], v[120:123], v[4:7], v[32:47]
    s_nop 11
    v_exp_f32 v16, v16
    v_exp_f32 v17, v17
    v_exp_f32 v18, v18
    v_exp_f32 v19, v19
    v_exp_f32 v20, v20
    v_exp_f32 v21, v21
    v_exp_f32 v22, v22
    v_exp_f32 v23, v23
    v_exp_f32 v24, v24
    v_exp_f32 v25, v25
    v_exp_f32 v26, v26
    v_exp_f32 v27, v27
    v_exp_f32 v28, v28
    v_exp_f32 v29, v29
    v_exp_f32 v30, v30
    v_exp_f32 v31, v31
    s_nop 0
    v_cvt_pk_bf16_f32 v8, v16, v17
    v_cvt_pk_bf16_f32 v9, v18, v19
    v_cvt_pk_bf16_f32 v10, v20, v21
    v_cvt_pk_bf16_f32 v11, v22, v23
    v_cvt_pk_bf16_f32 v12, v24, v25
    v_cvt_pk_bf16_f32 v13, v26, v27
    v_cvt_pk_bf16_f32 v14, v28, v29
    v_cvt_pk_bf16_f32 v15, v30, v31
    s_nop 1
    v_mfma_f32_32x32x16_bf16 v[48:63], v[240:243], v[8:11], v[48:63]
    v_mfma_f32_32x32x16_bf16 v[48:63], v[244:247], v[12:15], v[48:63]
    v_mfma_f32_32x32x16_bf16 v[16:31], v[124:127], v[4:7], v[32:47]
    s_nop 11
    v_exp_f32 v16, v16
    v_exp_f32 v17, v17
    v_exp_f32 v18, v18
    v_exp_f32 v19, v19
    v_exp_f32 v20, v20
    v_exp_f32 v21, v21
    v_exp_f32 v22, v22
    v_exp_f32 v23, v23
    v_exp_f32 v24, v24
    v_exp_f32 v25, v25
    v_exp_f32 v26, v26
    v_exp_f32 v27, v27
    v_exp_f32 v28, v28
    v_exp_f32 v29, v29
    v_exp_f32 v30, v30
    v_exp_f32 v31, v31
    s_nop 0
    v_cvt_pk_bf16_f32 v8, v16, v17
    v_cvt_pk_bf16_f32 v9, v18, v19
    v_cvt_pk_bf16_f32 v10, v20, v21
    v_cvt_pk_bf16_f32 v11, v22, v23
    v_cvt_pk_bf16_f32 v12, v24, v25
    v_cvt_pk_bf16_f32 v13, v26, v27
    v_cvt_pk_bf16_f32 v14, v28, v29
    v_cvt_pk_bf16_f32 v15, v30, v31
    s_nop 1
    v_mfma_f32_32x32x16_bf16 v[48:63], v[248:251], v[8:11], v[48:63]
    v_mfma_f32_32x32x16_bf16 v[48:63], v[252:255], v[12:15], v[48:63]
    s_nop 11
    ds_write_b128 v1, v[48:51] offset:0
    ds_write_b128 v1, v[52:55] offset:1024
    ds_write_b32 v3, v56 offset:0
    s_waitcnt lgkmcnt(0)
    s_barrier
    s_barrier
    s_add_u32 s61, s61, 0x400
    s_cmp_lt_u32 s61, 0x2000
    s_cbranch_scc1 M_CSLOOP
    s_branch M_CFIN
M_H:
    s_mov_b32 s28, s12
    s_and_b32 s29, s13, 0xffff
    s_mov_b32 s35, 0x254000
    s_load_dword s99, s[12:13], s35
    v_mov_b32 v116, 0x3f803f80
    v_mov_b32 v117, 0x3f803f80
    v_mov_b32 v118, 0x3f803f80
    v_mov_b32 v119, 0x3f803f80
    v_and_b32 v6, 15, v0
    s_lshl_b32 s35, s37, 4
    v_add_u32 v6, s35, v6
    v_bfe_u32 v5, v0, 1, 3
    v_xor_b32 v5, v4, v5
    v_lshlrev_b32 v5, 4, v5
    v_lshl_add_u32 v120, v6, 7, v5
    v_xor_b32 v121, 64, v120
    v_lshlrev_b32 v123, 3, v6
    v_add_u32 v123, 147456, v123
    v_lshlrev_b32 v124, 2, v6
    v_add_u32 v124, 147968, v124
    v_bfe_u32 v5, v0, 2, 2
    v_lshl_add_u32 v6, v4, 3, v5
    v_and_b32 v5, 2, v5
    v_xor_b32 v5, s37, v5
    v_lshlrev_b32 v5, 5, v5
    v_lshl_add_u32 v5, v6, 7, v5
    v_and_b32 v6, 3, v0
    v_lshl_add_u32 v5, v6, 3, v5
    v_add_u32 v122, 0x10000, v5
    s_lshl_b32 s35, s97, 3
    v_add_u32 v6, s35, v3
    v_bfe_u32 v5, v6, 1, 3
    v_lshrrev_b32 v68, 5, v0
    v_xor_b32 v5, v5, v68
    v_lshlrev_b32 v5, 4, v5
    v_lshl_add_u32 v5, v6, 7, v5
    v_bfe_u32 v6, v0, 4, 1
    v_lshl_add_u32 v5, v6, 3, v5
    s_lshl_b32 s35, s37, 1
    s_sub_u32 s35, s35, s98
    s_and_b32 s35, s35, 7
    s_lshl_b32 s35, s35, 13
    v_add_u32 v68, s35, v5
    v_xor_b32 v69, 32, v68
    v_xor_b32 v70, 64, v68
    v_xor_b32 v71, 96, v68
    v_bfe_u32 v5, v0, 2, 2
    v_cmp_eq_u32 s[4:5], v4, v5
    v_and_b32 v5, 3, v0
    v_cmp_eq_u32 s[6:7], 1, v5
    v_cmp_eq_u32 s[8:9], 2, v5
    v_cmp_eq_u32 s[10:11], 3, v5
    v_and_b32 v11, 31, v0
    v_lshlrev_b32 v11, 2, v11
    v_lshlrev_b32 v125, 4, v0
    s_barrier
    s_lshl_b32 s56, s14, 7
    s_mov_b32 m0, s44
    s_add_u32 s56, s56, s40
    buffer_load_dwordx4 v64, s[48:51], s56 offen lds
    s_add_u32 m0, s44, s59
    s_add_u32 s14, s14, 1
    buffer_load_dwordx4 v65, s[48:51], s56 offen lds
    s_and_b32 s14, s14, 7
    s_add_u32 s44, s44, s46
    s_waitcnt lgkmcnt(0)
    s_mul_i32 s99, s99, 0x9e3779b1
    s_add_u32 s99, s99, 0x7f4a7c15
    s_setprio 1
    s_lshl_b32 s56, s14, 7
    s_mov_b32 m0, s44
    s_add_u32 s56, s56, s40
    buffer_load_dwordx4 v64, s[48:51], s56 offen lds
    s_add_u32 m0, s44, s59
    s_add_u32 s14, s14, 1
    buffer_load_dwordx4 v65, s[48:51], s56 offen lds
    s_and_b32 s14, s14, 7
    s_add_u32 s44, s44, s46
    s_lshl_b32 s57, s42, 16
    s_add_u32 m0, s58, 81920
    s_add_u32 s57, s57, s41
    buffer_load_dwordx4 v66, s[52:55], s57 offen lds
    s_add_u32 m0, s58, 82944
    s_add_u32 s42, s42, 1
    buffer_load_dwordx4 v67, s[52:55], s57 offen lds
    s_and_b32 s42, s42, 7
    s_lshl_b32 s56, s14, 7
    s_mov_b32 m0, s44
    s_add_u32 s56, s56, s40
    buffer_load_dwordx4 v64, s[48:51], s56 offen lds
    s_add_u32 m0, s44, s59
    s_add_u32 s14, s14, 1
    buffer_load_dwordx4 v65, s[48:51], s56 offen lds
    s_and_b32 s14, s14, 7
    s_add_u32 s44, s44, s46
    s_waitcnt vmcnt(6)
    s_barrier
    ds_read_b128 v[72:75], v120 offset:0
    ds_read_b64_tr_b16 v[88:89], v122 offset:0
    ds_read_b64_tr_b16 v[90:91], v122 offset:512
    s_lshl_b32 s57, s42, 16
    s_add_u32 m0, s58, 90112
    s_add_u32 s57, s57, s41
    buffer_load_dwordx4 v66, s[52:55], s57 offen lds
    s_add_u32 m0, s58, 91136
    s_add_u32 s42, s42, 1
    buffer_load_dwordx4 v67, s[52:55], s57 offen lds
    s_and_b32 s42, s42, 7
    s_lshl_b32 s56, s14, 7
    s_mov_b32 m0, s44
    s_add_u32 s56, s56, s40
    buffer_load_dwordx4 v64, s[48:51], s56 offen lds
    s_add_u32 m0, s44, s59
    s_add_u32 s14, s14, 1
    buffer_load_dwordx4 v65, s[48:51], s56 offen lds
    s_and_b32 s14, s14, 7
    s_add_u32 s44, s44, s46
    ds_read_b128 v[76:79], v121 offset:0
    ds_read_b64_tr_b16 v[92:93], v122 offset:4096
    ds_read_b64_tr_b16 v[94:95], v122 offset:4608
    s_waitcnt vmcnt(8)
    s_barrier
    ds_read_b128 v[80:83], v120 offset:8192
    ds_read_b64_tr_b16 v[96:97], v122 offset:8192
    ds_read_b64_tr_b16 v[98:99], v122 offset:8704
    s_lshl_b32 s57, s42, 16
    s_add_u32 m0, s58, 98304
    s_add_u32 s57, s57, s41
    buffer_load_dwordx4 v66, s[52:55], s57 offen lds
    s_add_u32 m0, s58, 99328
    s_add_u32 s42, s42, 1
    buffer_load_dwordx4 v67, s[52:55], s57 offen lds
    s_and_b32 s42, s42, 7
    s_lshl_b32 s56, s14, 7
    s_mov_b32 m0, s44
    s_add_u32 s56, s56, s40
    buffer_load_dwordx4 v64, s[48:51], s56 offen lds
    s_add_u32 m0, s44, s59
    s_add_u32 s14, s14, 1
    buffer_load_dwordx4 v65, s[48:51], s56 offen lds
    s_and_b32 s14, s14, 7
    s_add_u32 s44, s44, s46
    s_waitcnt lgkmcnt(6)
    v_mfma_f32_16x16x32_bf16 v[108:111], v[72:75], v[72:75], 0
    v_mfma_f32_16x16x32_bf16 v[104:107], v[116:119], v[72:75], 0
    v_mfma_f32_16x16x32_bf16 v[112:115], v[116:119], v[88:91], 0
    ds_read_b128 v[84:87], v121 offset:8192
    ds_read_b64_tr_b16 v[100:101], v122 offset:12288
    ds_read_b64_tr_b16 v[102:103], v122 offset:12800
    s_waitcnt lgkmcnt(6)
    v_mfma_f32_16x16x32_bf16 v[108:111], v[76:79], v[76:79], v[108:111]
    v_mfma_f32_16x16x32_bf16 v[104:107], v[116:119], v[76:79], v[104:107]
    v_mfma_f32_16x16x32_bf16 v[112:115], v[116:119], v[92:95], v[112:115]
    s_waitcnt vmcnt(8)
    s_barrier
    ds_read_b128 v[72:75], v120 offset:16384
    ds_read_b64_tr_b16 v[88:89], v122 offset:16384
    ds_read_b64_tr_b16 v[90:91], v122 offset:16896
    s_lshl_b32 s57, s42, 16
    s_add_u32 m0, s58, 106496
    s_add_u32 s57, s57, s41
    buffer_load_dwordx4 v66, s[52:55], s57 offen lds
    s_add_u32 m0, s58, 107520
    s_add_u32 s42, s42, 1
    buffer_load_dwordx4 v67, s[52:55], s57 offen lds
    s_and_b32 s42, s42, 7
    s_lshl_b32 s56, s14, 7
    s_mov_b32 m0, s44
    s_add_u32 s56, s56, s40
    buffer_load_dwordx4 v64, s[48:51], s56 offen lds
    s_add_u32 m0, s44, s59
    s_add_u32 s14, s14, 1
    buffer_load_dwordx4 v65, s[48:51], s56 offen lds
    s_and_b32 s14, s14, 7
    s_add_u32 s44, s44, s46
    s_waitcnt lgkmcnt(6)
    v_mfma_f32_16x16x32_bf16 v[108:111], v[80:83], v[80:83], v[108:111]
    v_mfma_f32_16x16x32_bf16 v[104:107], v[116:119], v[80:83], v[104:107]
    v_mfma_f32_16x16x32_bf16 v[112:115], v[116:119], v[96:99], v[112:115]
    ds_read_b128 v[76:79], v121 offset:16384
    ds_read_b64_tr_b16 v[92:93], v122 offset:20480
    ds_read_b64_tr_b16 v[94:95], v122 offset:20992
    s_waitcnt lgkmcnt(6)
    v_mfma_f32_16x16x32_bf16 v[108:111], v[84:87], v[84:87], v[108:111]
    v_mfma_f32_16x16x32_bf16 v[104:107], v[116:119], v[84:87], v[104:107]
    v_mfma_f32_16x16x32_bf16 v[112:115], v[116:119], v[100:103], v[112:115]
    s_waitcnt vmcnt(8)
    s_barrier
    ds_read_b128 v[80:83], v120 offset:24576
    ds_read_b64_tr_b16 v[96:97], v122 offset:24576
    ds_read_b64_tr_b16 v[98:99], v122 offset:25088
    s_lshl_b32 s57, s42, 16
    s_add_u32 m0, s58, 114688
    s_add_u32 s57, s57, s41
    buffer_load_dwordx4 v66, s[52:55], s57 offen lds
    s_add_u32 m0, s58, 115712
    s_add_u32 s42, s42, 1
    buffer_load_dwordx4 v67, s[52:55], s57 offen lds
    s_and_b32 s42, s42, 7
    s_lshl_b32 s56, s14, 7
    s_mov_b32 m0, s44
    s_add_u32 s56, s56, s40
    buffer_load_dwordx4 v64, s[48:51], s56 offen lds
    s_add_u32 m0, s44, s59
    s_add_u32 s14, s14, 1
    buffer_load_dwordx4 v65, s[48:51], s56 offen lds
    s_and_b32 s14, s14, 7
    s_add_u32 s44, s44, s46
    s_waitcnt lgkmcnt(6)
    v_mfma_f32_16x16x32_bf16 v[108:111], v[72:75], v[72:75], v[108:111]
    v_mfma_f32_16x16x32_bf16 v[104:107], v[116:119], v[72:75], v[104:107]
    v_mfma_f32_16x16x32_bf16 v[112:115], v[116:119], v[88:91], v[112:115]
    ds_read_b128 v[84:87], v121 offset:24576
    ds_read_b64_tr_b16 v[100:101], v122 offset:28672
    ds_read_b64_tr_b16 v[102:103], v122 offset:29184
    s_waitcnt lgkmcnt(6)
    v_mfma_f32_16x16x32_bf16 v[108:111], v[76:79], v[76:79], v[108:111]
    v_mfma_f32_16x16x32_bf16 v[104:107], v[116:119], v[76:79], v[104:107]
    v_mfma_f32_16x16x32_bf16 v[112:115], v[116:119], v[92:95], v[112:115]
    s_waitcnt vmcnt(8)
    s_barrier
    ds_read_b128 v[72:75], v120 offset:32768
    ds_read_b64_tr_b16 v[88:89], v122 offset:32768
    ds_read_b64_tr_b16 v[90:91], v122 offset:33280
    s_lshl_b32 s57, s42, 16
    s_add_u32 m0, s58, 122880
    s_add_u32 s57, s57, s41
    buffer_load_dwordx4 v66, s[52:55], s57 offen lds
    s_add_u32 m0, s58, 123904
    s_add_u32 s42, s42, 1
    buffer_load_dwordx4 v67, s[52:55], s57 offen lds
    s_and_b32 s42, s42, 7
    s_lshl_b32 s56, s14, 7
    s_mov_b32 m0, s44
    s_add_u32 s56, s56, s40
    buffer_load_dwordx4 v64, s[48:51], s56 offen lds
    s_add_u32 m0, s44, s59
    s_add_u32 s14, s14, 1
    buffer_load_dwordx4 v65, s[48:51], s56 offen lds
    s_and_b32 s14, s14, 7
    s_add_u32 s44, s44, s46
    s_waitcnt lgkmcnt(6)
    v_mfma_f32_16x16x32_bf16 v[108:111], v[80:83], v[80:83], v[108:111]
    v_mfma_f32_16x16x32_bf16 v[104:107], v[116:119], v[80:83], v[104:107]
    v_mfma_f32_16x16x32_bf16 v[112:115], v[116:119], v[96:99], v[112:115]
    ds_read_b128 v[76:79], v121 offset:32768
    ds_read_b64_tr_b16 v[92:93], v122 offset:36864
    ds_read_b64_tr_b16 v[94:95], v122 offset:37376
    s_waitcnt lgkmcnt(6)
    v_mfma_f32_16x16x32_bf16 v[108:111], v[84:87], v[84:87], v[108:111]
    v_mfma_f32_16x16x32_bf16 v[104:107], v[116:119], v[84:87], v[104:107]
    v_mfma_f32_16x16x32_bf16 v[112:115], v[116:119], v[100:103], v[112:115]
    s_waitcnt vmcnt(8)
    s_barrier
    ds_read_b128 v[80:83], v120 offset:40960
    ds_read_b64_tr_b16 v[96:97], v122 offset:40960
    ds_read_b64_tr_b16 v[98:99], v122 offset:41472
    s_waitcnt lgkmcnt(6)
    v_mfma_f32_16x16x32_bf16 v[108:111], v[72:75], v[72:75], v[108:111]
    v_mfma_f32_16x16x32_bf16 v[104:107], v[116:119], v[72:75], v[104:107]
    v_mfma_f32_16x16x32_bf16 v[112:115], v[116:119], v[88:91], v[112:115]
    ds_read_b128 v[84:87], v121 offset:40960
    ds_read_b64_tr_b16 v[100:101], v122 offset:45056
    ds_read_b64_tr_b16 v[102:103], v122 offset:45568
    s_waitcnt lgkmcnt(6)
    v_mfma_f32_16x16x32_bf16 v[108:111], v[76:79], v[76:79], v[108:111]
    v_mfma_f32_16x16x32_bf16 v[104:107], v[116:119], v[76:79], v[104:107]
    v_mfma_f32_16x16x32_bf16 v[112:115], v[116:119], v[92:95], v[112:115]
    s_waitcnt vmcnt(4)
    s_barrier
    ds_read_b128 v[72:75], v120 offset:49152
    ds_read_b64_tr_b16 v[88:89], v122 offset:49152
    ds_read_b64_tr_b16 v[90:91], v122 offset:49664
    s_lshl_b32 s35, s43, 7
    s_add_u32 s35, s35, 0x250000
    buffer_load_dword v10, v11, s[28:31], s35 offen sc1
    s_waitcnt lgkmcnt(6)
    v_mfma_f32_16x16x32_bf16 v[108:111], v[80:83], v[80:83], v[108:111]
    v_mfma_f32_16x16x32_bf16 v[104:107], v[116:119], v[80:83], v[104:107]
    v_mfma_f32_16x16x32_bf16 v[112:115], v[116:119], v[96:99], v[112:115]
    ds_read_b128 v[76:79], v121 offset:49152
    ds_read_b64_tr_b16 v[92:93], v122 offset:53248
    ds_read_b64_tr_b16 v[94:95], v122 offset:53760
    s_waitcnt lgkmcnt(6)
    v_mfma_f32_16x16x32_bf16 v[108:111], v[84:87], v[84:87], v[108:111]
    v_mfma_f32_16x16x32_bf16 v[104:107], v[116:119], v[84:87], v[104:107]
    v_mfma_f32_16x16x32_bf16 v[112:115], v[116:119], v[100:103], v[112:115]
    s_waitcnt vmcnt(1)
    s_barrier
    ds_read_b128 v[80:83], v120 offset:57344
    ds_read_b64_tr_b16 v[96:97], v122 offset:57344
    ds_read_b64_tr_b16 v[98:99], v122 offset:57856
    s_waitcnt lgkmcnt(6)
    v_mfma_f32_16x16x32_bf16 v[108:111], v[72:75], v[72:75], v[108:111]
    v_mfma_f32_16x16x32_bf16 v[104:107], v[116:119], v[72:75], v[104:107]
    v_mfma_f32_16x16x32_bf16 v[112:115], v[116:119], v[88:91], v[112:115]
    ds_read_b128 v[84:87], v121 offset:57344
    ds_read_b64_tr_b16 v[100:101], v122 offset:61440
    ds_read_b64_tr_b16 v[102:103], v122 offset:61952
    s_waitcnt lgkmcnt(6)
    v_mfma_f32_16x16x32_bf16 v[108:111], v[76:79], v[76:79], v[108:111]
    v_mfma_f32_16x16x32_bf16 v[104:107], v[116:119], v[76:79], v[104:107]
    v_mfma_f32_16x16x32_bf16 v[112:115], v[116:119], v[92:95], v[112:115]
    s_waitcnt lgkmcnt(3)
    v_mfma_f32_16x16x32_bf16 v[108:111], v[80:83], v[80:83], v[108:111]
    v_mfma_f32_16x16x32_bf16 v[104:107], v[116:119], v[80:83], v[104:107]
    v_mfma_f32_16x16x32_bf16 v[112:115], v[116:119], v[96:99], v[112:115]
    s_waitcnt lgkmcnt(0)
    v_mfma_f32_16x16x32_bf16 v[108:111], v[84:87], v[84:87], v[108:111]
    v_mfma_f32_16x16x32_bf16 v[104:107], v[116:119], v[84:87], v[104:107]
    v_mfma_f32_16x16x32_bf16 v[112:115], v[116:119], v[100:103], v[112:115]
    ds_read_b64 v[40:41], v68 offset:0
    ds_read_b64 v[42:43], v69 offset:0
    ds_read_b64 v[44:45], v70 offset:0
    ds_read_b64 v[46:47], v71 offset:0
    ds_read_b64 v[48:49], v68 offset:8192
    ds_read_b64 v[50:51], v69 offset:8192
    ds_read_b64 v[52:53], v70 offset:8192
    ds_read_b64 v[54:55], v71 offset:8192
    v_cndmask_b32 v108, v108, v109, s[6:7]
    v_cndmask_b32 v108, v108, v110, s[8:9]
    v_cndmask_b32 v105, v108, v111, s[10:11]
    s_mov_b64 exec, s[4:5]
    ds_write_b64 v123, v[104:105]
    ds_write_b32 v124, v112
    s_mov_b64 exec, -1
    s_waitcnt lgkmcnt(0)
    s_barrier
    s_load_dwordx4 s[8:11], s[0:1], 48
    s_load_dwordx4 s[24:27], s[0:1], 64
    v_mov_b32 v16, 0
    v_lshlrev_b32 v64, 16, v40
    v_and_b32 v65, 0xffff0000, v40
    v_lshlrev_b32 v66, 16, v41
    v_and_b32 v67, 0xffff0000, v41
    v_lshlrev_b32 v68, 16, v42
    v_and_b32 v69, 0xffff0000, v42
    v_lshlrev_b32 v70, 16, v43
    v_and_b32 v71, 0xffff0000, v43
    v_lshlrev_b32 v72, 16, v44
    v_and_b32 v73, 0xffff0000, v44
    v_lshlrev_b32 v74, 16, v45
    v_and_b32 v75, 0xffff0000, v45
    v_lshlrev_b32 v76, 16, v46
    v_and_b32 v77, 0xffff0000, v46
    v_lshlrev_b32 v78, 16, v47
    v_and_b32 v79, 0xffff0000, v47
    v_lshlrev_b32 v80, 16, v48
    v_and_b32 v81, 0xffff0000, v48
    v_lshlrev_b32 v82, 16, v49
    v_and_b32 v83, 0xffff0000, v49
    v_lshlrev_b32 v84, 16, v50
    v_and_b32 v85, 0xffff0000, v50
    v_lshlrev_b32 v86, 16, v51
    v_and_b32 v87, 0xffff0000, v51
    v_lshlrev_b32 v88, 16, v52
    v_and_b32 v89, 0xffff0000, v52
    v_lshlrev_b32 v90, 16, v53
    v_and_b32 v91, 0xffff0000, v53
    v_lshlrev_b32 v92, 16, v54
    v_and_b32 v93, 0xffff0000, v54
    v_lshlrev_b32 v94, 16, v55
    v_and_b32 v95, 0xffff0000, v55
    s_waitcnt vmcnt(0)
    s_getreg_b32 s23, hwreg(HW_REG_XCC_ID, 0, 4)
    s_add_u32 s23, s23, s99
    v_cmp_ne_u32 vcc, s23, v10
    s_cmp_eq_u64 vcc, 0
    s_cselect_b32 s3, 1, 0
    s_waitcnt lgkmcnt(0)
    s_mov_b32 s16, s26
    s_and_b32 s17, s27, 0xffff
    s_mov_b32 s18, 0x200000
    s_mov_b32 s19, 0x00020000
    s_mov_b32 s48, s8
    s_and_b32 s49, s9, 0xffff
    s_mov_b32 s50, 0x1c0000
    s_mov_b32 s51, 0x00020000
    s_mov_b32 s52, s10
    s_and_b32 s53, s11, 0xffff
    s_mov_b32 s54, 0x1c0000
    s_mov_b32 s55, 0x00020000
    s_mov_b32 s56, s24
    s_and_b32 s57, s25, 0xffff
    s_mov_b32 s58, 0x1c0000
    s_mov_b32 s59, 0x00020000
    s_cmp_lt_u32 s34, 28
    s_cselect_b32 s50, s50, 0
    s_cselect_b32 s54, s54, 0
    s_mul_i32 s60, s37, 458752
    s_lshl_b32 s35, s34, 11
    s_add_u32 s60, s60, s35
    s_lshl_b32 s20, s37, 14
    s_add_u32 s20, s20, 0x280000
    s_mul_i32 s21, s37, 28672
    s_lshl_b32 s35, s34, 7
    s_add_u32 s21, s21, s35
    s_lshl_b32 s22, s37, 10
    s_barrier
    s_setprio 2
    s_lshl_b32 s40, s96, 7
    s_cmp_lg_u32 s37, 0
    s_cbranch_scc1 F_H0
    ds_read_b128 v[128:131], v125 offset:0
    ds_read_b128 v[132:135], v125 offset:1024
    ds_read_b128 v[136:139], v125 offset:2048
    ds_read_b128 v[140:143], v125 offset:3072
    ds_read_b128 v[144:147], v125 offset:4096
    ds_read_b128 v[148:151], v125 offset:5120
    ds_read_b128 v[152:155], v125 offset:6144
    ds_read_b128 v[156:159], v125 offset:7168
    s_lshl_b32 s41, s96, 16
    s_lshl_b32 s35, s97, 10
    s_add_u32 s41, s41, s35
    s_add_u32 s4, s41, 8192
    s_add_u32 s5, s41, 16384
    s_add_u32 s6, s41, 24576
    s_add_u32 s7, s41, 32768
    s_add_u32 s8, s41, 40960
    s_add_u32 s9, s41, 49152
    s_add_u32 s10, s41, 57344
    s_waitcnt lgkmcnt(0)
    s_cmp_eq_u32 s3, 1
    s_cbranch_scc0 M_SF1
    buffer_store_dwordx4 v[128:131], v125, s[28:31], s41 offen nt
    buffer_store_dwordx4 v[132:135], v125, s[28:31], s4 offen nt
    buffer_store_dwordx4 v[136:139], v125, s[28:31], s5 offen nt
    buffer_store_dwordx4 v[140:143], v125, s[28:31], s6 offen nt
    buffer_store_dwordx4 v[144:147], v125, s[28:31], s7 offen nt
    buffer_store_dwordx4 v[148:151], v125, s[28:31], s8 offen nt
    buffer_store_dwordx4 v[152:155], v125, s[28:31], s9 offen nt
    buffer_store_dwordx4 v[156:159], v125, s[28:31], s10 offen nt
M_SE1:
F_H0:
    v_lshlrev_b32 v6, 7, v0
    v_lshrrev_b32 v8, 4, v0
    v_mov_b32 v17, -1.0
    v_lshlrev_b32 v7, 2, v0
    s_mul_i32 s35, s37, 2304
    s_add_u32 s35, s35, 75776
    v_add_u32 v20, s35, v7
    v_add_u32 v21, 36864, v20
    v_and_b32 v22, 127, v7
    v_add_u32 v22, 157696, v22
    s_lshl_b32 s35, s37, 8
    v_lshrrev_b32 v7, 3, v0
    v_bfe_u32 v23, v0, 4, 1
    v_lshlrev_b32 v23, 1, v23
    v_and_b32 v14, 7, v0
    v_xor_b32 v14, v14, v23
    v_lshlrev_b32 v14, 4, v14
    v_mul_u32_u24 v62, 3584, v7
    v_add_u32 v62, v62, v14
    v_xor_b32 v63, 64, v62
    v_lshlrev_b32 v1, 3, v0
    s_lshl_b32 s35, s37, 9
    s_add_u32 s35, s35, 75776
    v_add_u32 v1, s35, v1
    v_add_u32 v19, 36864, v1
    v_lshrrev_b32 v23, 1, v0
    v_lshlrev_b32 v2, 2, v23
    v_add_u32 v2, 75776, v2
    v_add_u32 v56, 36864, v2
    v_and_b32 v3, 7, v23
    v_lshlrev_b32 v3, 7, v3
    v_lshrrev_b32 v23, 3, v23
    v_lshl_add_u32 v3, v23, 5, v3
    v_and_b32 v23, 1, v0
    v_lshl_add_u32 v3, v23, 2, v3
    s_lshl_b32 s35, s37, 3
    s_add_u32 s35, s35, 149504
    v_add_u32 v3, s35, v3
    v_and_b32 v4, 7, v0
    v_lshlrev_b32 v4, 7, v4
    v_lshl_add_u32 v4, v8, 4, v4
    v_add_u32 v4, 149504, v4
    v_mov_b32 v9, 157696
    s_lshl_b32 s35, s37, 2
    v_add_u32 v5, s35, v9
    v_and_b32 v23, 3, v0
    v_lshl_add_u32 v9, v23, 2, v9
    v_mul_u32_u24 v12, 2304, v23
    v_and_b32 v23, 60, v0
    v_lshl_add_u32 v12, v23, 2, v12
    v_add_u32 v12, 77836, v12
    v_add_u32 v13, 36864, v12
    v_and_b32 v11, 31, v0
    v_lshlrev_b32 v11, 2, v11
    v_mov_b32 v17, 1.0
    v_lshlrev_b32 v14, 4, v0
    v_lshrrev_b32 v57, 5, v0
    v_lshlrev_b32 v57, 9, v57
    v_and_b32 v23, 7, v0
    v_lshl_add_u32 v57, v23, 4, v57
    v_bfe_u32 v23, v0, 4, 1
    v_lshl_add_u32 v57, v23, 10, v57
    v_and_b32 v23, 8, v0
    v_lshl_add_u32 v57, v23, 9, v57
    v_cmp_ne_u32 s[62:63], 0, v23
    s_lshl_b32 s35, s37, 13
    v_add_u32 v57, s35, v57
    v_and_b32 v58, 15, v0
    v_lshlrev_b32 v58, 5, v58
    s_lshl_b32 s35, s37, 3
    s_add_u32 s35, s35, 157824
    v_add_u32 v58, s35, v58
    v_mov_b32 v26, -1.0
    v_mov_b32 v27, -1.0
    v_and_b32 v59, 7, v0
    v_lshlrev_b32 v59, 5, v59
    v_add_u32 v59, 157824, v59
    v_lshlrev_b32 v60, 3, v0
    v_add_u32 v60, 157824, v60
    s_lshr_b32 s38, s33, 2
    s_lshl_b32 s38, s38, 15
    s_and_b32 s35, s33, 3
    s_lshl_b32 s35, s35, 7
    s_add_u32 s38, s38, s35
    s_add_u32 s39, s38, 0x300000
    s_add_u32 s38, s38, 0x500000
    ds_write_b32 v20, v26 offset:2048
    ds_write_b32 v20, v26 offset:11264
    ds_write_b32 v20, v26 offset:20480
    ds_write_b32 v20, v26 offset:29696
    ds_write_b32 v21, v26 offset:2048
    ds_write_b32 v21, v26 offset:11264
    ds_write_b32 v21, v26 offset:20480
    ds_write_b32 v21, v26 offset:29696
    ds_write_b32 v22, v26
    ds_write_b64 v58, v[26:27]
    s_cmp_eq_u32 s37, 1
    s_cbranch_scc1 F_H1
    s_cmp_lg_u32 s37, 0
    s_cbranch_scc1 F_HJ
    s_lshl_b32 s35, s97, 2
    s_add_u32 s35, s35, s40
    s_add_u32 s35, s35, 0x252000
    s_waitcnt vmcnt(0)
    v_mov_b32 v126, s99
    v_mov_b32 v127, 0
    s_mov_b64 exec, 1
    s_cmp_eq_u32 s3, 1
    s_cbranch_scc0 M_SF2
    buffer_store_dword v126, v127, s[28:31], s35 offen
M_SE2:
    s_mov_b64 exec, -1
    s_branch F_HJ
F_H1:
    s_add_u32 s40, s40, 0x252000
    v_and_b32 v126, 7, v0
    v_lshlrev_b32 v126, 2, v126
    s_sleep 2
    s_mov_b32 s46, 0
M_PLQ:
    buffer_load_dword v127, v126, s[28:31], s40 offen sc1
    s_waitcnt vmcnt(0)
    v_cmp_ne_u32 vcc, s99, v127
    s_cbranch_vccz M_PGQ
    s_add_u32 s46, s46, 1
    s_sleep 2
    s_cmp_lt_u32 s46, 131072
    s_cbranch_scc1 M_PLQ
M_PGQ:
    s_add_u32 s35, s97, 1
    s_and_b32 s35, s35, 7
    s_lshl_b32 s35, s35, 10
    s_mov_b32 m0, 150528
    s_add_u32 s35, s35, s36
    buffer_load_dwordx4 v14, s[28:31], s35 offen sc1 lds
    s_add_u32 s35, s97, 2
    s_and_b32 s35, s35, 7
    s_lshl_b32 s35, s35, 10
    s_mov_b32 m0, 151552
    s_add_u32 s35, s35, s36
    buffer_load_dwordx4 v14, s[28:31], s35 offen sc1 lds
    s_add_u32 s35, s97, 3
    s_and_b32 s35, s35, 7
    s_lshl_b32 s35, s35, 10
    s_mov_b32 m0, 152576
    s_add_u32 s35, s35, s36
    buffer_load_dwordx4 v14, s[28:31], s35 offen sc1 lds
    s_add_u32 s35, s97, 4
    s_and_b32 s35, s35, 7
    s_lshl_b32 s35, s35, 10
    s_mov_b32 m0, 153600
    s_add_u32 s35, s35, s36
    buffer_load_dwordx4 v14, s[28:31], s35 offen sc1 lds
    s_add_u32 s35, s97, 5
    s_and_b32 s35, s35, 7
    s_lshl_b32 s35, s35, 10
    s_mov_b32 m0, 154624
    s_add_u32 s35, s35, s36
    buffer_load_dwordx4 v14, s[28:31], s35 offen sc1 lds
    s_add_u32 s35, s97, 6
    s_and_b32 s35, s35, 7
    s_lshl_b32 s35, s35, 10
    s_mov_b32 m0, 155648
    s_add_u32 s35, s35, s36
    buffer_load_dwordx4 v14, s[28:31], s35 offen sc1 lds
    s_add_u32 s35, s97, 7
    s_and_b32 s35, s35, 7
    s_lshl_b32 s35, s35, 10
    s_mov_b32 m0, 156672
    s_add_u32 s35, s35, s36
    buffer_load_dwordx4 v14, s[28:31], s35 offen sc1 lds
F_HJ:
    s_waitcnt vmcnt(0) lgkmcnt(0)
    s_barrier
    v_lshrrev_b32 v126, 1, v0
    v_lshlrev_b32 v126, 7, v126
    v_and_b32 v127, 1, v0
    v_lshl_add_u32 v126, v127, 4, v126
    s_mov_b32 s40, 0x253000
    s_mov_b32 s46, 0
F_PP:
    buffer_load_dwordx4 v[96:99], v126, s[28:31], s40 offen sc1
    s_waitcnt vmcnt(0)
    v_xor_b32 v96, s99, v96
    v_xor_b32 v97, s99, v97
    v_xor_b32 v98, s99, v98
    v_xor_b32 v99, s99, v99
    v_or3_b32 v96, v96, v97, v98
    v_or_b32 v96, v96, v99
    v_cmp_ne_u32 vcc, 0, v96
    s_cbranch_vccz F_PQ
    s_sleep 8
    s_add_u32 s46, s46, 1
    s_cmp_lt_u32 s46, 16384
    s_cbranch_scc1 F_PP
F_PQ:
    s_or_b32 s35, s2, s37
    s_cmp_lg_u32 s35, 0
    s_cbranch_scc1 F_HK
    s_mov_b32 s35, 0x254000
    v_mov_b32 v126, s99
    v_mov_b32 v127, 0
    s_mov_b64 exec, 1
    buffer_store_dword v126, v127, s[28:31], s35 offen sc1
    s_mov_b64 exec, -1
F_HK:
    s_setprio 0
    s_add_u32 s44, s97, 0
    s_and_b32 s44, s44, 7
    s_lshl_b32 s44, s44, 16
    s_add_u32 s44, s44, s20
    s_add_u32 s45, s44, 0
    buffer_load_dwordx4 v[160:163], v14, s[28:31], s45 offen offset:0 sc1
    buffer_load_dwordx4 v[164:167], v14, s[28:31], s45 offen offset:1024 sc1
    buffer_load_dwordx4 v[168:171], v14, s[28:31], s45 offen offset:2048 sc1
    buffer_load_dwordx4 v[172:175], v14, s[28:31], s45 offen offset:3072 sc1
    s_add_u32 s45, s44, 4096
    buffer_load_dwordx4 v[176:179], v14, s[28:31], s45 offen offset:0 sc1
    buffer_load_dwordx4 v[180:183], v14, s[28:31], s45 offen offset:1024 sc1
    buffer_load_dwordx4 v[184:187], v14, s[28:31], s45 offen offset:2048 sc1
    buffer_load_dwordx4 v[188:191], v14, s[28:31], s45 offen offset:3072 sc1
    s_add_u32 s45, s44, 8192
    buffer_load_dwordx4 v[192:195], v14, s[28:31], s45 offen offset:0 sc1
    buffer_load_dwordx4 v[196:199], v14, s[28:31], s45 offen offset:1024 sc1
    buffer_load_dwordx4 v[200:203], v14, s[28:31], s45 offen offset:2048 sc1
    buffer_load_dwordx4 v[204:207], v14, s[28:31], s45 offen offset:3072 sc1
    s_add_u32 s45, s44, 12288
    buffer_load_dwordx4 v[208:211], v14, s[28:31], s45 offen offset:0 sc1
    buffer_load_dwordx4 v[212:215], v14, s[28:31], s45 offen offset:1024 sc1
    buffer_load_dwordx4 v[216:219], v14, s[28:31], s45 offen offset:2048 sc1
    buffer_load_dwordx4 v[220:223], v14, s[28:31], s45 offen offset:3072 sc1
    s_add_u32 s44, s97, 1
    s_and_b32 s44, s44, 7
    s_lshl_b32 s44, s44, 16
    s_add_u32 s44, s44, s20
    s_add_u32 s45, s44, 0
    buffer_load_dwordx4 v[96:99], v14, s[28:31], s45 offen offset:0 sc1
    buffer_load_dwordx4 v[100:103], v14, s[28:31], s45 offen offset:1024 sc1
    buffer_load_dwordx4 v[104:107], v14, s[28:31], s45 offen offset:2048 sc1
    buffer_load_dwordx4 v[108:111], v14, s[28:31], s45 offen offset:3072 sc1
    s_add_u32 s45, s44, 4096
    buffer_load_dwordx4 v[112:115], v14, s[28:31], s45 offen offset:0 sc1
    buffer_load_dwordx4 v[116:119], v14, s[28:31], s45 offen offset:1024 sc1
    buffer_load_dwordx4 v[120:123], v14, s[28:31], s45 offen offset:2048 sc1
    buffer_load_dwordx4 v[124:127], v14, s[28:31], s45 offen offset:3072 sc1
    s_add_u32 s45, s44, 8192
    buffer_load_dwordx4 v[128:131], v14, s[28:31], s45 offen offset:0 sc1
    buffer_load_dwordx4 v[132:135], v14, s[28:31], s45 offen offset:1024 sc1
    buffer_load_dwordx4 v[136:139], v14, s[28:31], s45 offen offset:2048 sc1
    buffer_load_dwordx4 v[140:143], v14, s[28:31], s45 offen offset:3072 sc1
    s_add_u32 s45, s44, 12288
    buffer_load_dwordx4 v[144:147], v14, s[28:31], s45 offen offset:0 sc1
    buffer_load_dwordx4 v[148:151], v14, s[28:31], s45 offen offset:1024 sc1
    buffer_load_dwordx4 v[152:155], v14, s[28:31], s45 offen offset:2048 sc1
    buffer_load_dwordx4 v[156:159], v14, s[28:31], s45 offen offset:3072 sc1
    s_add_u32 m0, s22, 0
    s_add_u32 s45, s21, 0
    buffer_load_dwordx4 v62, s[48:51], s45 offen lds
    s_add_u32 m0, s22, 4096
    s_add_u32 s45, s21, 114688
    buffer_load_dwordx4 v62, s[48:51], s45 offen lds
    s_add_u32 m0, s22, 8192
    s_add_u32 s45, s21, 229376
    buffer_load_dwordx4 v62, s[48:51], s45 offen lds
    s_add_u32 m0, s22, 12288
    s_add_u32 s45, s21, 344064
    buffer_load_dwordx4 v62, s[48:51], s45 offen lds
    s_add_u32 m0, s22, 16384
    s_add_u32 s45, s21, 458752
    buffer_load_dwordx4 v62, s[48:51], s45 offen lds
    s_add_u32 m0, s22, 65536
    s_add_u32 s45, s21, 0
    buffer_load_dwordx4 v63, s[52:55], s45 offen lds
    s_add_u32 m0, s22, 69632
    s_add_u32 s45, s21, 114688
    buffer_load_dwordx4 v63, s[52:55], s45 offen lds
    s_mov_b32 s46, 0
M_P0:
    ds_read_b32 v18, v12 offset:0
    ds_read2st64_b32 v[28:29], v2 offset0:8 offset1:17
    ds_read2st64_b32 v[30:31], v2 offset0:26 offset1:35
    ds_read_b64 v[20:21], v1 offset:0
    ds_read_b64 v[22:23], v1 offset:2304
    ds_read_b64 v[24:25], v1 offset:4608
    ds_read_b64 v[26:27], v1 offset:6912
    s_waitcnt lgkmcnt(0)
    s_setprio 2
    v_cmp_eq_u32 vcc, -1.0, v18
    s_cbranch_vccz M_R0
    s_add_u32 s46, s46, 1
    s_cmp_gt_u32 s46, 131072
    s_cbranch_scc1 M_R0
    s_cmp_lg_u32 s46, 1
    s_cbranch_scc1 M_P0
    s_sleep 40
    s_branch M_P0
M_R0:
    v_add_f32 v28, v28, v29
    v_add_f32 v30, v30, v31
    v_add_f32 v28, v28, v30
    v_rcp_f32 v29, v28
    v_add_f32 v20, v20, v22
    v_add_f32 v21, v21, v23
    v_add_f32 v24, v24, v26
    v_add_f32 v25, v25, v27
    v_add_f32 v20, v20, v24
    v_add_f32 v21, v21, v25
    v_mul_f32 v20, v20, v29
    v_mul_f32 v21, v21, v29
    v_cvt_pk_bf16_f32 v20, v20, v21
    ds_write_b32 v3, v20 offset:0
    ds_write_b32 v5, v17 offset:0
    v_max3_f32 v16, v16, v28, v29
    s_setprio 0
    s_sleep 2
M_O0:
    ds_read_b32 v20, v9 offset:0
    ds_read_b128 v[32:35], v4 offset:0
    ds_read_b128 v[36:39], v4 offset:64
    s_waitcnt lgkmcnt(0)
    s_setprio 2
    v_cmp_gt_f32 vcc, 0, v20
    s_setprio 0
    s_cbranch_vccz M_OK0
    s_add_u32 s46, s46, 1
    s_cmp_lt_u32 s46, 262144
    s_cbranch_scc1 M_O0
M_OK0:
    s_waitcnt vmcnt(23)
    v_mfma_f32_16x16x32_bf16 v[64:67], v[160:163], v[32:35], v[64:67]
    v_mfma_f32_16x16x32_bf16 v[68:71], v[164:167], v[32:35], v[68:71]
    v_mfma_f32_16x16x32_bf16 v[72:75], v[168:171], v[32:35], v[72:75]
    v_mfma_f32_16x16x32_bf16 v[76:79], v[172:175], v[32:35], v[76:79]
    v_mfma_f32_16x16x32_bf16 v[80:83], v[176:179], v[32:35], v[80:83]
    v_mfma_f32_16x16x32_bf16 v[84:87], v[180:183], v[32:35], v[84:87]
    v_mfma_f32_16x16x32_bf16 v[88:91], v[184:187], v[32:35], v[88:91]
    v_mfma_f32_16x16x32_bf16 v[92:95], v[188:191], v[32:35], v[92:95]
    v_mfma_f32_16x16x32_bf16 v[64:67], v[192:195], v[36:39], v[64:67]
    v_mfma_f32_16x16x32_bf16 v[68:71], v[196:199], v[36:39], v[68:71]
    v_mfma_f32_16x16x32_bf16 v[72:75], v[200:203], v[36:39], v[72:75]
    v_mfma_f32_16x16x32_bf16 v[76:79], v[204:207], v[36:39], v[76:79]
    v_mfma_f32_16x16x32_bf16 v[80:83], v[208:211], v[36:39], v[80:83]
    v_mfma_f32_16x16x32_bf16 v[84:87], v[212:215], v[36:39], v[84:87]
    v_mfma_f32_16x16x32_bf16 v[88:91], v[216:219], v[36:39], v[88:91]
    v_mfma_f32_16x16x32_bf16 v[92:95], v[220:223], v[36:39], v[92:95]
    s_add_u32 s44, s97, 2
    s_and_b32 s44, s44, 7
    s_lshl_b32 s44, s44, 16
    s_add_u32 s44, s44, s20
    s_add_u32 s45, s44, 0
    buffer_load_dwordx4 v[160:163], v14, s[28:31], s45 offen offset:0 sc1
    buffer_load_dwordx4 v[164:167], v14, s[28:31], s45 offen offset:1024 sc1
    buffer_load_dwordx4 v[168:171], v14, s[28:31], s45 offen offset:2048 sc1
    buffer_load_dwordx4 v[172:175], v14, s[28:31], s45 offen offset:3072 sc1
    s_add_u32 s45, s44, 4096
    buffer_load_dwordx4 v[176:179], v14, s[28:31], s45 offen offset:0 sc1
    buffer_load_dwordx4 v[180:183], v14, s[28:31], s45 offen offset:1024 sc1
    buffer_load_dwordx4 v[184:187], v14, s[28:31], s45 offen offset:2048 sc1
    buffer_load_dwordx4 v[188:191], v14, s[28:31], s45 offen offset:3072 sc1
    s_add_u32 s45, s44, 8192
    buffer_load_dwordx4 v[192:195], v14, s[28:31], s45 offen offset:0 sc1
    buffer_load_dwordx4 v[196:199], v14, s[28:31], s45 offen offset:1024 sc1
    buffer_load_dwordx4 v[200:203], v14, s[28:31], s45 offen offset:2048 sc1
    buffer_load_dwordx4 v[204:207], v14, s[28:31], s45 offen offset:3072 sc1
    s_add_u32 s45, s44, 12288
    buffer_load_dwordx4 v[208:211], v14, s[28:31], s45 offen offset:0 sc1
    buffer_load_dwordx4 v[212:215], v14, s[28:31], s45 offen offset:1024 sc1
    buffer_load_dwordx4 v[216:219], v14, s[28:31], s45 offen offset:2048 sc1
    buffer_load_dwordx4 v[220:223], v14, s[28:31], s45 offen offset:3072 sc1
    s_add_u32 m0, s22, 20480
    s_add_u32 s45, s21, 573440
    buffer_load_dwordx4 v62, s[48:51], s45 offen lds
    s_add_u32 m0, s22, 24576
    s_add_u32 s45, s21, 688128
    buffer_load_dwordx4 v62, s[48:51], s45 offen lds
    s_add_u32 m0, s22, 28672
    s_add_u32 s45, s21, 802816
    buffer_load_dwordx4 v62, s[48:51], s45 offen lds
    s_add_u32 m0, s22, 32768
    s_add_u32 s45, s21, 917504
    buffer_load_dwordx4 v62, s[48:51], s45 offen lds
    s_add_u32 m0, s22, 36864
    s_add_u32 s45, s21, 1032192
    buffer_load_dwordx4 v62, s[48:51], s45 offen lds
    s_add_u32 m0, s22, 73728
    s_add_u32 s45, s21, 229376
    buffer_load_dwordx4 v63, s[52:55], s45 offen lds
    s_add_u32 m0, s22, 77824
    s_add_u32 s45, s21, 344064
    buffer_load_dwordx4 v63, s[52:55], s45 offen lds
    s_mov_b32 s46, 0
M_P1:
    ds_read_b32 v18, v12 offset:9216
    ds_read2st64_b32 v[28:29], v2 offset0:44 offset1:53
    ds_read2st64_b32 v[30:31], v2 offset0:62 offset1:71
    ds_read_b64 v[20:21], v1 offset:9216
    ds_read_b64 v[22:23], v1 offset:11520
    ds_read_b64 v[24:25], v1 offset:13824
    ds_read_b64 v[26:27], v1 offset:16128
    s_waitcnt lgkmcnt(0)
    s_setprio 2
    v_cmp_eq_u32 vcc, -1.0, v18
    s_cbranch_vccz M_R1
    s_add_u32 s46, s46, 1
    s_cmp_gt_u32 s46, 131072
    s_cbranch_scc1 M_R1
    s_cmp_lg_u32 s46, 1
    s_cbranch_scc1 M_P1
    s_sleep 40
    s_branch M_P1
M_R1:
    v_add_f32 v28, v28, v29
    v_add_f32 v30, v30, v31
    v_add_f32 v28, v28, v30
    v_rcp_f32 v29, v28
    v_add_f32 v20, v20, v22
    v_add_f32 v21, v21, v23
    v_add_f32 v24, v24, v26
    v_add_f32 v25, v25, v27
    v_add_f32 v20, v20, v24
    v_add_f32 v21, v21, v25
    v_mul_f32 v20, v20, v29
    v_mul_f32 v21, v21, v29
    v_cvt_pk_bf16_f32 v20, v20, v21
    ds_write_b32 v3, v20 offset:1024
    ds_write_b32 v5, v17 offset:16
    v_max3_f32 v16, v16, v28, v29
    s_setprio 0
    s_sleep 2
M_O1:
    ds_read_b32 v20, v9 offset:16
    ds_read_b128 v[32:35], v4 offset:1024
    ds_read_b128 v[36:39], v4 offset:1088
    s_waitcnt lgkmcnt(0)
    s_setprio 2
    v_cmp_gt_f32 vcc, 0, v20
    s_setprio 0
    s_cbranch_vccz M_OK1
    s_add_u32 s46, s46, 1
    s_cmp_lt_u32 s46, 262144
    s_cbranch_scc1 M_O1
M_OK1:
    s_waitcnt vmcnt(30)
    v_mfma_f32_16x16x32_bf16 v[64:67], v[96:99], v[32:35], v[64:67]
    v_mfma_f32_16x16x32_bf16 v[68:71], v[100:103], v[32:35], v[68:71]
    v_mfma_f32_16x16x32_bf16 v[72:75], v[104:107], v[32:35], v[72:75]
    v_mfma_f32_16x16x32_bf16 v[76:79], v[108:111], v[32:35], v[76:79]
    v_mfma_f32_16x16x32_bf16 v[80:83], v[112:115], v[32:35], v[80:83]
    v_mfma_f32_16x16x32_bf16 v[84:87], v[116:119], v[32:35], v[84:87]
    v_mfma_f32_16x16x32_bf16 v[88:91], v[120:123], v[32:35], v[88:91]
    v_mfma_f32_16x16x32_bf16 v[92:95], v[124:127], v[32:35], v[92:95]
    v_mfma_f32_16x16x32_bf16 v[64:67], v[128:131], v[36:39], v[64:67]
    v_mfma_f32_16x16x32_bf16 v[68:71], v[132:135], v[36:39], v[68:71]
    v_mfma_f32_16x16x32_bf16 v[72:75], v[136:139], v[36:39], v[72:75]
    v_mfma_f32_16x16x32_bf16 v[76:79], v[140:143], v[36:39], v[76:79]
    v_mfma_f32_16x16x32_bf16 v[80:83], v[144:147], v[36:39], v[80:83]
    v_mfma_f32_16x16x32_bf16 v[84:87], v[148:151], v[36:39], v[84:87]
    v_mfma_f32_16x16x32_bf16 v[88:91], v[152:155], v[36:39], v[88:91]
    v_mfma_f32_16x16x32_bf16 v[92:95], v[156:159], v[36:39], v[92:95]
    s_add_u32 s44, s97, 3
    s_and_b32 s44, s44, 7
    s_lshl_b32 s44, s44, 16
    s_add_u32 s44, s44, s20
    s_add_u32 s45, s44, 0
    buffer_load_dwordx4 v[96:99], v14, s[28:31], s45 offen offset:0 sc1
    buffer_load_dwordx4 v[100:103], v14, s[28:31], s45 offen offset:1024 sc1
    buffer_load_dwordx4 v[104:107], v14, s[28:31], s45 offen offset:2048 sc1
    buffer_load_dwordx4 v[108:111], v14, s[28:31], s45 offen offset:3072 sc1
    s_add_u32 s45, s44, 4096
    buffer_load_dwordx4 v[112:115], v14, s[28:31], s45 offen offset:0 sc1
    buffer_load_dwordx4 v[116:119], v14, s[28:31], s45 offen offset:1024 sc1
    buffer_load_dwordx4 v[120:123], v14, s[28:31], s45 offen offset:2048 sc1
    buffer_load_dwordx4 v[124:127], v14, s[28:31], s45 offen offset:3072 sc1
    s_add_u32 s45, s44, 8192
    buffer_load_dwordx4 v[128:131], v14, s[28:31], s45 offen offset:0 sc1
    buffer_load_dwordx4 v[132:135], v14, s[28:31], s45 offen offset:1024 sc1
    buffer_load_dwordx4 v[136:139], v14, s[28:31], s45 offen offset:2048 sc1
    buffer_load_dwordx4 v[140:143], v14, s[28:31], s45 offen offset:3072 sc1
    s_add_u32 s45, s44, 12288
    buffer_load_dwordx4 v[144:147], v14, s[28:31], s45 offen offset:0 sc1
    buffer_load_dwordx4 v[148:151], v14, s[28:31], s45 offen offset:1024 sc1
    buffer_load_dwordx4 v[152:155], v14, s[28:31], s45 offen offset:2048 sc1
    buffer_load_dwordx4 v[156:159], v14, s[28:31], s45 offen offset:3072 sc1
    s_add_u32 m0, s22, 40960
    s_add_u32 s45, s21, 1146880
    buffer_load_dwordx4 v62, s[48:51], s45 offen lds
    s_add_u32 m0, s22, 45056
    s_add_u32 s45, s21, 1261568
    buffer_load_dwordx4 v62, s[48:51], s45 offen lds
    s_add_u32 m0, s22, 49152
    s_add_u32 s45, s21, 1376256
    buffer_load_dwordx4 v62, s[48:51], s45 offen lds
    s_add_u32 m0, s22, 81920
    s_add_u32 s45, s21, 458752
    buffer_load_dwordx4 v63, s[52:55], s45 offen lds
    s_add_u32 m0, s22, 86016
    s_add_u32 s45, s21, 573440
    buffer_load_dwordx4 v63, s[52:55], s45 offen lds
    s_add_u32 m0, s22, 90112
    s_add_u32 s45, s21, 688128
    buffer_load_dwordx4 v63, s[52:55], s45 offen lds
    s_lshl_b32 s35, s2, 2
    s_add_u32 s35, s35, s37
    s_mul_i32 s35, s35, 1792
    s_mov_b32 exec_lo, 0x3fff
    s_mov_b32 exec_hi, 0x0
    buffer_load_dword v61, v6, s[56:59], s35 offen
    s_mov_b64 exec, -1
    s_lshl_b32 s35, s43, 7
    s_add_u32 s35, s35, 0x250000
    buffer_load_dword v10, v11, s[28:31], s35 offen sc1
    s_mov_b32 s46, 0
M_P2:
    ds_read_b32 v18, v12 offset:18432
    ds_read2st64_b32 v[28:29], v2 offset0:80 offset1:89
    ds_read2st64_b32 v[30:31], v2 offset0:98 offset1:107
    ds_read_b64 v[20:21], v1 offset:18432
    ds_read_b64 v[22:23], v1 offset:20736
    ds_read_b64 v[24:25], v1 offset:23040
    ds_read_b64 v[26:27], v1 offset:25344
    s_waitcnt lgkmcnt(0)
    s_setprio 2
    v_cmp_eq_u32 vcc, -1.0, v18
    s_cbranch_vccz M_R2
    s_add_u32 s46, s46, 1
    s_cmp_gt_u32 s46, 131072
    s_cbranch_scc1 M_R2
    s_cmp_lg_u32 s46, 1
    s_cbranch_scc1 M_P2
    s_sleep 40
    s_branch M_P2
M_R2:
    v_add_f32 v28, v28, v29
    v_add_f32 v30, v30, v31
    v_add_f32 v28, v28, v30
    v_rcp_f32 v29, v28
    v_add_f32 v20, v20, v22
    v_add_f32 v21, v21, v23
    v_add_f32 v24, v24, v26
    v_add_f32 v25, v25, v27
    v_add_f32 v20, v20, v24
    v_add_f32 v21, v21, v25
    v_mul_f32 v20, v20, v29
    v_mul_f32 v21, v21, v29
    v_cvt_pk_bf16_f32 v20, v20, v21
    ds_write_b32 v3, v20 offset:2048
    ds_write_b32 v5, v17 offset:32
    v_max3_f32 v16, v16, v28, v29
    s_setprio 0
    s_sleep 2
M_O2:
    ds_read_b32 v20, v9 offset:32
    ds_read_b128 v[32:35], v4 offset:2048
    ds_read_b128 v[36:39], v4 offset:2112
    s_waitcnt lgkmcnt(0)
    s_setprio 2
    v_cmp_gt_f32 vcc, 0, v20
    s_setprio 0
    s_cbranch_vccz M_OK2
    s_add_u32 s46, s46, 1
    s_cmp_lt_u32 s46, 262144
    s_cbranch_scc1 M_O2
M_OK2:
    s_waitcnt vmcnt(31)
    v_mfma_f32_16x16x32_bf16 v[64:67], v[160:163], v[32:35], v[64:67]
    v_mfma_f32_16x16x32_bf16 v[68:71], v[164:167], v[32:35], v[68:71]
    v_mfma_f32_16x16x32_bf16 v[72:75], v[168:171], v[32:35], v[72:75]
    v_mfma_f32_16x16x32_bf16 v[76:79], v[172:175], v[32:35], v[76:79]
    v_mfma_f32_16x16x32_bf16 v[80:83], v[176:179], v[32:35], v[80:83]
    v_mfma_f32_16x16x32_bf16 v[84:87], v[180:183], v[32:35], v[84:87]
    v_mfma_f32_16x16x32_bf16 v[88:91], v[184:187], v[32:35], v[88:91]
    v_mfma_f32_16x16x32_bf16 v[92:95], v[188:191], v[32:35], v[92:95]
    v_mfma_f32_16x16x32_bf16 v[64:67], v[192:195], v[36:39], v[64:67]
    v_mfma_f32_16x16x32_bf16 v[68:71], v[196:199], v[36:39], v[68:71]
    v_mfma_f32_16x16x32_bf16 v[72:75], v[200:203], v[36:39], v[72:75]
    v_mfma_f32_16x16x32_bf16 v[76:79], v[204:207], v[36:39], v[76:79]
    v_mfma_f32_16x16x32_bf16 v[80:83], v[208:211], v[36:39], v[80:83]
    v_mfma_f32_16x16x32_bf16 v[84:87], v[212:215], v[36:39], v[84:87]
    v_mfma_f32_16x16x32_bf16 v[88:91], v[216:219], v[36:39], v[88:91]
    v_mfma_f32_16x16x32_bf16 v[92:95], v[220:223], v[36:39], v[92:95]
    s_add_u32 s44, s97, 4
    s_and_b32 s44, s44, 7
    s_lshl_b32 s44, s44, 16
    s_add_u32 s44, s44, s20
    s_add_u32 s45, s44, 0
    buffer_load_dwordx4 v[160:163], v14, s[28:31], s45 offen offset:0 sc1
    buffer_load_dwordx4 v[164:167], v14, s[28:31], s45 offen offset:1024 sc1
    buffer_load_dwordx4 v[168:171], v14, s[28:31], s45 offen offset:2048 sc1
    buffer_load_dwordx4 v[172:175], v14, s[28:31], s45 offen offset:3072 sc1
    s_add_u32 s45, s44, 4096
    buffer_load_dwordx4 v[176:179], v14, s[28:31], s45 offen offset:0 sc1
    buffer_load_dwordx4 v[180:183], v14, s[28:31], s45 offen offset:1024 sc1
    buffer_load_dwordx4 v[184:187], v14, s[28:31], s45 offen offset:2048 sc1
    buffer_load_dwordx4 v[188:191], v14, s[28:31], s45 offen offset:3072 sc1
    s_add_u32 s45, s44, 8192
    buffer_load_dwordx4 v[192:195], v14, s[28:31], s45 offen offset:0 sc1
    buffer_load_dwordx4 v[196:199], v14, s[28:31], s45 offen offset:1024 sc1
    buffer_load_dwordx4 v[200:203], v14, s[28:31], s45 offen offset:2048 sc1
    buffer_load_dwordx4 v[204:207], v14, s[28:31], s45 offen offset:3072 sc1
    s_add_u32 s45, s44, 12288
    buffer_load_dwordx4 v[208:211], v14, s[28:31], s45 offen offset:0 sc1
    buffer_load_dwordx4 v[212:215], v14, s[28:31], s45 offen offset:1024 sc1
    buffer_load_dwordx4 v[216:219], v14, s[28:31], s45 offen offset:2048 sc1
    buffer_load_dwordx4 v[220:223], v14, s[28:31], s45 offen offset:3072 sc1
    s_add_u32 m0, s22, 53248
    s_add_u32 s45, s21, 1490944
    buffer_load_dwordx4 v62, s[48:51], s45 offen lds
    s_add_u32 m0, s22, 57344
    s_add_u32 s45, s21, 1605632
    buffer_load_dwordx4 v62, s[48:51], s45 offen lds
    s_add_u32 m0, s22, 61440
    s_add_u32 s45, s21, 1720320
    buffer_load_dwordx4 v62, s[48:51], s45 offen lds
    s_add_u32 m0, s22, 94208
    s_add_u32 s45, s21, 802816
    buffer_load_dwordx4 v63, s[52:55], s45 offen lds
    s_add_u32 m0, s22, 98304
    s_add_u32 s45, s21, 917504
    buffer_load_dwordx4 v63, s[52:55], s45 offen lds
    s_mov_b32 s46, 0
M_P3:
    ds_read_b32 v18, v12 offset:27648
    ds_read2st64_b32 v[28:29], v2 offset0:116 offset1:125
    ds_read2st64_b32 v[30:31], v2 offset0:134 offset1:143
    ds_read_b64 v[20:21], v1 offset:27648
    ds_read_b64 v[22:23], v1 offset:29952
    ds_read_b64 v[24:25], v1 offset:32256
    ds_read_b64 v[26:27], v1 offset:34560
    s_waitcnt lgkmcnt(0)
    s_setprio 2
    v_cmp_eq_u32 vcc, -1.0, v18
    s_cbranch_vccz M_R3
    s_add_u32 s46, s46, 1
    s_cmp_gt_u32 s46, 131072
    s_cbranch_scc1 M_R3
    s_cmp_lg_u32 s46, 1
    s_cbranch_scc1 M_P3
    s_sleep 40
    s_branch M_P3
M_R3:
    v_add_f32 v28, v28, v29
    v_add_f32 v30, v30, v31
    v_add_f32 v28, v28, v30
    v_rcp_f32 v29, v28
    v_add_f32 v20, v20, v22
    v_add_f32 v21, v21, v23
    v_add_f32 v24, v24, v26
    v_add_f32 v25, v25, v27
    v_add_f32 v20, v20, v24
    v_add_f32 v21, v21, v25
    v_mul_f32 v20, v20, v29
    v_mul_f32 v21, v21, v29
    v_cvt_pk_bf16_f32 v20, v20, v21
    ds_write_b32 v3, v20 offset:3072
    ds_write_b32 v5, v17 offset:48
    v_max3_f32 v16, v16, v28, v29
    s_setprio 0
    s_sleep 2
M_O3:
    ds_read_b32 v20, v9 offset:48
    ds_read_b128 v[32:35], v4 offset:3072
    ds_read_b128 v[36:39], v4 offset:3136
    s_waitcnt lgkmcnt(0)
    s_setprio 2
    v_cmp_gt_f32 vcc, 0, v20
    s_setprio 0
    s_cbranch_vccz M_OK3
    s_add_u32 s46, s46, 1
    s_cmp_lt_u32 s46, 262144
    s_cbranch_scc1 M_O3
M_OK3:
    s_waitcnt vmcnt(29)
    v_mfma_f32_16x16x32_bf16 v[64:67], v[96:99], v[32:35], v[64:67]
    v_mfma_f32_16x16x32_bf16 v[68:71], v[100:103], v[32:35], v[68:71]
    v_mfma_f32_16x16x32_bf16 v[72:75], v[104:107], v[32:35], v[72:75]
    v_mfma_f32_16x16x32_bf16 v[76:79], v[108:111], v[32:35], v[76:79]
    v_mfma_f32_16x16x32_bf16 v[80:83], v[112:115], v[32:35], v[80:83]
    v_mfma_f32_16x16x32_bf16 v[84:87], v[116:119], v[32:35], v[84:87]
    v_mfma_f32_16x16x32_bf16 v[88:91], v[120:123], v[32:35], v[88:91]
    v_mfma_f32_16x16x32_bf16 v[92:95], v[124:127], v[32:35], v[92:95]
    v_mfma_f32_16x16x32_bf16 v[64:67], v[128:131], v[36:39], v[64:67]
    v_mfma_f32_16x16x32_bf16 v[68:71], v[132:135], v[36:39], v[68:71]
    v_mfma_f32_16x16x32_bf16 v[72:75], v[136:139], v[36:39], v[72:75]
    v_mfma_f32_16x16x32_bf16 v[76:79], v[140:143], v[36:39], v[76:79]
    v_mfma_f32_16x16x32_bf16 v[80:83], v[144:147], v[36:39], v[80:83]
    v_mfma_f32_16x16x32_bf16 v[84:87], v[148:151], v[36:39], v[84:87]
    v_mfma_f32_16x16x32_bf16 v[88:91], v[152:155], v[36:39], v[88:91]
    v_mfma_f32_16x16x32_bf16 v[92:95], v[156:159], v[36:39], v[92:95]
    s_add_u32 s44, s97, 5
    s_and_b32 s44, s44, 7
    s_lshl_b32 s44, s44, 16
    s_add_u32 s44, s44, s20
    s_add_u32 s45, s44, 0
    buffer_load_dwordx4 v[96:99], v14, s[28:31], s45 offen offset:0 sc1
    buffer_load_dwordx4 v[100:103], v14, s[28:31], s45 offen offset:1024 sc1
    buffer_load_dwordx4 v[104:107], v14, s[28:31], s45 offen offset:2048 sc1
    buffer_load_dwordx4 v[108:111], v14, s[28:31], s45 offen offset:3072 sc1
    s_add_u32 s45, s44, 4096
    buffer_load_dwordx4 v[112:115], v14, s[28:31], s45 offen offset:0 sc1
    buffer_load_dwordx4 v[116:119], v14, s[28:31], s45 offen offset:1024 sc1
    buffer_load_dwordx4 v[120:123], v14, s[28:31], s45 offen offset:2048 sc1
    buffer_load_dwordx4 v[124:127], v14, s[28:31], s45 offen offset:3072 sc1
    s_add_u32 s45, s44, 8192
    buffer_load_dwordx4 v[128:131], v14, s[28:31], s45 offen offset:0 sc1
    buffer_load_dwordx4 v[132:135], v14, s[28:31], s45 offen offset:1024 sc1
    buffer_load_dwordx4 v[136:139], v14, s[28:31], s45 offen offset:2048 sc1
    buffer_load_dwordx4 v[140:143], v14, s[28:31], s45 offen offset:3072 sc1
    s_add_u32 s45, s44, 12288
    buffer_load_dwordx4 v[144:147], v14, s[28:31], s45 offen offset:0 sc1
    buffer_load_dwordx4 v[148:151], v14, s[28:31], s45 offen offset:1024 sc1
    buffer_load_dwordx4 v[152:155], v14, s[28:31], s45 offen offset:2048 sc1
    buffer_load_dwordx4 v[156:159], v14, s[28:31], s45 offen offset:3072 sc1
    s_add_u32 m0, s22, 102400
    s_add_u32 s45, s21, 1032192
    buffer_load_dwordx4 v63, s[52:55], s45 offen lds
    s_add_u32 m0, s22, 106496
    s_add_u32 s45, s21, 1146880
    buffer_load_dwordx4 v63, s[52:55], s45 offen lds
    s_add_u32 s35, s60, 0
    s_mov_b32 exec_lo, 0xffff
    s_mov_b32 exec_hi, 0x0
    buffer_load_dword v61, v6, s[56:59], s35 offen
    s_mov_b64 exec, -1
    s_add_u32 s35, s60, 65536
    s_mov_b32 exec_lo, 0xffff
    s_mov_b32 exec_hi, 0x0
    buffer_load_dword v61, v6, s[56:59], s35 offen
    s_mov_b64 exec, -1
    s_mov_b32 s46, 0
M_P4:
    ds_read_b32 v18, v13 offset:0
    ds_read2st64_b32 v[28:29], v56 offset0:8 offset1:17
    ds_read2st64_b32 v[30:31], v56 offset0:26 offset1:35
    ds_read_b64 v[20:21], v19 offset:0
    ds_read_b64 v[22:23], v19 offset:2304
    ds_read_b64 v[24:25], v19 offset:4608
    ds_read_b64 v[26:27], v19 offset:6912
    s_waitcnt lgkmcnt(0)
    s_setprio 2
    v_cmp_eq_u32 vcc, -1.0, v18
    s_cbranch_vccz M_R4
    s_add_u32 s46, s46, 1
    s_cmp_gt_u32 s46, 131072
    s_cbranch_scc1 M_R4
    s_cmp_lg_u32 s46, 1
    s_cbranch_scc1 M_P4
    s_sleep 40
    s_branch M_P4
M_R4:
    v_add_f32 v28, v28, v29
    v_add_f32 v30, v30, v31
    v_add_f32 v28, v28, v30
    v_rcp_f32 v29, v28
    v_add_f32 v20, v20, v22
    v_add_f32 v21, v21, v23
    v_add_f32 v24, v24, v26
    v_add_f32 v25, v25, v27
    v_add_f32 v20, v20, v24
    v_add_f32 v21, v21, v25
    v_mul_f32 v20, v20, v29
    v_mul_f32 v21, v21, v29
    v_cvt_pk_bf16_f32 v20, v20, v21
    ds_write_b32 v3, v20 offset:4096
    ds_write_b32 v5, v17 offset:64
    v_max3_f32 v16, v16, v28, v29
    s_setprio 0
    s_sleep 2
M_O4:
    ds_read_b32 v20, v9 offset:64
    ds_read_b128 v[32:35], v4 offset:4096
    ds_read_b128 v[36:39], v4 offset:4160
    s_waitcnt lgkmcnt(0)
    s_setprio 2
    v_cmp_gt_f32 vcc, 0, v20
    s_setprio 0
    s_cbranch_vccz M_OK4
    s_add_u32 s46, s46, 1
    s_cmp_lt_u32 s46, 262144
    s_cbranch_scc1 M_O4
M_OK4:
    s_waitcnt vmcnt(25)
    v_mfma_f32_16x16x32_bf16 v[64:67], v[160:163], v[32:35], v[64:67]
    v_mfma_f32_16x16x32_bf16 v[68:71], v[164:167], v[32:35], v[68:71]
    v_mfma_f32_16x16x32_bf16 v[72:75], v[168:171], v[32:35], v[72:75]
    v_mfma_f32_16x16x32_bf16 v[76:79], v[172:175], v[32:35], v[76:79]
    v_mfma_f32_16x16x32_bf16 v[80:83], v[176:179], v[32:35], v[80:83]
    v_mfma_f32_16x16x32_bf16 v[84:87], v[180:183], v[32:35], v[84:87]
    v_mfma_f32_16x16x32_bf16 v[88:91], v[184:187], v[32:35], v[88:91]
    v_mfma_f32_16x16x32_bf16 v[92:95], v[188:191], v[32:35], v[92:95]
    v_mfma_f32_16x16x32_bf16 v[64:67], v[192:195], v[36:39], v[64:67]
    v_mfma_f32_16x16x32_bf16 v[68:71], v[196:199], v[36:39], v[68:71]
    v_mfma_f32_16x16x32_bf16 v[72:75], v[200:203], v[36:39], v[72:75]
    v_mfma_f32_16x16x32_bf16 v[76:79], v[204:207], v[36:39], v[76:79]
    v_mfma_f32_16x16x32_bf16 v[80:83], v[208:211], v[36:39], v[80:83]
    v_mfma_f32_16x16x32_bf16 v[84:87], v[212:215], v[36:39], v[84:87]
    v_mfma_f32_16x16x32_bf16 v[88:91], v[216:219], v[36:39], v[88:91]
    v_mfma_f32_16x16x32_bf16 v[92:95], v[220:223], v[36:39], v[92:95]
    s_add_u32 s44, s97, 6
    s_and_b32 s44, s44, 7
    s_lshl_b32 s44, s44, 16
    s_add_u32 s44, s44, s20
    s_add_u32 s45, s44, 0
    buffer_load_dwordx4 v[160:163], v14, s[28:31], s45 offen offset:0 sc1
    buffer_load_dwordx4 v[164:167], v14, s[28:31], s45 offen offset:1024 sc1
    buffer_load_dwordx4 v[168:171], v14, s[28:31], s45 offen offset:2048 sc1
    buffer_load_dwordx4 v[172:175], v14, s[28:31], s45 offen offset:3072 sc1
    s_add_u32 s45, s44, 4096
    buffer_load_dwordx4 v[176:179], v14, s[28:31], s45 offen offset:0 sc1
    buffer_load_dwordx4 v[180:183], v14, s[28:31], s45 offen offset:1024 sc1
    buffer_load_dwordx4 v[184:187], v14, s[28:31], s45 offen offset:2048 sc1
    buffer_load_dwordx4 v[188:191], v14, s[28:31], s45 offen offset:3072 sc1
    s_add_u32 s45, s44, 8192
    buffer_load_dwordx4 v[192:195], v14, s[28:31], s45 offen offset:0 sc1
    buffer_load_dwordx4 v[196:199], v14, s[28:31], s45 offen offset:1024 sc1
    buffer_load_dwordx4 v[200:203], v14, s[28:31], s45 offen offset:2048 sc1
    buffer_load_dwordx4 v[204:207], v14, s[28:31], s45 offen offset:3072 sc1
    s_add_u32 s45, s44, 12288
    buffer_load_dwordx4 v[208:211], v14, s[28:31], s45 offen offset:0 sc1
    buffer_load_dwordx4 v[212:215], v14, s[28:31], s45 offen offset:1024 sc1
    buffer_load_dwordx4 v[216:219], v14, s[28:31], s45 offen offset:2048 sc1
    buffer_load_dwordx4 v[220:223], v14, s[28:31], s45 offen offset:3072 sc1
    s_add_u32 m0, s22, 110592
    s_add_u32 s45, s21, 1261568
    buffer_load_dwordx4 v63, s[52:55], s45 offen lds
    s_add_u32 m0, s22, 114688
    s_add_u32 s45, s21, 1376256
    buffer_load_dwordx4 v63, s[52:55], s45 offen lds
    s_add_u32 s35, s60, 131072
    s_mov_b32 exec_lo, 0xffff
    s_mov_b32 exec_hi, 0x0
    buffer_load_dword v61, v6, s[56:59], s35 offen
    s_mov_b64 exec, -1
    s_add_u32 s35, s60, 196608
    s_mov_b32 exec_lo, 0xffff
    s_mov_b32 exec_hi, 0x0
    buffer_load_dword v61, v6, s[56:59], s35 offen
    s_mov_b64 exec, -1
    s_add_u32 s35, s60, 262144
    s_mov_b32 exec_lo, 0xffff
    s_mov_b32 exec_hi, 0x0
    buffer_load_dword v61, v6, s[56:59], s35 offen
    s_mov_b64 exec, -1
    s_mov_b32 s46, 0
M_P5:
    ds_read_b32 v18, v13 offset:9216
    ds_read2st64_b32 v[28:29], v56 offset0:44 offset1:53
    ds_read2st64_b32 v[30:31], v56 offset0:62 offset1:71
    ds_read_b64 v[20:21], v19 offset:9216
    ds_read_b64 v[22:23], v19 offset:11520
    ds_read_b64 v[24:25], v19 offset:13824
    ds_read_b64 v[26:27], v19 offset:16128
    s_waitcnt lgkmcnt(0)
    s_setprio 2
    v_cmp_eq_u32 vcc, -1.0, v18
    s_cbranch_vccz M_R5
    s_add_u32 s46, s46, 1
    s_cmp_gt_u32 s46, 131072
    s_cbranch_scc1 M_R5
    s_cmp_lg_u32 s46, 1
    s_cbranch_scc1 M_P5
    s_sleep 40
    s_branch M_P5
M_R5:
    v_add_f32 v28, v28, v29
    v_add_f32 v30, v30, v31
    v_add_f32 v28, v28, v30
    v_rcp_f32 v29, v28
    v_add_f32 v20, v20, v22
    v_add_f32 v21, v21, v23
    v_add_f32 v24, v24, v26
    v_add_f32 v25, v25, v27
    v_add_f32 v20, v20, v24
    v_add_f32 v21, v21, v25
    v_mul_f32 v20, v20, v29
    v_mul_f32 v21, v21, v29
    v_cvt_pk_bf16_f32 v20, v20, v21
    ds_write_b32 v3, v20 offset:5120
    ds_write_b32 v5, v17 offset:80
    v_max3_f32 v16, v16, v28, v29
    s_setprio 0
    s_sleep 2
M_O5:
    ds_read_b32 v20, v9 offset:80
    ds_read_b128 v[32:35], v4 offset:5120
    ds_read_b128 v[36:39], v4 offset:5184
    s_waitcnt lgkmcnt(0)
    s_setprio 2
    v_cmp_gt_f32 vcc, 0, v20
    s_setprio 0
    s_cbranch_vccz M_OK5
    s_add_u32 s46, s46, 1
    s_cmp_lt_u32 s46, 262144
    s_cbranch_scc1 M_O5
M_OK5:
    s_waitcnt vmcnt(25)
    v_mfma_f32_16x16x32_bf16 v[64:67], v[96:99], v[32:35], v[64:67]
    v_mfma_f32_16x16x32_bf16 v[68:71], v[100:103], v[32:35], v[68:71]
    v_mfma_f32_16x16x32_bf16 v[72:75], v[104:107], v[32:35], v[72:75]
    v_mfma_f32_16x16x32_bf16 v[76:79], v[108:111], v[32:35], v[76:79]
    v_mfma_f32_16x16x32_bf16 v[80:83], v[112:115], v[32:35], v[80:83]
    v_mfma_f32_16x16x32_bf16 v[84:87], v[116:119], v[32:35], v[84:87]
    v_mfma_f32_16x16x32_bf16 v[88:91], v[120:123], v[32:35], v[88:91]
    v_mfma_f32_16x16x32_bf16 v[92:95], v[124:127], v[32:35], v[92:95]
    v_mfma_f32_16x16x32_bf16 v[64:67], v[128:131], v[36:39], v[64:67]
    v_mfma_f32_16x16x32_bf16 v[68:71], v[132:135], v[36:39], v[68:71]
    v_mfma_f32_16x16x32_bf16 v[72:75], v[136:139], v[36:39], v[72:75]
    v_mfma_f32_16x16x32_bf16 v[76:79], v[140:143], v[36:39], v[76:79]
    v_mfma_f32_16x16x32_bf16 v[80:83], v[144:147], v[36:39], v[80:83]
    v_mfma_f32_16x16x32_bf16 v[84:87], v[148:151], v[36:39], v[84:87]
    v_mfma_f32_16x16x32_bf16 v[88:91], v[152:155], v[36:39], v[88:91]
    v_mfma_f32_16x16x32_bf16 v[92:95], v[156:159], v[36:39], v[92:95]
    s_add_u32 s44, s97, 7
    s_and_b32 s44, s44, 7
    s_lshl_b32 s44, s44, 16
    s_add_u32 s44, s44, s20
    s_add_u32 s45, s44, 0
    buffer_load_dwordx4 v[96:99], v14, s[28:31], s45 offen offset:0 sc1
    buffer_load_dwordx4 v[100:103], v14, s[28:31], s45 offen offset:1024 sc1
    buffer_load_dwordx4 v[104:107], v14, s[28:31], s45 offen offset:2048 sc1
    buffer_load_dwordx4 v[108:111], v14, s[28:31], s45 offen offset:3072 sc1
    s_add_u32 s45, s44, 4096
    buffer_load_dwordx4 v[112:115], v14, s[28:31], s45 offen offset:0 sc1
    buffer_load_dwordx4 v[116:119], v14, s[28:31], s45 offen offset:1024 sc1
    buffer_load_dwordx4 v[120:123], v14, s[28:31], s45 offen offset:2048 sc1
    buffer_load_dwordx4 v[124:127], v14, s[28:31], s45 offen offset:3072 sc1
    s_add_u32 s45, s44, 8192
    buffer_load_dwordx4 v[128:131], v14, s[28:31], s45 offen offset:0 sc1
    buffer_load_dwordx4 v[132:135], v14, s[28:31], s45 offen offset:1024 sc1
    buffer_load_dwordx4 v[136:139], v14, s[28:31], s45 offen offset:2048 sc1
    buffer_load_dwordx4 v[140:143], v14, s[28:31], s45 offen offset:3072 sc1
    s_add_u32 s45, s44, 12288
    buffer_load_dwordx4 v[144:147], v14, s[28:31], s45 offen offset:0 sc1
    buffer_load_dwordx4 v[148:151], v14, s[28:31], s45 offen offset:1024 sc1
    buffer_load_dwordx4 v[152:155], v14, s[28:31], s45 offen offset:2048 sc1
    buffer_load_dwordx4 v[156:159], v14, s[28:31], s45 offen offset:3072 sc1
    s_add_u32 m0, s22, 118784
    s_add_u32 s45, s21, 1490944
    buffer_load_dwordx4 v63, s[52:55], s45 offen lds
    s_add_u32 m0, s22, 122880
    s_add_u32 s45, s21, 1605632
    buffer_load_dwordx4 v63, s[52:55], s45 offen lds
    s_add_u32 m0, s22, 126976
    s_add_u32 s45, s21, 1720320
    buffer_load_dwordx4 v63, s[52:55], s45 offen lds
    buffer_load_dword v61, v57, s[28:31], s38 offen offset:0 sc1
    buffer_load_dword v61, v57, s[28:31], s38 offen offset:2048 sc1
    buffer_load_dword v61, v57, s[28:31], s39 offen offset:0 sc1
    buffer_load_dword v61, v57, s[28:31], s39 offen offset:2048 sc1
    s_lshl_b32 s35, s33, 7
    s_add_u32 s35, s35, 0x240000
    s_lshl_b32 s45, s37, 15
    s_and_b32 s45, s45, 0x8000
    s_add_u32 s35, s35, s45
    s_mov_b32 exec_lo, 0x1
    s_mov_b32 exec_hi, 0x0
    buffer_load_dword v61, v6, s[28:31], s35 offen sc1
    s_mov_b64 exec, -1
    s_mov_b32 s46, 0
M_P6:
    ds_read_b32 v18, v13 offset:18432
    ds_read2st64_b32 v[28:29], v56 offset0:80 offset1:89
    ds_read2st64_b32 v[30:31], v56 offset0:98 offset1:107
    ds_read_b64 v[20:21], v19 offset:18432
    ds_read_b64 v[22:23], v19 offset:20736
    ds_read_b64 v[24:25], v19 offset:23040
    ds_read_b64 v[26:27], v19 offset:25344
    s_waitcnt lgkmcnt(0)
    s_setprio 2
    v_cmp_eq_u32 vcc, -1.0, v18
    s_cbranch_vccz M_R6
    s_add_u32 s46, s46, 1
    s_cmp_gt_u32 s46, 131072
    s_cbranch_scc1 M_R6
    s_cmp_lg_u32 s46, 1
    s_cbranch_scc1 M_P6
    s_sleep 40
    s_branch M_P6
M_R6:
    v_add_f32 v28, v28, v29
    v_add_f32 v30, v30, v31
    v_add_f32 v28, v28, v30
    v_rcp_f32 v29, v28
    v_add_f32 v20, v20, v22
    v_add_f32 v21, v21, v23
    v_add_f32 v24, v24, v26
    v_add_f32 v25, v25, v27
    v_add_f32 v20, v20, v24
    v_add_f32 v21, v21, v25
    v_mul_f32 v20, v20, v29
    v_mul_f32 v21, v21, v29
    v_cvt_pk_bf16_f32 v20, v20, v21
    ds_write_b32 v3, v20 offset:6144
    ds_write_b32 v5, v17 offset:96
    v_max3_f32 v16, v16, v28, v29
    s_setprio 0
    s_sleep 2
M_O6:
    ds_read_b32 v20, v9 offset:96
    ds_read_b128 v[32:35], v4 offset:6144
    ds_read_b128 v[36:39], v4 offset:6208
    s_waitcnt lgkmcnt(0)
    s_setprio 2
    v_cmp_gt_f32 vcc, 0, v20
    s_setprio 0
    s_cbranch_vccz M_OK6
    s_add_u32 s46, s46, 1
    s_cmp_lt_u32 s46, 262144
    s_cbranch_scc1 M_O6
M_OK6:
    s_waitcnt vmcnt(29)
    v_mfma_f32_16x16x32_bf16 v[64:67], v[160:163], v[32:35], v[64:67]
    v_mfma_f32_16x16x32_bf16 v[68:71], v[164:167], v[32:35], v[68:71]
    v_mfma_f32_16x16x32_bf16 v[72:75], v[168:171], v[32:35], v[72:75]
    v_mfma_f32_16x16x32_bf16 v[76:79], v[172:175], v[32:35], v[76:79]
    v_mfma_f32_16x16x32_bf16 v[80:83], v[176:179], v[32:35], v[80:83]
    v_mfma_f32_16x16x32_bf16 v[84:87], v[180:183], v[32:35], v[84:87]
    v_mfma_f32_16x16x32_bf16 v[88:91], v[184:187], v[32:35], v[88:91]
    v_mfma_f32_16x16x32_bf16 v[92:95], v[188:191], v[32:35], v[92:95]
    v_mfma_f32_16x16x32_bf16 v[64:67], v[192:195], v[36:39], v[64:67]
    v_mfma_f32_16x16x32_bf16 v[68:71], v[196:199], v[36:39], v[68:71]
    v_mfma_f32_16x16x32_bf16 v[72:75], v[200:203], v[36:39], v[72:75]
    v_mfma_f32_16x16x32_bf16 v[76:79], v[204:207], v[36:39], v[76:79]
    v_mfma_f32_16x16x32_bf16 v[80:83], v[208:211], v[36:39], v[80:83]
    v_mfma_f32_16x16x32_bf16 v[84:87], v[212:215], v[36:39], v[84:87]
    v_mfma_f32_16x16x32_bf16 v[88:91], v[216:219], v[36:39], v[88:91]
    v_mfma_f32_16x16x32_bf16 v[92:95], v[220:223], v[36:39], v[92:95]
    s_lshr_b32 s35, s34, 2
    s_lshl_b32 s35, s35, 2
    s_add_u32 s35, s35, s37
    s_lshl_b32 s35, s35, 14
    s_add_u32 s45, s35, 0x700000
    buffer_load_dwordx4 v[192:195], v14, s[28:31], s45 offen offset:0 sc1
    buffer_load_dwordx4 v[196:199], v14, s[28:31], s45 offen offset:1024 sc1
    buffer_load_dwordx4 v[200:203], v14, s[28:31], s45 offen offset:2048 sc1
    buffer_load_dwordx4 v[204:207], v14, s[28:31], s45 offen offset:3072 sc1
    s_add_u32 s45, s35, 0x701000
    buffer_load_dwordx4 v[208:211], v14, s[28:31], s45 offen offset:0 sc1
    buffer_load_dwordx4 v[212:215], v14, s[28:31], s45 offen offset:1024 sc1
    buffer_load_dwordx4 v[216:219], v14, s[28:31], s45 offen offset:2048 sc1
    buffer_load_dwordx4 v[220:223], v14, s[28:31], s45 offen offset:3072 sc1
    s_add_u32 s45, s35, 0x702000
    buffer_load_dwordx4 v[224:227], v14, s[28:31], s45 offen offset:0 sc1
    buffer_load_dwordx4 v[228:231], v14, s[28:31], s45 offen offset:1024 sc1
    buffer_load_dwordx4 v[232:235], v14, s[28:31], s45 offen offset:2048 sc1
    buffer_load_dwordx4 v[236:239], v14, s[28:31], s45 offen offset:3072 sc1
    s_add_u32 s45, s35, 0x703000
    buffer_load_dwordx4 v[240:243], v14, s[28:31], s45 offen offset:0 sc1
    buffer_load_dwordx4 v[244:247], v14, s[28:31], s45 offen offset:1024 sc1
    buffer_load_dwordx4 v[248:251], v14, s[28:31], s45 offen offset:2048 sc1
    buffer_load_dwordx4 v[252:255], v14, s[28:31], s45 offen offset:3072 sc1
    s_lshl_b32 s35, s43, 3
    s_add_u32 s35, s35, s32
    s_mul_i32 s35, s35, 114688
    s_lshl_b32 s45, s34, 12
    s_add_u32 s35, s35, s45
    s_add_u32 s35, s35, 0x800000
    s_mov_b32 exec_lo, 0xffffffff
    s_mov_b32 exec_hi, 0x0
    buffer_load_dword v61, v6, s[28:31], s35 offen sc1
    s_mov_b64 exec, -1
    s_setprio 2
    s_getreg_b32 s23, hwreg(HW_REG_XCC_ID, 0, 4)
    s_add_u32 s23, s23, s99
    v_cmp_ne_u32 vcc, s23, v10
    s_cmp_eq_u64 vcc, 0
    s_cselect_b32 s3, 1, 0
    s_setprio 0
    s_mov_b32 s46, 0
M_P7:
    ds_read_b32 v18, v13 offset:27648
    ds_read2st64_b32 v[28:29], v56 offset0:116 offset1:125
    ds_read2st64_b32 v[30:31], v56 offset0:134 offset1:143
    ds_read_b64 v[20:21], v19 offset:27648
    ds_read_b64 v[22:23], v19 offset:29952
    ds_read_b64 v[24:25], v19 offset:32256
    ds_read_b64 v[26:27], v19 offset:34560
    s_waitcnt lgkmcnt(0)
    s_setprio 2
    v_cmp_eq_u32 vcc, -1.0, v18
    s_cbranch_vccz M_R7
    s_add_u32 s46, s46, 1
    s_cmp_gt_u32 s46, 131072
    s_cbranch_scc1 M_R7
    s_cmp_gt_u32 s46, 1
    s_cbranch_scc1 M_P7
    s_sleep 16
    s_branch M_P7
M_R7:
    v_add_f32 v28, v28, v29
    v_add_f32 v30, v30, v31
    v_add_f32 v28, v28, v30
    v_rcp_f32 v29, v28
    v_add_f32 v20, v20, v22
    v_add_f32 v21, v21, v23
    v_add_f32 v24, v24, v26
    v_add_f32 v25, v25, v27
    v_add_f32 v20, v20, v24
    v_add_f32 v21, v21, v25
    v_mul_f32 v20, v20, v29
    v_mul_f32 v21, v21, v29
    v_cvt_pk_bf16_f32 v20, v20, v21
    ds_write_b32 v3, v20 offset:7168
    ds_write_b32 v5, v17 offset:112
    v_max3_f32 v16, v16, v28, v29
    s_setprio 0
M_O7:
    ds_read_b32 v20, v9 offset:112
    ds_read_b128 v[32:35], v4 offset:7168
    ds_read_b128 v[36:39], v4 offset:7232
    s_waitcnt lgkmcnt(0)
    s_setprio 2
    v_cmp_gt_f32 vcc, 0, v20
    s_setprio 0
    s_cbranch_vccz M_OK7
    s_add_u32 s46, s46, 1
    s_cmp_lt_u32 s46, 262144
    s_cbranch_scc1 M_O7
M_OK7:
    s_waitcnt vmcnt(25)
    v_mfma_f32_16x16x32_bf16 v[64:67], v[96:99], v[32:35], v[64:67]
    v_mfma_f32_16x16x32_bf16 v[68:71], v[100:103], v[32:35], v[68:71]
    v_mfma_f32_16x16x32_bf16 v[72:75], v[104:107], v[32:35], v[72:75]
    v_mfma_f32_16x16x32_bf16 v[76:79], v[108:111], v[32:35], v[76:79]
    v_mfma_f32_16x16x32_bf16 v[80:83], v[112:115], v[32:35], v[80:83]
    v_mfma_f32_16x16x32_bf16 v[84:87], v[116:119], v[32:35], v[84:87]
    v_mfma_f32_16x16x32_bf16 v[88:91], v[120:123], v[32:35], v[88:91]
    v_mfma_f32_16x16x32_bf16 v[92:95], v[124:127], v[32:35], v[92:95]
    v_mfma_f32_16x16x32_bf16 v[64:67], v[128:131], v[36:39], v[64:67]
    v_mfma_f32_16x16x32_bf16 v[68:71], v[132:135], v[36:39], v[68:71]
    v_mfma_f32_16x16x32_bf16 v[72:75], v[136:139], v[36:39], v[72:75]
    v_mfma_f32_16x16x32_bf16 v[76:79], v[140:143], v[36:39], v[76:79]
    v_mfma_f32_16x16x32_bf16 v[80:83], v[144:147], v[36:39], v[80:83]
    v_mfma_f32_16x16x32_bf16 v[84:87], v[148:151], v[36:39], v[84:87]
    v_mfma_f32_16x16x32_bf16 v[88:91], v[152:155], v[36:39], v[88:91]
    v_mfma_f32_16x16x32_bf16 v[92:95], v[156:159], v[36:39], v[92:95]
M_FINAL:
    s_mov_b32 s35, 0x5d800000
    v_cmp_ge_f32 vcc, s35, v16
    v_mov_b32 v33, 0
    v_mov_b32 v7, 0x7fc00000
    v_cndmask_b32 v32, v7, v33, vcc
    v_mov_b32 v34, 0x3f803f80
    v_cndmask_b32 v112, v64, v80, s[62:63]
    v_cndmask_b32 v113, v65, v81, s[62:63]
    v_cndmask_b32 v114, v66, v82, s[62:63]
    v_cndmask_b32 v115, v67, v83, s[62:63]
    v_cndmask_b32 v116, v68, v84, s[62:63]
    v_cndmask_b32 v117, v69, v85, s[62:63]
    v_cndmask_b32 v118, v70, v86, s[62:63]
    v_cndmask_b32 v119, v71, v87, s[62:63]
    v_cndmask_b32 v120, v72, v88, s[62:63]
    v_cndmask_b32 v121, v73, v89, s[62:63]
    v_cndmask_b32 v122, v74, v90, s[62:63]
    v_cndmask_b32 v123, v75, v91, s[62:63]
    v_cndmask_b32 v124, v76, v92, s[62:63]
    v_cndmask_b32 v125, v77, v93, s[62:63]
    v_cndmask_b32 v126, v78, v94, s[62:63]
    v_cndmask_b32 v127, v79, v95, s[62:63]
    v_cvt_pk_bf16_f32 v96, v112, v113
    v_cvt_pk_bf16_f32 v97, v114, v115
    v_cvt_pk_bf16_f32 v98, v116, v117
    v_cvt_pk_bf16_f32 v99, v118, v119
    v_cvt_pk_bf16_f32 v100, v120, v121
    v_cvt_pk_bf16_f32 v101, v122, v123
    v_cvt_pk_bf16_f32 v102, v124, v125
    v_cvt_pk_bf16_f32 v103, v126, v127
    v_dot2c_f32_bf16 v32, v96, v34
    v_dot2c_f32_bf16 v33, v96, v96
    v_dot2c_f32_bf16 v32, v97, v34
    v_dot2c_f32_bf16 v33, v97, v97
    v_dot2c_f32_bf16 v32, v98, v34
    v_dot2c_f32_bf16 v33, v98, v98
    v_dot2c_f32_bf16 v32, v99, v34
    v_dot2c_f32_bf16 v33, v99, v99
    v_dot2c_f32_bf16 v32, v100, v34
    v_dot2c_f32_bf16 v33, v100, v100
    v_dot2c_f32_bf16 v32, v101, v34
    v_dot2c_f32_bf16 v33, v101, v101
    v_dot2c_f32_bf16 v32, v102, v34
    v_dot2c_f32_bf16 v33, v102, v102
    v_dot2c_f32_bf16 v32, v103, v34
    v_dot2c_f32_bf16 v33, v103, v103
    s_lshl_b32 s35, s37, 13
    s_add_u32 s35, s35, 0x21fd0
    v_mov_b32 v28, s35
    v_mov_b32 v7, v32
    v_mov_b32 v8, v33
    v_nop
    v_permlane16_swap_b32 v32, v7
    v_permlane16_swap_b32 v33, v8
    v_add_f32 v32, v32, v7
    v_add_f32 v33, v33, v8
    v_mov_b32 v7, v32
    v_mov_b32 v8, v33
    v_nop
    v_permlane32_swap_b32 v32, v7
    v_permlane32_swap_b32 v33, v8
    v_add_f32 v32, v32, v7
    v_add_f32 v33, v33, v8
    ds_write_b64 v58, v[32:33]
    v_permlane16_swap_b32 v96, v98
    v_permlane16_swap_b32 v97, v99
    v_permlane16_swap_b32 v100, v102
    v_permlane16_swap_b32 v101, v103
    s_mov_b32 s46, 0
    ds_read_b64 v[22:23], v60
    ds_read_b128 v[128:131], v59 offset:0
    ds_read_b128 v[136:139], v59 offset:256
    ds_read_b128 v[132:135], v59 offset:16
    ds_read_b128 v[140:143], v59 offset:272
    s_cmp_eq_u32 s3, 1
    s_cbranch_scc0 M_SF3
    buffer_store_dwordx4 v[96:99], v57, s[28:31], s39 offen nt
    buffer_store_dwordx4 v[100:103], v57, s[28:31], s39 offen offset:2048 nt
M_SE3:
    v_lshlrev_b32 v112, 16, v96
    v_and_b32 v113, 0xffff0000, v96
    v_lshlrev_b32 v114, 16, v97
    v_and_b32 v115, 0xffff0000, v97
    v_lshlrev_b32 v116, 16, v98
    v_and_b32 v117, 0xffff0000, v98
    v_lshlrev_b32 v118, 16, v99
    v_and_b32 v119, 0xffff0000, v99
    v_lshlrev_b32 v120, 16, v100
    v_and_b32 v121, 0xffff0000, v100
    v_lshlrev_b32 v122, 16, v101
    v_and_b32 v123, 0xffff0000, v101
    v_lshlrev_b32 v124, 16, v102
    v_and_b32 v125, 0xffff0000, v102
    v_lshlrev_b32 v126, 16, v103
    v_and_b32 v127, 0xffff0000, v103
M_SP:
    s_waitcnt lgkmcnt(0)
    v_cmp_gt_f32 vcc, 0, v23
    s_cbranch_vccz M_SR
    ds_read_b64 v[22:23], v60
    ds_read_b128 v[128:131], v59 offset:0
    ds_read_b128 v[136:139], v59 offset:256
    ds_read_b128 v[132:135], v59 offset:16
    ds_read_b128 v[140:143], v59 offset:272
    s_add_u32 s46, s46, 1
    s_cmp_lt_u32 s46, 131072
    s_cbranch_scc1 M_SP
    s_waitcnt lgkmcnt(0)
M_SR:
    v_pk_add_f32 v[128:129], v[128:129], v[130:131]
    v_pk_add_f32 v[132:133], v[132:133], v[134:135]
    v_pk_add_f32 v[136:137], v[136:137], v[138:139]
    v_pk_add_f32 v[140:141], v[140:141], v[142:143]
    v_cmp_u_f32 vcc, v22, v22
    v_pk_add_f32 v[128:129], v[128:129], v[132:133]
    v_pk_add_f32 v[136:137], v[136:137], v[140:141]
    v_pk_add_f32 v[128:129], v[128:129], v[136:137]
    s_cmp_lg_u32 s47, 0
    s_cbranch_scc1 M_GO
    s_cbranch_vccnz M_HSLOW
M_GO:
    v_mul_f32 v130, 0x3b000000, v128
    v_mul_f32 v129, 0x3b000000, v129
    v_fma_f32 v129, -v130, v130, v129
    v_max_f32 v129, 0, v129
    v_add_f32 v129, 0x3727c5ac, v129
    v_rsq_f32 v132, v129
    s_nop 0
    v_mul_f32 v132, 0x3eeff558, v132
    v_mul_f32 v130, -v130, v132
    v_pk_fma_f32 v[112:113], v[112:113], v[132:133], v[130:131] op_sel_hi:[1,0,0]
    v_pk_fma_f32 v[114:115], v[114:115], v[132:133], v[130:131] op_sel_hi:[1,0,0]
    v_pk_fma_f32 v[116:117], v[116:117], v[132:133], v[130:131] op_sel_hi:[1,0,0]
    v_pk_fma_f32 v[118:119], v[118:119], v[132:133], v[130:131] op_sel_hi:[1,0,0]
    v_cvt_pk_bf16_f32 v64, v112, v113
    v_cvt_pk_bf16_f32 v65, v114, v115
    v_cvt_pk_bf16_f32 v66, v116, v117
    v_cvt_pk_bf16_f32 v67, v118, v119
    s_cmp_eq_u32 s3, 1
    s_cbranch_scc0 M_SF4
    buffer_store_dwordx4 v[64:67], v57, s[28:31], s38 offen offset:0 nt
M_SE4:
    v_pk_fma_f32 v[120:121], v[120:121], v[132:133], v[130:131] op_sel_hi:[1,0,0]
    v_pk_fma_f32 v[122:123], v[122:123], v[132:133], v[130:131] op_sel_hi:[1,0,0]
    v_pk_fma_f32 v[124:125], v[124:125], v[132:133], v[130:131] op_sel_hi:[1,0,0]
    v_pk_fma_f32 v[126:127], v[126:127], v[132:133], v[130:131] op_sel_hi:[1,0,0]
    v_cvt_pk_bf16_f32 v68, v120, v121
    v_cvt_pk_bf16_f32 v69, v122, v123
    v_cvt_pk_bf16_f32 v70, v124, v125
    v_cvt_pk_bf16_f32 v71, v126, v127
    s_cmp_eq_u32 s3, 1
    s_cbranch_scc0 M_SF5
    buffer_store_dwordx4 v[68:71], v57, s[28:31], s38 offen offset:2048 nt
M_SE5:
    s_cmp_ge_u32 s34, 28
    s_cselect_b32 s35, 32, 0
    v_mov_b32 v20, 0
    v_mov_b32 v24, s35
    v_mov_b32 v25, s35
    v_mov_b32 v26, s35
    v_mov_b32 v27, s35
    ds_write_b32 v28, v20
    ds_write_b128 v28, v[24:27] offset:16
    ds_write_b128 v28, v[24:27] offset:32
    s_lshl_b32 s35, s33, 7
    s_lshl_b32 s38, s37, 2
    s_add_u32 s35, s35, s38
    s_add_u32 s38, s35, 0x240000
    s_waitcnt lgkmcnt(0)
    v_lshlrev_b32 v12, 4, v0
    v_lshrrev_b32 v10, 5, v0
    v_bfe_u32 v11, v0, 2, 2
    v_lshl_add_u32 v10, v10, 3, v11
    v_lshlrev_b32 v10, 7, v10
    v_bfe_u32 v11, v0, 3, 2
    v_lshl_add_u32 v10, v11, 5, v10
    v_bfe_u32 v11, v0, 4, 1
    v_lshl_add_u32 v10, v11, 16, v10
    v_and_b32 v11, 1, v0
    v_lshl_add_u32 v10, v11, 4, v10
    v_bfe_u32 v11, v0, 1, 1
    v_lshl_add_u32 v14, v11, 3, v10
    v_xor_b32 v15, 32, v14
    v_xor_b32 v16, 64, v14
    v_xor_b32 v17, 96, v14
    s_mov_b32 s40, 0x3e60ec05
    s_mov_b32 s41, 0x3e60ec05
    v_mov_b32 v22, 0x409d30fc
    v_mov_b32 v23, 0x409d30fc
    s_lshl_b32 s45, s43, 3
    s_add_u32 s45, s45, s32
    s_lshl_b32 s39, s45, 15
    s_add_u32 s39, s39, 0x500000
    s_mul_i32 s42, s45, 114688
    s_lshl_b32 s35, s34, 12
    s_add_u32 s42, s42, s35
    s_add_u32 s42, s42, 0x800000
    v_bfe_u32 v13, v0, 2, 2
    v_lshlrev_b32 v13, 7, v13
    v_and_b32 v11, 3, v0
    v_lshl_add_u32 v13, v11, 2, v13
    s_lshl_b32 s44, s45, 9
    s_add_u32 s44, s44, 0x240000
    v_mov_b32 v10, s99
    v_mov_b32 v11, 0
    s_waitcnt vmcnt(0)
    s_mov_b64 exec, 1
    s_cmp_eq_u32 s3, 1
    s_cbranch_scc0 M_SF6
    buffer_store_dword v10, v11, s[28:31], s38 offen
M_SE6:
    s_mov_b64 exec, -1
    s_barrier
    s_cmp_ge_u32 s34, 28
    s_cbranch_scc1 M_HD0
    v_and_b32 v8, 3, v0
    v_lshlrev_b32 v8, 13, v8
    s_lshl_b32 s35, s32, 2
    s_add_u32 s35, s35, 0x21fe0
    v_add_u32 v8, s35, v8
    v_mov_b32 v4, 8
    v_mov_b32 v5, 16
    v_mov_b32 v6, 24
    v_mov_b32 v7, 32
    s_mov_b32 s46, 0
M_PLB:
    buffer_load_dword v10, v13, s[28:31], s44 offen sc1
    s_waitcnt vmcnt(0)
    v_cmp_ne_u32 vcc, s99, v10
    s_cbranch_vccz M_PGB
    s_add_u32 s46, s46, 1
    s_sleep 2
    s_cmp_lt_u32 s46, 131072
    s_cbranch_scc1 M_PLB
M_PGB:
    buffer_load_dwordx4 v[128:131], v12, s[28:31], s39 offen offset:0 sc1
    buffer_load_dwordx4 v[132:135], v12, s[28:31], s39 offen offset:1024 sc1
    buffer_load_dwordx4 v[136:139], v12, s[28:31], s39 offen offset:2048 sc1
    s_waitcnt vmcnt(2)
    buffer_load_dwordx4 v[140:143], v12, s[28:31], s39 offen offset:3072 sc1
    s_waitcnt vmcnt(2)
    s_add_u32 s39, s39, 0x1000
    buffer_load_dwordx4 v[144:147], v12, s[28:31], s39 offen offset:0 sc1
    s_waitcnt vmcnt(2)
    buffer_load_dwordx4 v[148:151], v12, s[28:31], s39 offen offset:1024 sc1
    s_waitcnt vmcnt(2)
    buffer_load_dwordx4 v[152:155], v12, s[28:31], s39 offen offset:2048 sc1
    s_waitcnt vmcnt(2)
    buffer_load_dwordx4 v[156:159], v12, s[28:31], s39 offen offset:3072 sc1
    s_waitcnt vmcnt(2)
    s_add_u32 s39, s39, 0x1000
    buffer_load_dwordx4 v[160:163], v12, s[28:31], s39 offen offset:0 sc1
    s_waitcnt vmcnt(2)
    buffer_load_dwordx4 v[164:167], v12, s[28:31], s39 offen offset:1024 sc1
    s_waitcnt vmcnt(2)
    buffer_load_dwordx4 v[168:171], v12, s[28:31], s39 offen offset:2048 sc1
    s_waitcnt vmcnt(2)
    buffer_load_dwordx4 v[172:175], v12, s[28:31], s39 offen offset:3072 sc1
    s_waitcnt vmcnt(2)
    s_add_u32 s39, s39, 0x1000
    buffer_load_dwordx4 v[176:179], v12, s[28:31], s39 offen offset:0 sc1
    s_waitcnt vmcnt(2)
    buffer_load_dwordx4 v[180:183], v12, s[28:31], s39 offen offset:1024 sc1
    s_waitcnt vmcnt(2)
    buffer_load_dwordx4 v[184:187], v12, s[28:31], s39 offen offset:2048 sc1
    s_waitcnt vmcnt(2)
    s_setprio 1
    ds_read_b64_tr_b16 v[32:33], v14 offset:0
    ds_read_b64_tr_b16 v[34:35], v14 offset:512
    ds_read_b64_tr_b16 v[36:37], v15 offset:0
    ds_read_b64_tr_b16 v[38:39], v15 offset:512
    ds_read_b64_tr_b16 v[40:41], v16 offset:0
    ds_read_b64_tr_b16 v[42:43], v16 offset:512
    ds_read_b64_tr_b16 v[44:45], v17 offset:0
    ds_read_b64_tr_b16 v[46:47], v17 offset:512
    ds_read_b64_tr_b16 v[48:49], v14 offset:2048
    ds_read_b64_tr_b16 v[50:51], v14 offset:2560
    ds_read_b64_tr_b16 v[52:53], v15 offset:2048
    ds_read_b64_tr_b16 v[54:55], v15 offset:2560
    ds_read_b64_tr_b16 v[56:57], v16 offset:2048
    ds_read_b64_tr_b16 v[58:59], v16 offset:2560
    s_waitcnt vmcnt(14) lgkmcnt(10)
    v_mfma_f32_32x32x16_bf16 v[64:79], v[32:35], v[128:131], 0
    ds_read_b64_tr_b16 v[60:61], v17 offset:2048
    ds_read_b64_tr_b16 v[62:63], v17 offset:2560
    v_mfma_f32_32x32x16_bf16 v[80:95], v[36:39], v[128:131], 0
    buffer_load_dwordx4 v[188:191], v12, s[28:31], s39 offen offset:3072 sc1
    ds_read_b64_tr_b16 v[32:33], v14 offset:4096
    ds_read_b64_tr_b16 v[34:35], v14 offset:4608
    s_waitcnt lgkmcnt(10)
    v_mfma_f32_32x32x16_bf16 v[96:111], v[40:43], v[128:131], 0
    ds_read_b64_tr_b16 v[36:37], v15 offset:4096
    ds_read_b64_tr_b16 v[38:39], v15 offset:4608
    v_mfma_f32_32x32x16_bf16 v[112:127], v[44:47], v[128:131], 0
    ds_read_b64_tr_b16 v[40:41], v16 offset:4096
    ds_read_b64_tr_b16 v[42:43], v16 offset:4608
    s_waitcnt vmcnt(14) lgkmcnt(10)
    v_mfma_f32_32x32x16_bf16 v[64:79], v[48:51], v[132:135], v[64:79]
    ds_read_b64_tr_b16 v[44:45], v17 offset:4096
    ds_read_b64_tr_b16 v[46:47], v17 offset:4608
    v_mfma_f32_32x32x16_bf16 v[80:95], v[52:55], v[132:135], v[80:95]
    s_add_u32 s39, s39, 0x1000
    buffer_load_dwordx4 v[128:131], v12, s[28:31], s39 offen offset:0 sc1
    ds_read_b64_tr_b16 v[48:49], v14 offset:6144
    ds_read_b64_tr_b16 v[50:51], v14 offset:6656
    s_waitcnt lgkmcnt(10)
    v_mfma_f32_32x32x16_bf16 v[96:111], v[56:59], v[132:135], v[96:111]
    ds_read_b64_tr_b16 v[52:53], v15 offset:6144
    ds_read_b64_tr_b16 v[54:55], v15 offset:6656
    v_mfma_f32_32x32x16_bf16 v[112:127], v[60:63], v[132:135], v[112:127]
    ds_read_b64_tr_b16 v[56:57], v16 offset:6144
    ds_read_b64_tr_b16 v[58:59], v16 offset:6656
    s_waitcnt vmcnt(14) lgkmcnt(10)
    v_mfma_f32_32x32x16_bf16 v[64:79], v[32:35], v[136:139], v[64:79]
    ds_read_b64_tr_b16 v[60:61], v17 offset:6144
    ds_read_b64_tr_b16 v[62:63], v17 offset:6656
    v_mfma_f32_32x32x16_bf16 v[80:95], v[36:39], v[136:139], v[80:95]
    buffer_load_dwordx4 v[132:135], v12, s[28:31], s39 offen offset:1024 sc1
    ds_read_b64_tr_b16 v[32:33], v14 offset:8192
    ds_read_b64_tr_b16 v[34:35], v14 offset:8704
    s_waitcnt lgkmcnt(10)
    v_mfma_f32_32x32x16_bf16 v[96:111], v[40:43], v[136:139], v[96:111]
    ds_read_b64_tr_b16 v[36:37], v15 offset:8192
    ds_read_b64_tr_b16 v[38:39], v15 offset:8704
    v_mfma_f32_32x32x16_bf16 v[112:127], v[44:47], v[136:139], v[112:127]
    ds_read_b64_tr_b16 v[40:41], v16 offset:8192
    ds_read_b64_tr_b16 v[42:43], v16 offset:8704
    s_waitcnt vmcnt(14) lgkmcnt(10)
    v_mfma_f32_32x32x16_bf16 v[64:79], v[48:51], v[140:143], v[64:79]
    ds_read_b64_tr_b16 v[44:45], v17 offset:8192
    ds_read_b64_tr_b16 v[46:47], v17 offset:8704
    v_mfma_f32_32x32x16_bf16 v[80:95], v[52:55], v[140:143], v[80:95]
    buffer_load_dwordx4 v[136:139], v12, s[28:31], s39 offen offset:2048 sc1
    ds_read_b64_tr_b16 v[48:49], v14 offset:10240
    ds_read_b64_tr_b16 v[50:51], v14 offset:10752
    s_waitcnt lgkmcnt(10)
    v_mfma_f32_32x32x16_bf16 v[96:111], v[56:59], v[140:143], v[96:111]
    ds_read_b64_tr_b16 v[52:53], v15 offset:10240
    ds_read_b64_tr_b16 v[54:55], v15 offset:10752
    v_mfma_f32_32x32x16_bf16 v[112:127], v[60:63], v[140:143], v[112:127]
    ds_read_b64_tr_b16 v[56:57], v16 offset:10240
    ds_read_b64_tr_b16 v[58:59], v16 offset:10752
    s_waitcnt vmcnt(14) lgkmcnt(10)
    v_mfma_f32_32x32x16_bf16 v[64:79], v[32:35], v[144:147], v[64:79]
    ds_read_b64_tr_b16 v[60:61], v17 offset:10240
    ds_read_b64_tr_b16 v[62:63], v17 offset:10752
    v_mfma_f32_32x32x16_bf16 v[80:95], v[36:39], v[144:147], v[80:95]
    buffer_load_dwordx4 v[140:143], v12, s[28:31], s39 offen offset:3072 sc1
    ds_read_b64_tr_b16 v[32:33], v14 offset:12288
    ds_read_b64_tr_b16 v[34:35], v14 offset:12800
    s_waitcnt lgkmcnt(10)
    v_mfma_f32_32x32x16_bf16 v[96:111], v[40:43], v[144:147], v[96:111]
    ds_read_b64_tr_b16 v[36:37], v15 offset:12288
    ds_read_b64_tr_b16 v[38:39], v15 offset:12800
    v_mfma_f32_32x32x16_bf16 v[112:127], v[44:47], v[144:147], v[112:127]
    ds_read_b64_tr_b16 v[40:41], v16 offset:12288
    ds_read_b64_tr_b16 v[42:43], v16 offset:12800
    s_waitcnt vmcnt(14) lgkmcnt(10)
    v_mfma_f32_32x32x16_bf16 v[64:79], v[48:51], v[148:151], v[64:79]
    ds_read_b64_tr_b16 v[44:45], v17 offset:12288
    ds_read_b64_tr_b16 v[46:47], v17 offset:12800
    v_mfma_f32_32x32x16_bf16 v[80:95], v[52:55], v[148:151], v[80:95]
    s_add_u32 s39, s39, 0x1000
    buffer_load_dwordx4 v[144:147], v12, s[28:31], s39 offen offset:0 sc1
    ds_read_b64_tr_b16 v[48:49], v14 offset:14336
    ds_read_b64_tr_b16 v[50:51], v14 offset:14848
    s_waitcnt lgkmcnt(10)
    v_mfma_f32_32x32x16_bf16 v[96:111], v[56:59], v[148:151], v[96:111]
    ds_read_b64_tr_b16 v[52:53], v15 offset:14336
    ds_read_b64_tr_b16 v[54:55], v15 offset:14848
    v_mfma_f32_32x32x16_bf16 v[112:127], v[60:63], v[148:151], v[112:127]
    ds_read_b64_tr_b16 v[56:57], v16 offset:14336
    ds_read_b64_tr_b16 v[58:59], v16 offset:14848
    s_waitcnt vmcnt(14) lgkmcnt(10)
    v_mfma_f32_32x32x16_bf16 v[64:79], v[32:35], v[152:155], v[64:79]
    ds_read_b64_tr_b16 v[60:61], v17 offset:14336
    ds_read_b64_tr_b16 v[62:63], v17 offset:14848
    v_mfma_f32_32x32x16_bf16 v[80:95], v[36:39], v[152:155], v[80:95]
    buffer_load_dwordx4 v[148:151], v12, s[28:31], s39 offen offset:1024 sc1
    ds_read_b64_tr_b16 v[32:33], v14 offset:16384
    ds_read_b64_tr_b16 v[34:35], v14 offset:16896
    s_waitcnt lgkmcnt(10)
    v_mfma_f32_32x32x16_bf16 v[96:111], v[40:43], v[152:155], v[96:111]
    ds_read_b64_tr_b16 v[36:37], v15 offset:16384
    ds_read_b64_tr_b16 v[38:39], v15 offset:16896
    v_mfma_f32_32x32x16_bf16 v[112:127], v[44:47], v[152:155], v[112:127]
    ds_read_b64_tr_b16 v[40:41], v16 offset:16384
    ds_read_b64_tr_b16 v[42:43], v16 offset:16896
    s_waitcnt vmcnt(14) lgkmcnt(10)
    v_mfma_f32_32x32x16_bf16 v[64:79], v[48:51], v[156:159], v[64:79]
    ds_read_b64_tr_b16 v[44:45], v17 offset:16384
    ds_read_b64_tr_b16 v[46:47], v17 offset:16896
    v_mfma_f32_32x32x16_bf16 v[80:95], v[52:55], v[156:159], v[80:95]
    buffer_load_dwordx4 v[152:155], v12, s[28:31], s39 offen offset:2048 sc1
    ds_read_b64_tr_b16 v[48:49], v14 offset:18432
    ds_read_b64_tr_b16 v[50:51], v14 offset:18944
    s_waitcnt lgkmcnt(10)
    v_mfma_f32_32x32x16_bf16 v[96:111], v[56:59], v[156:159], v[96:111]
    ds_write_b32 v8, v4
    ds_read_b64_tr_b16 v[52:53], v15 offset:18432
    ds_read_b64_tr_b16 v[54:55], v15 offset:18944
    v_mfma_f32_32x32x16_bf16 v[112:127], v[60:63], v[156:159], v[112:127]
    ds_read_b64_tr_b16 v[56:57], v16 offset:18432
    ds_read_b64_tr_b16 v[58:59], v16 offset:18944
    s_waitcnt vmcnt(14) lgkmcnt(11)
    v_mfma_f32_32x32x16_bf16 v[64:79], v[32:35], v[160:163], v[64:79]
    ds_read_b64_tr_b16 v[60:61], v17 offset:18432
    ds_read_b64_tr_b16 v[62:63], v17 offset:18944
    v_mfma_f32_32x32x16_bf16 v[80:95], v[36:39], v[160:163], v[80:95]
    buffer_load_dwordx4 v[156:159], v12, s[28:31], s39 offen offset:3072 sc1
    ds_read_b64_tr_b16 v[32:33], v14 offset:20480
    ds_read_b64_tr_b16 v[34:35], v14 offset:20992
    s_waitcnt lgkmcnt(11)
    v_mfma_f32_32x32x16_bf16 v[96:111], v[40:43], v[160:163], v[96:111]
    ds_read_b64_tr_b16 v[36:37], v15 offset:20480
    ds_read_b64_tr_b16 v[38:39], v15 offset:20992
    v_mfma_f32_32x32x16_bf16 v[112:127], v[44:47], v[160:163], v[112:127]
    ds_read_b64_tr_b16 v[40:41], v16 offset:20480
    ds_read_b64_tr_b16 v[42:43], v16 offset:20992
    s_waitcnt vmcnt(14) lgkmcnt(10)
    v_mfma_f32_32x32x16_bf16 v[64:79], v[48:51], v[164:167], v[64:79]
    ds_read_b64_tr_b16 v[44:45], v17 offset:20480
    ds_read_b64_tr_b16 v[46:47], v17 offset:20992
    v_mfma_f32_32x32x16_bf16 v[80:95], v[52:55], v[164:167], v[80:95]
    s_add_u32 s39, s39, 0x1000
    buffer_load_dwordx4 v[160:163], v12, s[28:31], s39 offen offset:0 sc1
    ds_read_b64_tr_b16 v[48:49], v14 offset:22528
    ds_read_b64_tr_b16 v[50:51], v14 offset:23040
    s_waitcnt lgkmcnt(10)
    v_mfma_f32_32x32x16_bf16 v[96:111], v[56:59], v[164:167], v[96:111]
    ds_read_b64_tr_b16 v[52:53], v15 offset:22528
    ds_read_b64_tr_b16 v[54:55], v15 offset:23040
    v_mfma_f32_32x32x16_bf16 v[112:127], v[60:63], v[164:167], v[112:127]
    ds_read_b64_tr_b16 v[56:57], v16 offset:22528
    ds_read_b64_tr_b16 v[58:59], v16 offset:23040
    s_waitcnt vmcnt(14) lgkmcnt(10)
    v_mfma_f32_32x32x16_bf16 v[64:79], v[32:35], v[168:171], v[64:79]
    ds_read_b64_tr_b16 v[60:61], v17 offset:22528
    ds_read_b64_tr_b16 v[62:63], v17 offset:23040
    v_mfma_f32_32x32x16_bf16 v[80:95], v[36:39], v[168:171], v[80:95]
    buffer_load_dwordx4 v[164:167], v12, s[28:31], s39 offen offset:1024 sc1
    ds_read_b64_tr_b16 v[32:33], v14 offset:24576
    ds_read_b64_tr_b16 v[34:35], v14 offset:25088
    s_waitcnt lgkmcnt(10)
    v_mfma_f32_32x32x16_bf16 v[96:111], v[40:43], v[168:171], v[96:111]
    ds_read_b64_tr_b16 v[36:37], v15 offset:24576
    ds_read_b64_tr_b16 v[38:39], v15 offset:25088
    v_mfma_f32_32x32x16_bf16 v[112:127], v[44:47], v[168:171], v[112:127]
    ds_read_b64_tr_b16 v[40:41], v16 offset:24576
    ds_read_b64_tr_b16 v[42:43], v16 offset:25088
    s_waitcnt vmcnt(14) lgkmcnt(10)
    v_mfma_f32_32x32x16_bf16 v[64:79], v[48:51], v[172:175], v[64:79]
    ds_read_b64_tr_b16 v[44:45], v17 offset:24576
    ds_read_b64_tr_b16 v[46:47], v17 offset:25088
    v_mfma_f32_32x32x16_bf16 v[80:95], v[52:55], v[172:175], v[80:95]
    buffer_load_dwordx4 v[168:171], v12, s[28:31], s39 offen offset:2048 sc1
    ds_read_b64_tr_b16 v[48:49], v14 offset:26624
    ds_read_b64_tr_b16 v[50:51], v14 offset:27136
    s_waitcnt lgkmcnt(10)
    v_mfma_f32_32x32x16_bf16 v[96:111], v[56:59], v[172:175], v[96:111]
    ds_read_b64_tr_b16 v[52:53], v15 offset:26624
    ds_read_b64_tr_b16 v[54:55], v15 offset:27136
    v_mfma_f32_32x32x16_bf16 v[112:127], v[60:63], v[172:175], v[112:127]
    ds_read_b64_tr_b16 v[56:57], v16 offset:26624
    ds_read_b64_tr_b16 v[58:59], v16 offset:27136
    s_waitcnt vmcnt(14) lgkmcnt(10)
    v_mfma_f32_32x32x16_bf16 v[64:79], v[32:35], v[176:179], v[64:79]
    ds_read_b64_tr_b16 v[60:61], v17 offset:26624
    ds_read_b64_tr_b16 v[62:63], v17 offset:27136
    v_mfma_f32_32x32x16_bf16 v[80:95], v[36:39], v[176:179], v[80:95]
    buffer_load_dwordx4 v[172:175], v12, s[28:31], s39 offen offset:3072 sc1
    ds_read_b64_tr_b16 v[32:33], v14 offset:28672
    ds_read_b64_tr_b16 v[34:35], v14 offset:29184
    s_waitcnt lgkmcnt(10)
    v_mfma_f32_32x32x16_bf16 v[96:111], v[40:43], v[176:179], v[96:111]
    ds_read_b64_tr_b16 v[36:37], v15 offset:28672
    ds_read_b64_tr_b16 v[38:39], v15 offset:29184
    v_mfma_f32_32x32x16_bf16 v[112:127], v[44:47], v[176:179], v[112:127]
    ds_read_b64_tr_b16 v[40:41], v16 offset:28672
    ds_read_b64_tr_b16 v[42:43], v16 offset:29184
    s_waitcnt vmcnt(14) lgkmcnt(10)
    v_mfma_f32_32x32x16_bf16 v[64:79], v[48:51], v[180:183], v[64:79]
    ds_read_b64_tr_b16 v[44:45], v17 offset:28672
    ds_read_b64_tr_b16 v[46:47], v17 offset:29184
    v_mfma_f32_32x32x16_bf16 v[80:95], v[52:55], v[180:183], v[80:95]
    s_add_u32 s39, s39, 0x1000
    buffer_load_dwordx4 v[176:179], v12, s[28:31], s39 offen offset:0 sc1
    ds_read_b64_tr_b16 v[48:49], v14 offset:30720
    ds_read_b64_tr_b16 v[50:51], v14 offset:31232
    s_waitcnt lgkmcnt(10)
    v_mfma_f32_32x32x16_bf16 v[96:111], v[56:59], v[180:183], v[96:111]
    ds_read_b64_tr_b16 v[52:53], v15 offset:30720
    ds_read_b64_tr_b16 v[54:55], v15 offset:31232
    v_mfma_f32_32x32x16_bf16 v[112:127], v[60:63], v[180:183], v[112:127]
    ds_read_b64_tr_b16 v[56:57], v16 offset:30720
    ds_read_b64_tr_b16 v[58:59], v16 offset:31232
    s_waitcnt vmcnt(14) lgkmcnt(10)
    v_mfma_f32_32x32x16_bf16 v[64:79], v[32:35], v[184:187], v[64:79]
    ds_read_b64_tr_b16 v[60:61], v17 offset:30720
    ds_read_b64_tr_b16 v[62:63], v17 offset:31232
    v_mfma_f32_32x32x16_bf16 v[80:95], v[36:39], v[184:187], v[80:95]
    buffer_load_dwordx4 v[180:183], v12, s[28:31], s39 offen offset:1024 sc1
    ds_read_b64_tr_b16 v[32:33], v14 offset:32768
    ds_read_b64_tr_b16 v[34:35], v14 offset:33280
    s_waitcnt lgkmcnt(10)
    v_mfma_f32_32x32x16_bf16 v[96:111], v[40:43], v[184:187], v[96:111]
    ds_read_b64_tr_b16 v[36:37], v15 offset:32768
    ds_read_b64_tr_b16 v[38:39], v15 offset:33280
    v_mfma_f32_32x32x16_bf16 v[112:127], v[44:47], v[184:187], v[112:127]
    ds_read_b64_tr_b16 v[40:41], v16 offset:32768
    ds_read_b64_tr_b16 v[42:43], v16 offset:33280
    s_waitcnt vmcnt(14) lgkmcnt(10)
    v_mfma_f32_32x32x16_bf16 v[64:79], v[48:51], v[188:191], v[64:79]
    ds_read_b64_tr_b16 v[44:45], v17 offset:32768
    ds_read_b64_tr_b16 v[46:47], v17 offset:33280
    v_mfma_f32_32x32x16_bf16 v[80:95], v[52:55], v[188:191], v[80:95]
    buffer_load_dwordx4 v[184:187], v12, s[28:31], s39 offen offset:2048 sc1
    ds_read_b64_tr_b16 v[48:49], v14 offset:34816
    ds_read_b64_tr_b16 v[50:51], v14 offset:35328
    s_waitcnt lgkmcnt(10)
    v_mfma_f32_32x32x16_bf16 v[96:111], v[56:59], v[188:191], v[96:111]
    ds_write_b32 v8, v5
    ds_read_b64_tr_b16 v[52:53], v15 offset:34816
    ds_read_b64_tr_b16 v[54:55], v15 offset:35328
    v_mfma_f32_32x32x16_bf16 v[112:127], v[60:63], v[188:191], v[112:127]
    ds_read_b64_tr_b16 v[56:57], v16 offset:34816
    ds_read_b64_tr_b16 v[58:59], v16 offset:35328
    s_waitcnt vmcnt(14) lgkmcnt(11)
    v_mfma_f32_32x32x16_bf16 v[64:79], v[32:35], v[128:131], v[64:79]
    ds_read_b64_tr_b16 v[60:61], v17 offset:34816
    ds_read_b64_tr_b16 v[62:63], v17 offset:35328
    v_mfma_f32_32x32x16_bf16 v[80:95], v[36:39], v[128:131], v[80:95]
    buffer_load_dwordx4 v[188:191], v12, s[28:31], s39 offen offset:3072 sc1
    ds_read_b64_tr_b16 v[32:33], v14 offset:36864
    ds_read_b64_tr_b16 v[34:35], v14 offset:37376
    s_waitcnt lgkmcnt(11)
    v_mfma_f32_32x32x16_bf16 v[96:111], v[40:43], v[128:131], v[96:111]
    ds_read_b64_tr_b16 v[36:37], v15 offset:36864
    ds_read_b64_tr_b16 v[38:39], v15 offset:37376
    v_mfma_f32_32x32x16_bf16 v[112:127], v[44:47], v[128:131], v[112:127]
    ds_read_b64_tr_b16 v[40:41], v16 offset:36864
    ds_read_b64_tr_b16 v[42:43], v16 offset:37376
    s_waitcnt vmcnt(14) lgkmcnt(10)
    v_mfma_f32_32x32x16_bf16 v[64:79], v[48:51], v[132:135], v[64:79]
    ds_read_b64_tr_b16 v[44:45], v17 offset:36864
    ds_read_b64_tr_b16 v[46:47], v17 offset:37376
    v_mfma_f32_32x32x16_bf16 v[80:95], v[52:55], v[132:135], v[80:95]
    ds_read_b64_tr_b16 v[48:49], v14 offset:38912
    ds_read_b64_tr_b16 v[50:51], v14 offset:39424
    s_waitcnt lgkmcnt(10)
    v_mfma_f32_32x32x16_bf16 v[96:111], v[56:59], v[132:135], v[96:111]
    ds_read_b64_tr_b16 v[52:53], v15 offset:38912
    ds_read_b64_tr_b16 v[54:55], v15 offset:39424
    v_mfma_f32_32x32x16_bf16 v[112:127], v[60:63], v[132:135], v[112:127]
    ds_read_b64_tr_b16 v[56:57], v16 offset:38912
    ds_read_b64_tr_b16 v[58:59], v16 offset:39424
    s_waitcnt vmcnt(13) lgkmcnt(10)
    v_mfma_f32_32x32x16_bf16 v[64:79], v[32:35], v[136:139], v[64:79]
    ds_read_b64_tr_b16 v[60:61], v17 offset:38912
    ds_read_b64_tr_b16 v[62:63], v17 offset:39424
    v_mfma_f32_32x32x16_bf16 v[80:95], v[36:39], v[136:139], v[80:95]
    ds_read_b64_tr_b16 v[32:33], v14 offset:40960
    ds_read_b64_tr_b16 v[34:35], v14 offset:41472
    s_waitcnt lgkmcnt(10)
    v_mfma_f32_32x32x16_bf16 v[96:111], v[40:43], v[136:139], v[96:111]
    ds_read_b64_tr_b16 v[36:37], v15 offset:40960
    ds_read_b64_tr_b16 v[38:39], v15 offset:41472
    v_mfma_f32_32x32x16_bf16 v[112:127], v[44:47], v[136:139], v[112:127]
    ds_read_b64_tr_b16 v[40:41], v16 offset:40960
    ds_read_b64_tr_b16 v[42:43], v16 offset:41472
    s_waitcnt vmcnt(12) lgkmcnt(10)
    v_mfma_f32_32x32x16_bf16 v[64:79], v[48:51], v[140:143], v[64:79]
    ds_read_b64_tr_b16 v[44:45], v17 offset:40960
    ds_read_b64_tr_b16 v[46:47], v17 offset:41472
    v_mfma_f32_32x32x16_bf16 v[80:95], v[52:55], v[140:143], v[80:95]
    ds_read_b64_tr_b16 v[48:49], v14 offset:43008
    ds_read_b64_tr_b16 v[50:51], v14 offset:43520
    s_waitcnt lgkmcnt(10)
    v_mfma_f32_32x32x16_bf16 v[96:111], v[56:59], v[140:143], v[96:111]
    ds_read_b64_tr_b16 v[52:53], v15 offset:43008
    ds_read_b64_tr_b16 v[54:55], v15 offset:43520
    v_mfma_f32_32x32x16_bf16 v[112:127], v[60:63], v[140:143], v[112:127]
    ds_read_b64_tr_b16 v[56:57], v16 offset:43008
    ds_read_b64_tr_b16 v[58:59], v16 offset:43520
    s_waitcnt vmcnt(11) lgkmcnt(10)
    v_mfma_f32_32x32x16_bf16 v[64:79], v[32:35], v[144:147], v[64:79]
    ds_read_b64_tr_b16 v[60:61], v17 offset:43008
    ds_read_b64_tr_b16 v[62:63], v17 offset:43520
    v_mfma_f32_32x32x16_bf16 v[80:95], v[36:39], v[144:147], v[80:95]
    ds_read_b64_tr_b16 v[32:33], v14 offset:45056
    ds_read_b64_tr_b16 v[34:35], v14 offset:45568
    s_waitcnt lgkmcnt(10)
    v_mfma_f32_32x32x16_bf16 v[96:111], v[40:43], v[144:147], v[96:111]
    ds_read_b64_tr_b16 v[36:37], v15 offset:45056
    ds_read_b64_tr_b16 v[38:39], v15 offset:45568
    v_mfma_f32_32x32x16_bf16 v[112:127], v[44:47], v[144:147], v[112:127]
    ds_read_b64_tr_b16 v[40:41], v16 offset:45056
    ds_read_b64_tr_b16 v[42:43], v16 offset:45568
    s_waitcnt vmcnt(10) lgkmcnt(10)
    v_mfma_f32_32x32x16_bf16 v[64:79], v[48:51], v[148:151], v[64:79]
    ds_read_b64_tr_b16 v[44:45], v17 offset:45056
    ds_read_b64_tr_b16 v[46:47], v17 offset:45568
    v_mfma_f32_32x32x16_bf16 v[80:95], v[52:55], v[148:151], v[80:95]
    ds_read_b64_tr_b16 v[48:49], v14 offset:47104
    ds_read_b64_tr_b16 v[50:51], v14 offset:47616
    s_waitcnt lgkmcnt(10)
    v_mfma_f32_32x32x16_bf16 v[96:111], v[56:59], v[148:151], v[96:111]
    ds_read_b64_tr_b16 v[52:53], v15 offset:47104
    ds_read_b64_tr_b16 v[54:55], v15 offset:47616
    v_mfma_f32_32x32x16_bf16 v[112:127], v[60:63], v[148:151], v[112:127]
    ds_read_b64_tr_b16 v[56:57], v16 offset:47104
    ds_read_b64_tr_b16 v[58:59], v16 offset:47616
    s_waitcnt vmcnt(9) lgkmcnt(10)
    v_mfma_f32_32x32x16_bf16 v[64:79], v[32:35], v[152:155], v[64:79]
    ds_read_b64_tr_b16 v[60:61], v17 offset:47104
    ds_read_b64_tr_b16 v[62:63], v17 offset:47616
    v_mfma_f32_32x32x16_bf16 v[80:95], v[36:39], v[152:155], v[80:95]
    ds_read_b64_tr_b16 v[32:33], v14 offset:49152
    ds_read_b64_tr_b16 v[34:35], v14 offset:49664
    s_waitcnt lgkmcnt(10)
    v_mfma_f32_32x32x16_bf16 v[96:111], v[40:43], v[152:155], v[96:111]
    ds_read_b64_tr_b16 v[36:37], v15 offset:49152
    ds_read_b64_tr_b16 v[38:39], v15 offset:49664
    v_mfma_f32_32x32x16_bf16 v[112:127], v[44:47], v[152:155], v[112:127]
    ds_read_b64_tr_b16 v[40:41], v16 offset:49152
    ds_read_b64_tr_b16 v[42:43], v16 offset:49664
    s_waitcnt vmcnt(8) lgkmcnt(10)
    v_mfma_f32_32x32x16_bf16 v[64:79], v[48:51], v[156:159], v[64:79]
    ds_read_b64_tr_b16 v[44:45], v17 offset:49152
    ds_read_b64_tr_b16 v[46:47], v17 offset:49664
    v_mfma_f32_32x32x16_bf16 v[80:95], v[52:55], v[156:159], v[80:95]
    ds_read_b64_tr_b16 v[48:49], v14 offset:51200
    ds_read_b64_tr_b16 v[50:51], v14 offset:51712
    s_waitcnt lgkmcnt(10)
    v_mfma_f32_32x32x16_bf16 v[96:111], v[56:59], v[156:159], v[96:111]
    ds_write_b32 v8, v6
    ds_read_b64_tr_b16 v[52:53], v15 offset:51200
    ds_read_b64_tr_b16 v[54:55], v15 offset:51712
    v_mfma_f32_32x32x16_bf16 v[112:127], v[60:63], v[156:159], v[112:127]
    ds_read_b64_tr_b16 v[56:57], v16 offset:51200
    ds_read_b64_tr_b16 v[58:59], v16 offset:51712
    s_waitcnt vmcnt(7) lgkmcnt(11)
    v_mfma_f32_32x32x16_bf16 v[64:79], v[32:35], v[160:163], v[64:79]
    ds_read_b64_tr_b16 v[60:61], v17 offset:51200
    ds_read_b64_tr_b16 v[62:63], v17 offset:51712
    v_mfma_f32_32x32x16_bf16 v[80:95], v[36:39], v[160:163], v[80:95]
    ds_read_b64_tr_b16 v[32:33], v14 offset:53248
    ds_read_b64_tr_b16 v[34:35], v14 offset:53760
    s_waitcnt lgkmcnt(11)
    v_mfma_f32_32x32x16_bf16 v[96:111], v[40:43], v[160:163], v[96:111]
    ds_read_b64_tr_b16 v[36:37], v15 offset:53248
    ds_read_b64_tr_b16 v[38:39], v15 offset:53760
    v_mfma_f32_32x32x16_bf16 v[112:127], v[44:47], v[160:163], v[112:127]
    ds_read_b64_tr_b16 v[40:41], v16 offset:53248
    ds_read_b64_tr_b16 v[42:43], v16 offset:53760
    s_waitcnt vmcnt(6) lgkmcnt(10)
    v_mfma_f32_32x32x16_bf16 v[64:79], v[48:51], v[164:167], v[64:79]
    ds_read_b64_tr_b16 v[44:45], v17 offset:53248
    ds_read_b64_tr_b16 v[46:47], v17 offset:53760
    v_mfma_f32_32x32x16_bf16 v[80:95], v[52:55], v[164:167], v[80:95]
    ds_read_b64_tr_b16 v[48:49], v14 offset:55296
    ds_read_b64_tr_b16 v[50:51], v14 offset:55808
    s_waitcnt lgkmcnt(10)
    v_mfma_f32_32x32x16_bf16 v[96:111], v[56:59], v[164:167], v[96:111]
    ds_read_b64_tr_b16 v[52:53], v15 offset:55296
    ds_read_b64_tr_b16 v[54:55], v15 offset:55808
    v_mfma_f32_32x32x16_bf16 v[112:127], v[60:63], v[164:167], v[112:127]
    ds_read_b64_tr_b16 v[56:57], v16 offset:55296
    ds_read_b64_tr_b16 v[58:59], v16 offset:55808
    s_waitcnt vmcnt(5) lgkmcnt(10)
    v_mfma_f32_32x32x16_bf16 v[64:79], v[32:35], v[168:171], v[64:79]
    ds_read_b64_tr_b16 v[60:61], v17 offset:55296
    ds_read_b64_tr_b16 v[62:63], v17 offset:55808
    v_mfma_f32_32x32x16_bf16 v[80:95], v[36:39], v[168:171], v[80:95]
    ds_read_b64_tr_b16 v[32:33], v14 offset:57344
    ds_read_b64_tr_b16 v[34:35], v14 offset:57856
    s_waitcnt lgkmcnt(10)
    v_mfma_f32_32x32x16_bf16 v[96:111], v[40:43], v[168:171], v[96:111]
    ds_read_b64_tr_b16 v[36:37], v15 offset:57344
    ds_read_b64_tr_b16 v[38:39], v15 offset:57856
    v_mfma_f32_32x32x16_bf16 v[112:127], v[44:47], v[168:171], v[112:127]
    ds_read_b64_tr_b16 v[40:41], v16 offset:57344
    ds_read_b64_tr_b16 v[42:43], v16 offset:57856
    s_waitcnt vmcnt(4) lgkmcnt(10)
    v_mfma_f32_32x32x16_bf16 v[64:79], v[48:51], v[172:175], v[64:79]
    ds_read_b64_tr_b16 v[44:45], v17 offset:57344
    ds_read_b64_tr_b16 v[46:47], v17 offset:57856
    v_mfma_f32_32x32x16_bf16 v[80:95], v[52:55], v[172:175], v[80:95]
    ds_read_b64_tr_b16 v[48:49], v14 offset:59392
    ds_read_b64_tr_b16 v[50:51], v14 offset:59904
    s_waitcnt lgkmcnt(10)
    v_mfma_f32_32x32x16_bf16 v[96:111], v[56:59], v[172:175], v[96:111]
    ds_read_b64_tr_b16 v[52:53], v15 offset:59392
    ds_read_b64_tr_b16 v[54:55], v15 offset:59904
    v_mfma_f32_32x32x16_bf16 v[112:127], v[60:63], v[172:175], v[112:127]
    ds_read_b64_tr_b16 v[56:57], v16 offset:59392
    ds_read_b64_tr_b16 v[58:59], v16 offset:59904
    s_waitcnt vmcnt(3) lgkmcnt(10)
    v_mfma_f32_32x32x16_bf16 v[64:79], v[32:35], v[176:179], v[64:79]
    ds_read_b64_tr_b16 v[60:61], v17 offset:59392
    ds_read_b64_tr_b16 v[62:63], v17 offset:59904
    v_mfma_f32_32x32x16_bf16 v[80:95], v[36:39], v[176:179], v[80:95]
    ds_read_b64_tr_b16 v[32:33], v14 offset:61440
    ds_read_b64_tr_b16 v[34:35], v14 offset:61952
    s_waitcnt lgkmcnt(10)
    v_mfma_f32_32x32x16_bf16 v[96:111], v[40:43], v[176:179], v[96:111]
    ds_read_b64_tr_b16 v[36:37], v15 offset:61440
    ds_read_b64_tr_b16 v[38:39], v15 offset:61952
    v_mfma_f32_32x32x16_bf16 v[112:127], v[44:47], v[176:179], v[112:127]
    ds_read_b64_tr_b16 v[40:41], v16 offset:61440
    ds_read_b64_tr_b16 v[42:43], v16 offset:61952
    s_waitcnt vmcnt(2) lgkmcnt(10)
    v_mfma_f32_32x32x16_bf16 v[64:79], v[48:51], v[180:183], v[64:79]
    ds_read_b64_tr_b16 v[44:45], v17 offset:61440
    ds_read_b64_tr_b16 v[46:47], v17 offset:61952
    v_mfma_f32_32x32x16_bf16 v[80:95], v[52:55], v[180:183], v[80:95]
    ds_read_b64_tr_b16 v[48:49], v14 offset:63488
    ds_read_b64_tr_b16 v[50:51], v14 offset:64000
    s_waitcnt lgkmcnt(10)
    v_mfma_f32_32x32x16_bf16 v[96:111], v[56:59], v[180:183], v[96:111]
    ds_read_b64_tr_b16 v[52:53], v15 offset:63488
    ds_read_b64_tr_b16 v[54:55], v15 offset:64000
    v_mfma_f32_32x32x16_bf16 v[112:127], v[60:63], v[180:183], v[112:127]
    ds_read_b64_tr_b16 v[56:57], v16 offset:63488
    ds_read_b64_tr_b16 v[58:59], v16 offset:64000
    s_waitcnt vmcnt(1) lgkmcnt(10)
    v_mfma_f32_32x32x16_bf16 v[64:79], v[32:35], v[184:187], v[64:79]
    ds_read_b64_tr_b16 v[60:61], v17 offset:63488
    ds_read_b64_tr_b16 v[62:63], v17 offset:64000
    v_mfma_f32_32x32x16_bf16 v[80:95], v[36:39], v[184:187], v[80:95]
    s_waitcnt lgkmcnt(8)
    v_mfma_f32_32x32x16_bf16 v[96:111], v[40:43], v[184:187], v[96:111]
    v_mfma_f32_32x32x16_bf16 v[112:127], v[44:47], v[184:187], v[112:127]
    s_waitcnt vmcnt(0) lgkmcnt(4)
    v_mfma_f32_32x32x16_bf16 v[64:79], v[48:51], v[188:191], v[64:79]
    v_mfma_f32_32x32x16_bf16 v[80:95], v[52:55], v[188:191], v[80:95]
    s_waitcnt lgkmcnt(0)
    v_mfma_f32_32x32x16_bf16 v[96:111], v[56:59], v[188:191], v[96:111]
    ds_write_b32 v8, v7
    v_mfma_f32_32x32x16_bf16 v[112:127], v[60:63], v[188:191], v[112:127]
    s_nop 7
    v_fma_f32 v24, v64, v64, v22
    v_fma_f32 v25, v65, v65, v22
    v_fma_f32 v26, v66, v66, v22
    v_fma_f32 v27, v67, v67, v22
    v_fma_f32 v28, v68, v68, v22
    v_fma_f32 v29, v69, v69, v22
    v_fma_f32 v30, v70, v70, v22
    v_fma_f32 v31, v71, v71, v22
    v_mul_f32 v24, v24, v64
    v_mul_f32 v25, v25, v65
    v_mul_f32 v26, v26, v66
    v_mul_f32 v27, v27, v67
    v_mul_f32 v28, v28, v68
    v_mul_f32 v29, v29, v69
    v_mul_f32 v30, v30, v70
    v_mul_f32 v31, v31, v71
    v_exp_f32 v24, -v24
    v_exp_f32 v25, -v25
    v_exp_f32 v26, -v26
    v_exp_f32 v27, -v27
    v_exp_f32 v28, -v28
    v_exp_f32 v29, -v29
    v_exp_f32 v30, -v30
    v_exp_f32 v31, -v31
    v_mul_f32 v64, v64, v72
    v_mul_f32 v65, v65, v73
    v_mul_f32 v66, v66, v74
    v_mul_f32 v67, v67, v75
    v_mul_f32 v68, v68, v76
    v_mul_f32 v69, v69, v77
    v_mul_f32 v70, v70, v78
    v_mul_f32 v71, v71, v79
    v_fma_f32 v24, v24, s40, s40
    v_fma_f32 v25, v25, s40, s40
    v_fma_f32 v26, v26, s40, s40
    v_fma_f32 v27, v27, s40, s40
    v_fma_f32 v28, v28, s40, s40
    v_fma_f32 v29, v29, s40, s40
    v_fma_f32 v30, v30, s40, s40
    v_fma_f32 v31, v31, s40, s40
    v_rcp_f32 v24, v24
    v_rcp_f32 v25, v25
    v_rcp_f32 v26, v26
    v_rcp_f32 v27, v27
    v_rcp_f32 v28, v28
    v_rcp_f32 v29, v29
    v_rcp_f32 v30, v30
    v_rcp_f32 v31, v31
    v_mul_f32 v64, v64, v24
    v_mul_f32 v65, v65, v25
    v_mul_f32 v66, v66, v26
    v_mul_f32 v67, v67, v27
    v_mul_f32 v68, v68, v28
    v_mul_f32 v69, v69, v29
    v_mul_f32 v70, v70, v30
    v_mul_f32 v71, v71, v31
    v_cvt_pk_bf16_f32 v32, v64, v65
    v_cvt_pk_bf16_f32 v33, v66, v67
    v_cvt_pk_bf16_f32 v34, v68, v69
    v_cvt_pk_bf16_f32 v35, v70, v71
    s_cmp_eq_u32 s3, 1
    s_cbranch_scc0 M_SF7
    buffer_store_dwordx4 v[32:35], v12, s[28:31], s42 offen offset:0 nt
M_SE7:
    v_fma_f32 v24, v80, v80, v22
    v_fma_f32 v25, v81, v81, v22
    v_fma_f32 v26, v82, v82, v22
    v_fma_f32 v27, v83, v83, v22
    v_fma_f32 v28, v84, v84, v22
    v_fma_f32 v29, v85, v85, v22
    v_fma_f32 v30, v86, v86, v22
    v_fma_f32 v31, v87, v87, v22
    v_mul_f32 v24, v24, v80
    v_mul_f32 v25, v25, v81
    v_mul_f32 v26, v26, v82
    v_mul_f32 v27, v27, v83
    v_mul_f32 v28, v28, v84
    v_mul_f32 v29, v29, v85
    v_mul_f32 v30, v30, v86
    v_mul_f32 v31, v31, v87
    v_exp_f32 v24, -v24
    v_exp_f32 v25, -v25
    v_exp_f32 v26, -v26
    v_exp_f32 v27, -v27
    v_exp_f32 v28, -v28
    v_exp_f32 v29, -v29
    v_exp_f32 v30, -v30
    v_exp_f32 v31, -v31
    v_mul_f32 v80, v80, v88
    v_mul_f32 v81, v81, v89
    v_mul_f32 v82, v82, v90
    v_mul_f32 v83, v83, v91
    v_mul_f32 v84, v84, v92
    v_mul_f32 v85, v85, v93
    v_mul_f32 v86, v86, v94
    v_mul_f32 v87, v87, v95
    v_fma_f32 v24, v24, s40, s40
    v_fma_f32 v25, v25, s40, s40
    v_fma_f32 v26, v26, s40, s40
    v_fma_f32 v27, v27, s40, s40
    v_fma_f32 v28, v28, s40, s40
    v_fma_f32 v29, v29, s40, s40
    v_fma_f32 v30, v30, s40, s40
    v_fma_f32 v31, v31, s40, s40
    v_rcp_f32 v24, v24
    v_rcp_f32 v25, v25
    v_rcp_f32 v26, v26
    v_rcp_f32 v27, v27
    v_rcp_f32 v28, v28
    v_rcp_f32 v29, v29
    v_rcp_f32 v30, v30
    v_rcp_f32 v31, v31
    v_mul_f32 v80, v80, v24
    v_mul_f32 v81, v81, v25
    v_mul_f32 v82, v82, v26
    v_mul_f32 v83, v83, v27
    v_mul_f32 v84, v84, v28
    v_mul_f32 v85, v85, v29
    v_mul_f32 v86, v86, v30
    v_mul_f32 v87, v87, v31
    v_cvt_pk_bf16_f32 v36, v80, v81
    v_cvt_pk_bf16_f32 v37, v82, v83
    v_cvt_pk_bf16_f32 v38, v84, v85
    v_cvt_pk_bf16_f32 v39, v86, v87
    s_cmp_eq_u32 s3, 1
    s_cbranch_scc0 M_SF8
    buffer_store_dwordx4 v[36:39], v12, s[28:31], s42 offen offset:1024 nt
M_SE8:
    v_fma_f32 v24, v96, v96, v22
    v_fma_f32 v25, v97, v97, v22
    v_fma_f32 v26, v98, v98, v22
    v_fma_f32 v27, v99, v99, v22
    v_fma_f32 v28, v100, v100, v22
    v_fma_f32 v29, v101, v101, v22
    v_fma_f32 v30, v102, v102, v22
    v_fma_f32 v31, v103, v103, v22
    v_mul_f32 v24, v24, v96
    v_mul_f32 v25, v25, v97
    v_mul_f32 v26, v26, v98
    v_mul_f32 v27, v27, v99
    v_mul_f32 v28, v28, v100
    v_mul_f32 v29, v29, v101
    v_mul_f32 v30, v30, v102
    v_mul_f32 v31, v31, v103
    v_exp_f32 v24, -v24
    v_exp_f32 v25, -v25
    v_exp_f32 v26, -v26
    v_exp_f32 v27, -v27
    v_exp_f32 v28, -v28
    v_exp_f32 v29, -v29
    v_exp_f32 v30, -v30
    v_exp_f32 v31, -v31
    v_mul_f32 v96, v96, v104
    v_mul_f32 v97, v97, v105
    v_mul_f32 v98, v98, v106
    v_mul_f32 v99, v99, v107
    v_mul_f32 v100, v100, v108
    v_mul_f32 v101, v101, v109
    v_mul_f32 v102, v102, v110
    v_mul_f32 v103, v103, v111
    v_fma_f32 v24, v24, s40, s40
    v_fma_f32 v25, v25, s40, s40
    v_fma_f32 v26, v26, s40, s40
    v_fma_f32 v27, v27, s40, s40
    v_fma_f32 v28, v28, s40, s40
    v_fma_f32 v29, v29, s40, s40
    v_fma_f32 v30, v30, s40, s40
    v_fma_f32 v31, v31, s40, s40
    v_rcp_f32 v24, v24
    v_rcp_f32 v25, v25
    v_rcp_f32 v26, v26
    v_rcp_f32 v27, v27
    v_rcp_f32 v28, v28
    v_rcp_f32 v29, v29
    v_rcp_f32 v30, v30
    v_rcp_f32 v31, v31
    v_mul_f32 v96, v96, v24
    v_mul_f32 v97, v97, v25
    v_mul_f32 v98, v98, v26
    v_mul_f32 v99, v99, v27
    v_mul_f32 v100, v100, v28
    v_mul_f32 v101, v101, v29
    v_mul_f32 v102, v102, v30
    v_mul_f32 v103, v103, v31
    v_cvt_pk_bf16_f32 v40, v96, v97
    v_cvt_pk_bf16_f32 v41, v98, v99
    v_cvt_pk_bf16_f32 v42, v100, v101
    v_cvt_pk_bf16_f32 v43, v102, v103
    s_cmp_eq_u32 s3, 1
    s_cbranch_scc0 M_SF9
    buffer_store_dwordx4 v[40:43], v12, s[28:31], s42 offen offset:2048 nt
M_SE9:
    v_fma_f32 v24, v112, v112, v22
    v_fma_f32 v25, v113, v113, v22
    v_fma_f32 v26, v114, v114, v22
    v_fma_f32 v27, v115, v115, v22
    v_fma_f32 v28, v116, v116, v22
    v_fma_f32 v29, v117, v117, v22
    v_fma_f32 v30, v118, v118, v22
    v_fma_f32 v31, v119, v119, v22
    v_mul_f32 v24, v24, v112
    v_mul_f32 v25, v25, v113
    v_mul_f32 v26, v26, v114
    v_mul_f32 v27, v27, v115
    v_mul_f32 v28, v28, v116
    v_mul_f32 v29, v29, v117
    v_mul_f32 v30, v30, v118
    v_mul_f32 v31, v31, v119
    v_exp_f32 v24, -v24
    v_exp_f32 v25, -v25
    v_exp_f32 v26, -v26
    v_exp_f32 v27, -v27
    v_exp_f32 v28, -v28
    v_exp_f32 v29, -v29
    v_exp_f32 v30, -v30
    v_exp_f32 v31, -v31
    v_mul_f32 v112, v112, v120
    v_mul_f32 v113, v113, v121
    v_mul_f32 v114, v114, v122
    v_mul_f32 v115, v115, v123
    v_mul_f32 v116, v116, v124
    v_mul_f32 v117, v117, v125
    v_mul_f32 v118, v118, v126
    v_mul_f32 v119, v119, v127
    v_fma_f32 v24, v24, s40, s40
    v_fma_f32 v25, v25, s40, s40
    v_fma_f32 v26, v26, s40, s40
    v_fma_f32 v27, v27, s40, s40
    v_fma_f32 v28, v28, s40, s40
    v_fma_f32 v29, v29, s40, s40
    v_fma_f32 v30, v30, s40, s40
    v_fma_f32 v31, v31, s40, s40
    v_rcp_f32 v24, v24
    v_rcp_f32 v25, v25
    v_rcp_f32 v26, v26
    v_rcp_f32 v27, v27
    v_rcp_f32 v28, v28
    v_rcp_f32 v29, v29
    v_rcp_f32 v30, v30
    v_rcp_f32 v31, v31
    v_mul_f32 v112, v112, v24
    v_mul_f32 v113, v113, v25
    v_mul_f32 v114, v114, v26
    v_mul_f32 v115, v115, v27
    v_mul_f32 v116, v116, v28
    v_mul_f32 v117, v117, v29
    v_mul_f32 v118, v118, v30
    v_mul_f32 v119, v119, v31
    v_cvt_pk_bf16_f32 v44, v112, v113
    v_cvt_pk_bf16_f32 v45, v114, v115
    v_cvt_pk_bf16_f32 v46, v116, v117
    v_cvt_pk_bf16_f32 v47, v118, v119
    s_cmp_eq_u32 s3, 1
    s_cbranch_scc0 M_SF10
    buffer_store_dwordx4 v[44:47], v12, s[28:31], s42 offen offset:3072 nt
M_SE10:
M_HD0:
    s_and_b32 s37, s32, 3
    s_lshr_b32 s38, s34, 2
    v_lshlrev_b32 v12, 4, v0
    v_lshrrev_b32 v2, 5, v0
    v_bfe_u32 v3, v0, 2, 2
    v_lshl_add_u32 v1, v2, 3, v3
    v_lshlrev_b32 v1, 7, v1
    v_bfe_u32 v13, v0, 4, 1
    v_and_b32 v3, 2, v3
    v_xor_b32 v13, v13, v3
    v_lshl_add_u32 v1, v13, 5, v1
    v_and_b32 v3, 1, v0
    v_lshl_add_u32 v1, v3, 4, v1
    v_bfe_u32 v3, v0, 1, 1
    v_lshl_add_u32 v1, v3, 3, v1
    s_lshr_b32 s20, s37, 1
    s_lshl_b32 s20, s20, 16
    s_and_b32 s21, s37, 1
    s_lshl_b32 s21, s21, 13
    s_add_u32 s20, s20, s21
    s_lshl_b32 s21, s37, 13
    s_add_u32 s21, s21, 0x20000
    v_add_u32 v4, s20, v1
    v_xor_b32 v5, 64, v4
    v_add_u32 v6, s21, v1
    v_xor_b32 v7, 64, v6
    v_lshrrev_b32 v13, 3, v0
    v_and_b32 v1, 7, v0
    v_lshlrev_b32 v3, 4, v1
    v_lshl_add_u32 v3, v13, 10, v3
    v_lshlrev_b32 v1, 9, v1
    v_lshl_add_u32 v1, v13, 4, v1
    s_and_b32 s39, s34, 3
    s_add_u32 s39, s39, 4
    s_lshl_b32 s35, s43, 3
    s_add_u32 s35, s35, s39
    s_mul_i32 s40, s35, 114688
    s_mul_i32 s41, s37, 28672
    s_add_u32 s40, s40, s41
    s_add_u32 s40, s40, 0x800000
    s_lshl_b32 s35, s35, 15
    s_lshl_b32 s42, s38, 7
    s_add_u32 s42, s42, s35
    s_add_u32 s42, s42, s21
    s_sub_u32 s42, s42, 0x20000
    s_lshl_b32 s41, s38, 12
    s_add_u32 s41, s41, s35
    s_lshl_b32 s35, s37, 7
    s_add_u32 s41, s41, s35
    s_add_u32 s41, s41, 0x300000
    v_min_u32 v13, 6, v0
    v_lshlrev_b32 v13, 7, v13
    s_lshl_b32 s44, s43, 12
    s_mul_i32 s35, s37, 896
    s_add_u32 s44, s44, s35
    s_lshl_b32 s39, s39, 2
    s_add_u32 s44, s44, s39
    s_add_u32 s44, s44, 0x248000
    s_cmp_ge_u32 s34, 28
    s_cbranch_scc1 M_HD2
    s_waitcnt vmcnt(0)
    s_lshl_b32 s35, s33, 7
    s_lshl_b32 s45, s32, 2
    s_add_u32 s35, s35, s45
    s_add_u32 s35, s35, 0x248000
    v_mov_b32 v10, s99
    v_mov_b32 v11, 0
    s_mov_b64 exec, 1
    s_cmp_eq_u32 s3, 1
    s_cbranch_scc0 M_SF11
    buffer_store_dword v10, v11, s[28:31], s35 offen
M_SE11:
    s_mov_b64 exec, -1
M_HD2:
    s_mov_b32 s46, 0
M_PLD:
    buffer_load_dword v15, v13, s[28:31], s44 offen sc1
    s_waitcnt vmcnt(0)
    v_cmp_ne_u32 vcc, s99, v15
    s_cbranch_vccz M_PGD
    s_add_u32 s46, s46, 1
    s_sleep 2
    s_cmp_lt_u32 s46, 131072
    s_cbranch_scc1 M_PLD
M_PGD:
    s_add_u32 s39, s40, 20480
    buffer_load_dwordx4 v[144:147], v12, s[28:31], s39 offen offset:0 sc1
    buffer_load_dwordx4 v[148:151], v12, s[28:31], s39 offen offset:1024 sc1
    buffer_load_dwordx4 v[152:155], v12, s[28:31], s39 offen offset:2048 sc1
    buffer_load_dwordx4 v[156:159], v12, s[28:31], s39 offen offset:3072 sc1
    s_add_u32 s39, s40, 24576
    buffer_load_dwordx4 v[160:163], v12, s[28:31], s39 offen offset:0 sc1
    buffer_load_dwordx4 v[164:167], v12, s[28:31], s39 offen offset:1024 sc1
    buffer_load_dwordx4 v[168:171], v12, s[28:31], s39 offen offset:2048 sc1
    buffer_load_dwordx4 v[172:175], v12, s[28:31], s39 offen offset:3072 sc1
    s_add_u32 s39, s40, 4096
    buffer_load_dwordx4 v[80:83], v12, s[28:31], s39 offen offset:0 sc1
    buffer_load_dwordx4 v[84:87], v12, s[28:31], s39 offen offset:1024 sc1
    s_waitcnt vmcnt(9)
    v_mfma_f32_32x32x16_bf16 v[32:47], v[192:195], v[144:147], 0
    v_mfma_f32_32x32x16_bf16 v[48:63], v[196:199], v[144:147], 0
    buffer_load_dwordx4 v[88:91], v12, s[28:31], s39 offen offset:2048 sc1
    s_waitcnt vmcnt(9)
    v_mfma_f32_32x32x16_bf16 v[32:47], v[200:203], v[148:151], v[32:47]
    v_mfma_f32_32x32x16_bf16 v[48:63], v[204:207], v[148:151], v[48:63]
    buffer_load_dwordx4 v[92:95], v12, s[28:31], s39 offen offset:3072 sc1
    s_waitcnt vmcnt(9)
    v_mfma_f32_32x32x16_bf16 v[32:47], v[208:211], v[152:155], v[32:47]
    v_mfma_f32_32x32x16_bf16 v[48:63], v[212:215], v[152:155], v[48:63]
    s_add_u32 s39, s40, 8192
    buffer_load_dwordx4 v[96:99], v12, s[28:31], s39 offen offset:0 sc1
    s_waitcnt vmcnt(9)
    v_mfma_f32_32x32x16_bf16 v[32:47], v[216:219], v[156:159], v[32:47]
    v_mfma_f32_32x32x16_bf16 v[48:63], v[220:223], v[156:159], v[48:63]
    buffer_load_dwordx4 v[100:103], v12, s[28:31], s39 offen offset:1024 sc1
    s_waitcnt vmcnt(9)
    v_mfma_f32_32x32x16_bf16 v[32:47], v[224:227], v[160:163], v[32:47]
    v_mfma_f32_32x32x16_bf16 v[48:63], v[228:231], v[160:163], v[48:63]
    buffer_load_dwordx4 v[104:107], v12, s[28:31], s39 offen offset:2048 sc1
    s_waitcnt vmcnt(9)
    v_mfma_f32_32x32x16_bf16 v[32:47], v[232:235], v[164:167], v[32:47]
    v_mfma_f32_32x32x16_bf16 v[48:63], v[236:239], v[164:167], v[48:63]
    buffer_load_dwordx4 v[108:111], v12, s[28:31], s39 offen offset:3072 sc1
    s_barrier
    ds_read_b64_tr_b16 v[16:17], v4 offset:0
    ds_read_b64_tr_b16 v[18:19], v4 offset:512
    s_waitcnt vmcnt(9)
    v_mfma_f32_32x32x16_bf16 v[32:47], v[240:243], v[168:171], v[32:47]
    ds_read_b64_tr_b16 v[20:21], v5 offset:0
    ds_read_b64_tr_b16 v[22:23], v5 offset:512
    v_mfma_f32_32x32x16_bf16 v[48:63], v[244:247], v[168:171], v[48:63]
    s_add_u32 s39, s40, 12288
    buffer_load_dwordx4 v[112:115], v12, s[28:31], s39 offen offset:0 sc1
    ds_read_b64_tr_b16 v[24:25], v4 offset:2048
    ds_read_b64_tr_b16 v[26:27], v4 offset:2560
    s_waitcnt vmcnt(9)
    v_mfma_f32_32x32x16_bf16 v[32:47], v[248:251], v[172:175], v[32:47]
    ds_read_b64_tr_b16 v[28:29], v5 offset:2048
    ds_read_b64_tr_b16 v[30:31], v5 offset:2560
    v_mfma_f32_32x32x16_bf16 v[48:63], v[252:255], v[172:175], v[48:63]
    buffer_load_dwordx4 v[116:119], v12, s[28:31], s39 offen offset:1024 sc1
    ds_read_b64_tr_b16 v[176:177], v4 offset:4096
    ds_read_b64_tr_b16 v[178:179], v4 offset:4608
    s_waitcnt vmcnt(9) lgkmcnt(6)
    v_mfma_f32_32x32x16_bf16 v[32:47], v[16:19], v[80:83], v[32:47]
    ds_read_b64_tr_b16 v[180:181], v5 offset:4096
    ds_read_b64_tr_b16 v[182:183], v5 offset:4608
    v_mfma_f32_32x32x16_bf16 v[48:63], v[20:23], v[80:83], v[48:63]
    buffer_load_dwordx4 v[120:123], v12, s[28:31], s39 offen offset:2048 sc1
    ds_read_b64_tr_b16 v[184:185], v4 offset:6144
    ds_read_b64_tr_b16 v[186:187], v4 offset:6656
    s_waitcnt vmcnt(9) lgkmcnt(6)
    v_mfma_f32_32x32x16_bf16 v[32:47], v[24:27], v[84:87], v[32:47]
    ds_read_b64_tr_b16 v[188:189], v5 offset:6144
    ds_read_b64_tr_b16 v[190:191], v5 offset:6656
    v_mfma_f32_32x32x16_bf16 v[48:63], v[28:31], v[84:87], v[48:63]
    buffer_load_dwordx4 v[124:127], v12, s[28:31], s39 offen offset:3072 sc1
    ds_read_b64_tr_b16 v[16:17], v4 offset:16384
    ds_read_b64_tr_b16 v[18:19], v4 offset:16896
    s_waitcnt vmcnt(9) lgkmcnt(6)
    v_mfma_f32_32x32x16_bf16 v[32:47], v[176:179], v[88:91], v[32:47]
    ds_read_b64_tr_b16 v[20:21], v5 offset:16384
    ds_read_b64_tr_b16 v[22:23], v5 offset:16896
    v_mfma_f32_32x32x16_bf16 v[48:63], v[180:183], v[88:91], v[48:63]
    s_add_u32 s39, s40, 16384
    buffer_load_dwordx4 v[128:131], v12, s[28:31], s39 offen offset:0 sc1
    ds_read_b64_tr_b16 v[24:25], v4 offset:18432
    ds_read_b64_tr_b16 v[26:27], v4 offset:18944
    s_waitcnt vmcnt(9) lgkmcnt(6)
    v_mfma_f32_32x32x16_bf16 v[32:47], v[184:187], v[92:95], v[32:47]
    ds_read_b64_tr_b16 v[28:29], v5 offset:18432
    ds_read_b64_tr_b16 v[30:31], v5 offset:18944
    v_mfma_f32_32x32x16_bf16 v[48:63], v[188:191], v[92:95], v[48:63]
    buffer_load_dwordx4 v[132:135], v12, s[28:31], s39 offen offset:1024 sc1
    s_barrier
    ds_read_b64_tr_b16 v[176:177], v4 offset:20480
    ds_read_b64_tr_b16 v[178:179], v4 offset:20992
    s_waitcnt vmcnt(9) lgkmcnt(6)
    v_mfma_f32_32x32x16_bf16 v[32:47], v[16:19], v[96:99], v[32:47]
    ds_read_b64_tr_b16 v[180:181], v5 offset:20480
    ds_read_b64_tr_b16 v[182:183], v5 offset:20992
    v_mfma_f32_32x32x16_bf16 v[48:63], v[20:23], v[96:99], v[48:63]
    buffer_load_dwordx4 v[136:139], v12, s[28:31], s39 offen offset:2048 sc1
    ds_read_b64_tr_b16 v[184:185], v4 offset:22528
    ds_read_b64_tr_b16 v[186:187], v4 offset:23040
    s_waitcnt vmcnt(9) lgkmcnt(6)
    v_mfma_f32_32x32x16_bf16 v[32:47], v[24:27], v[100:103], v[32:47]
    ds_read_b64_tr_b16 v[188:189], v5 offset:22528
    ds_read_b64_tr_b16 v[190:191], v5 offset:23040
    v_mfma_f32_32x32x16_bf16 v[48:63], v[28:31], v[100:103], v[48:63]
    buffer_load_dwordx4 v[140:143], v12, s[28:31], s39 offen offset:3072 sc1
    ds_read_b64_tr_b16 v[16:17], v4 offset:32768
    ds_read_b64_tr_b16 v[18:19], v4 offset:33280
    s_waitcnt vmcnt(9) lgkmcnt(6)
    v_mfma_f32_32x32x16_bf16 v[32:47], v[176:179], v[104:107], v[32:47]
    ds_read_b64_tr_b16 v[20:21], v5 offset:32768
    ds_read_b64_tr_b16 v[22:23], v5 offset:33280
    v_mfma_f32_32x32x16_bf16 v[48:63], v[180:183], v[104:107], v[48:63]
    s_add_u32 s39, s40, 0
    buffer_load_dwordx4 v[64:67], v12, s[28:31], s39 offen offset:0 sc1
    ds_read_b64_tr_b16 v[24:25], v4 offset:34816
    ds_read_b64_tr_b16 v[26:27], v4 offset:35328
    s_waitcnt vmcnt(9) lgkmcnt(6)
    v_mfma_f32_32x32x16_bf16 v[32:47], v[184:187], v[108:111], v[32:47]
    ds_read_b64_tr_b16 v[28:29], v5 offset:34816
    ds_read_b64_tr_b16 v[30:31], v5 offset:35328
    v_mfma_f32_32x32x16_bf16 v[48:63], v[188:191], v[108:111], v[48:63]
    buffer_load_dwordx4 v[68:71], v12, s[28:31], s39 offen offset:1024 sc1
    ds_read_b64_tr_b16 v[176:177], v4 offset:36864
    ds_read_b64_tr_b16 v[178:179], v4 offset:37376
    s_waitcnt vmcnt(9) lgkmcnt(6)
    v_mfma_f32_32x32x16_bf16 v[32:47], v[16:19], v[112:115], v[32:47]
    ds_read_b64_tr_b16 v[180:181], v5 offset:36864
    ds_read_b64_tr_b16 v[182:183], v5 offset:37376
    v_mfma_f32_32x32x16_bf16 v[48:63], v[20:23], v[112:115], v[48:63]
    buffer_load_dwordx4 v[72:75], v12, s[28:31], s39 offen offset:2048 sc1
    ds_read_b64_tr_b16 v[184:185], v4 offset:38912
    ds_read_b64_tr_b16 v[186:187], v4 offset:39424
    s_waitcnt vmcnt(9) lgkmcnt(6)
    v_mfma_f32_32x32x16_bf16 v[32:47], v[24:27], v[116:119], v[32:47]
    ds_read_b64_tr_b16 v[188:189], v5 offset:38912
    ds_read_b64_tr_b16 v[190:191], v5 offset:39424
    v_mfma_f32_32x32x16_bf16 v[48:63], v[28:31], v[116:119], v[48:63]
    buffer_load_dwordx4 v[76:79], v12, s[28:31], s39 offen offset:3072 sc1
    ds_read_b64_tr_b16 v[16:17], v4 offset:49152
    ds_read_b64_tr_b16 v[18:19], v4 offset:49664
    s_waitcnt vmcnt(9) lgkmcnt(6)
    v_mfma_f32_32x32x16_bf16 v[32:47], v[176:179], v[120:123], v[32:47]
    ds_read_b64_tr_b16 v[20:21], v5 offset:49152
    ds_read_b64_tr_b16 v[22:23], v5 offset:49664
    v_mfma_f32_32x32x16_bf16 v[48:63], v[180:183], v[120:123], v[48:63]
    buffer_load_dwordx4 v[8:11], v1, s[28:31], s41 offen sc1
    ds_read_b64_tr_b16 v[24:25], v4 offset:51200
    ds_read_b64_tr_b16 v[26:27], v4 offset:51712
    s_waitcnt vmcnt(9) lgkmcnt(6)
    v_mfma_f32_32x32x16_bf16 v[32:47], v[184:187], v[124:127], v[32:47]
    ds_read_b64_tr_b16 v[28:29], v5 offset:51200
    ds_read_b64_tr_b16 v[30:31], v5 offset:51712
    v_mfma_f32_32x32x16_bf16 v[48:63], v[188:191], v[124:127], v[48:63]
    ds_read_b64_tr_b16 v[176:177], v4 offset:53248
    ds_read_b64_tr_b16 v[178:179], v4 offset:53760
    s_waitcnt vmcnt(8) lgkmcnt(6)
    v_mfma_f32_32x32x16_bf16 v[32:47], v[16:19], v[128:131], v[32:47]
    ds_read_b64_tr_b16 v[180:181], v5 offset:53248
    ds_read_b64_tr_b16 v[182:183], v5 offset:53760
    v_mfma_f32_32x32x16_bf16 v[48:63], v[20:23], v[128:131], v[48:63]
    ds_read_b64_tr_b16 v[184:185], v4 offset:55296
    ds_read_b64_tr_b16 v[186:187], v4 offset:55808
    s_waitcnt vmcnt(7) lgkmcnt(6)
    v_mfma_f32_32x32x16_bf16 v[32:47], v[24:27], v[132:135], v[32:47]
    ds_read_b64_tr_b16 v[188:189], v5 offset:55296
    ds_read_b64_tr_b16 v[190:191], v5 offset:55808
    v_mfma_f32_32x32x16_bf16 v[48:63], v[28:31], v[132:135], v[48:63]
    ds_read_b64_tr_b16 v[16:17], v6 offset:0
    ds_read_b64_tr_b16 v[18:19], v6 offset:512
    s_waitcnt vmcnt(6) lgkmcnt(6)
    v_mfma_f32_32x32x16_bf16 v[32:47], v[176:179], v[136:139], v[32:47]
    ds_read_b64_tr_b16 v[20:21], v7 offset:0
    ds_read_b64_tr_b16 v[22:23], v7 offset:512
    v_mfma_f32_32x32x16_bf16 v[48:63], v[180:183], v[136:139], v[48:63]
    ds_read_b64_tr_b16 v[24:25], v6 offset:2048
    ds_read_b64_tr_b16 v[26:27], v6 offset:2560
    s_waitcnt vmcnt(5) lgkmcnt(6)
    v_mfma_f32_32x32x16_bf16 v[32:47], v[184:187], v[140:143], v[32:47]
    ds_read_b64_tr_b16 v[28:29], v7 offset:2048
    ds_read_b64_tr_b16 v[30:31], v7 offset:2560
    v_mfma_f32_32x32x16_bf16 v[48:63], v[188:191], v[140:143], v[48:63]
    ds_read_b64_tr_b16 v[176:177], v6 offset:4096
    ds_read_b64_tr_b16 v[178:179], v6 offset:4608
    s_waitcnt vmcnt(4) lgkmcnt(6)
    v_mfma_f32_32x32x16_bf16 v[32:47], v[16:19], v[64:67], v[32:47]
    ds_read_b64_tr_b16 v[180:181], v7 offset:4096
    ds_read_b64_tr_b16 v[182:183], v7 offset:4608
    v_mfma_f32_32x32x16_bf16 v[48:63], v[20:23], v[64:67], v[48:63]
    ds_read_b64_tr_b16 v[184:185], v6 offset:6144
    ds_read_b64_tr_b16 v[186:187], v6 offset:6656
    s_waitcnt vmcnt(3) lgkmcnt(6)
    v_mfma_f32_32x32x16_bf16 v[32:47], v[24:27], v[68:71], v[32:47]
    ds_read_b64_tr_b16 v[188:189], v7 offset:6144
    ds_read_b64_tr_b16 v[190:191], v7 offset:6656
    v_mfma_f32_32x32x16_bf16 v[48:63], v[28:31], v[68:71], v[48:63]
    s_waitcnt vmcnt(2) lgkmcnt(4)
    v_mfma_f32_32x32x16_bf16 v[32:47], v[176:179], v[72:75], v[32:47]
    v_mfma_f32_32x32x16_bf16 v[48:63], v[180:183], v[72:75], v[48:63]
    s_waitcnt vmcnt(1) lgkmcnt(0)
    v_mfma_f32_32x32x16_bf16 v[32:47], v[184:187], v[76:79], v[32:47]
    v_mfma_f32_32x32x16_bf16 v[48:63], v[188:191], v[76:79], v[48:63]
    v_lshrrev_b32 v13, 5, v0
    v_lshlrev_b32 v13, 5, v13
    v_xor_b32 v13, v13, v12
    v_add_u32 v4, s20, v13
    v_xor_b32 v5, 64, v4
    v_xor_b32 v6, 128, v4
    v_xor_b32 v7, 192, v4
    s_nop 4
    ds_write_b128 v4, v[32:35] offset:16384
    ds_write_b128 v4, v[36:39] offset:17408
    ds_write_b128 v5, v[40:43] offset:18432
    ds_write_b128 v5, v[44:47] offset:19456
    ds_write_b128 v6, v[48:51] offset:20480
    ds_write_b128 v6, v[52:55] offset:21504
    ds_write_b128 v7, v[56:59] offset:22528
    ds_write_b128 v7, v[60:63] offset:23552
    v_and_b32 v13, 7, v0
    v_lshrrev_b32 v14, 3, v0
    s_lshl_b32 s35, s37, 3
    v_add_u32 v14, s35, v14
    v_lshlrev_b32 v15, 1, v13
    v_xor_b32 v14, v14, v15
    v_lshlrev_b32 v14, 4, v14
    v_and_b32 v15, 1, v13
    v_lshl_add_u32 v14, v15, 9, v14
    v_lshrrev_b32 v15, 1, v13
    v_lshl_add_u32 v15, v15, 11, v14
    v_add_u32 v13, 0x10000, v15
    s_waitcnt vmcnt(0)
    v_lshlrev_b32 v16, 16, v8
    v_and_b32 v17, 0xffff0000, v8
    v_lshlrev_b32 v18, 16, v9
    v_and_b32 v19, 0xffff0000, v9
    v_lshlrev_b32 v20, 16, v10
    v_and_b32 v21, 0xffff0000, v10
    v_lshlrev_b32 v22, 16, v11
    v_and_b32 v23, 0xffff0000, v11
    s_waitcnt lgkmcnt(0)
    s_barrier
    ds_read_b128 v[192:195], v15 offset:16384
    ds_read_b128 v[196:199], v15 offset:17408
    ds_read_b128 v[200:203], v15 offset:24576
    ds_read_b128 v[204:207], v15 offset:25600
    ds_read_b128 v[208:211], v13 offset:16384
    ds_read_b128 v[212:215], v13 offset:17408
    ds_read_b128 v[216:219], v13 offset:24576
    ds_read_b128 v[220:223], v13 offset:25600
    s_waitcnt lgkmcnt(6)
    s_waitcnt lgkmcnt(4)
    v_pk_add_f32 v[192:193], v[192:193], v[200:201]
    v_pk_add_f32 v[194:195], v[194:195], v[202:203]
    v_pk_add_f32 v[196:197], v[196:197], v[204:205]
    v_pk_add_f32 v[198:199], v[198:199], v[206:207]
    s_waitcnt lgkmcnt(2)
    v_pk_add_f32 v[192:193], v[192:193], v[208:209]
    v_pk_add_f32 v[194:195], v[194:195], v[210:211]
    v_pk_add_f32 v[196:197], v[196:197], v[212:213]
    v_pk_add_f32 v[198:199], v[198:199], v[214:215]
    s_waitcnt lgkmcnt(0)
    v_pk_add_f32 v[192:193], v[192:193], v[216:217]
    v_pk_add_f32 v[194:195], v[194:195], v[218:219]
    v_pk_add_f32 v[196:197], v[196:197], v[220:221]
    v_pk_add_f32 v[198:199], v[198:199], v[222:223]
    v_pk_add_f32 v[192:193], v[192:193], v[16:17]
    v_pk_add_f32 v[194:195], v[194:195], v[18:19]
    v_pk_add_f32 v[196:197], v[196:197], v[20:21]
    v_pk_add_f32 v[198:199], v[198:199], v[22:23]
    v_cvt_pk_bf16_f32 v8, v192, v193
    v_cvt_pk_bf16_f32 v9, v194, v195
    v_cvt_pk_bf16_f32 v10, v196, v197
    v_cvt_pk_bf16_f32 v11, v198, v199
    buffer_store_dwordx4 v[8:11], v3, s[16:19], s42 offen nt
M_END:
    s_endpgm
M_HSLOW:
    v_mov_b32 v20, 1
    ds_write_b32 v28, v20
    s_waitcnt vmcnt(0) lgkmcnt(0)
    s_barrier
    v_mov_b32 v26, -1.0
    v_mov_b32 v27, -1.0
    ds_write_b64 v58, v[26:27]
    s_waitcnt lgkmcnt(0)
    s_mov_b32 s47, 1
    s_mov_b32 s61, 0
    v_mov_b32 v16, 0
    v_lshlrev_b32 v64, 16, v40
    v_and_b32 v65, 0xffff0000, v40
    v_lshlrev_b32 v66, 16, v41
    v_and_b32 v67, 0xffff0000, v41
    v_lshlrev_b32 v68, 16, v42
    v_and_b32 v69, 0xffff0000, v42
    v_lshlrev_b32 v70, 16, v43
    v_and_b32 v71, 0xffff0000, v43
    v_lshlrev_b32 v72, 16, v44
    v_and_b32 v73, 0xffff0000, v44
    v_lshlrev_b32 v74, 16, v45
    v_and_b32 v75, 0xffff0000, v45
    v_lshlrev_b32 v76, 16, v46
    v_and_b32 v77, 0xffff0000, v46
    v_lshlrev_b32 v78, 16, v47
    v_and_b32 v79, 0xffff0000, v47
    v_lshlrev_b32 v80, 16, v48
    v_and_b32 v81, 0xffff0000, v48
    v_lshlrev_b32 v82, 16, v49
    v_and_b32 v83, 0xffff0000, v49
    v_lshlrev_b32 v84, 16, v50
    v_and_b32 v85, 0xffff0000, v50
    v_lshlrev_b32 v86, 16, v51
    v_and_b32 v87, 0xffff0000, v51
    v_lshlrev_b32 v88, 16, v52
    v_and_b32 v89, 0xffff0000, v52
    v_lshlrev_b32 v90, 16, v53
    v_and_b32 v91, 0xffff0000, v53
    v_lshlrev_b32 v92, 16, v54
    v_and_b32 v93, 0xffff0000, v54
    v_lshlrev_b32 v94, 16, v55
    v_and_b32 v95, 0xffff0000, v55
M_HSLOOP:
    s_add_u32 s23, s20, s61
    s_add_u32 s45, s23, 0
    buffer_load_dwordx4 v[96:99], v14, s[28:31], s45 offen offset:0 sc1
    buffer_load_dwordx4 v[100:103], v14, s[28:31], s45 offen offset:1024 sc1
    buffer_load_dwordx4 v[104:107], v14, s[28:31], s45 offen offset:2048 sc1
    buffer_load_dwordx4 v[108:111], v14, s[28:31], s45 offen offset:3072 sc1
    s_add_u32 s45, s23, 4096
    buffer_load_dwordx4 v[112:115], v14, s[28:31], s45 offen offset:0 sc1
    buffer_load_dwordx4 v[116:119], v14, s[28:31], s45 offen offset:1024 sc1
    buffer_load_dwordx4 v[120:123], v14, s[28:31], s45 offen offset:2048 sc1
    buffer_load_dwordx4 v[124:127], v14, s[28:31], s45 offen offset:3072 sc1
    s_add_u32 s45, s23, 8192
    buffer_load_dwordx4 v[128:131], v14, s[28:31], s45 offen offset:0 sc1
    buffer_load_dwordx4 v[132:135], v14, s[28:31], s45 offen offset:1024 sc1
    buffer_load_dwordx4 v[136:139], v14, s[28:31], s45 offen offset:2048 sc1
    buffer_load_dwordx4 v[140:143], v14, s[28:31], s45 offen offset:3072 sc1
    s_add_u32 s45, s23, 12288
    buffer_load_dwordx4 v[144:147], v14, s[28:31], s45 offen offset:0 sc1
    buffer_load_dwordx4 v[148:151], v14, s[28:31], s45 offen offset:1024 sc1
    buffer_load_dwordx4 v[152:155], v14, s[28:31], s45 offen offset:2048 sc1
    buffer_load_dwordx4 v[156:159], v14, s[28:31], s45 offen offset:3072 sc1
    s_barrier
    s_barrier
    ds_read2st64_b32 v[28:29], v56 offset0:116 offset1:125
    ds_read2st64_b32 v[30:31], v56 offset0:134 offset1:143
    ds_read_b64 v[20:21], v19 offset:27648
    ds_read_b64 v[22:23], v19 offset:29952
    ds_read_b64 v[24:25], v19 offset:32256
    ds_read_b64 v[26:27], v19 offset:34560
    s_waitcnt lgkmcnt(0)
    s_setprio 2
    v_add_f32 v28, v28, v29
    v_add_f32 v30, v30, v31
    v_add_f32 v28, v28, v30
    v_rcp_f32 v29, v28
    v_add_f32 v20, v20, v22
    v_add_f32 v21, v21, v23
    v_add_f32 v24, v24, v26
    v_add_f32 v25, v25, v27
    v_add_f32 v20, v20, v24
    v_add_f32 v21, v21, v25
    v_mul_f32 v20, v20, v29
    v_mul_f32 v21, v21, v29
    v_cvt_pk_bf16_f32 v20, v20, v21
    ds_write_b32 v3, v20 offset:7168
    v_max3_f32 v16, v16, v28, v29
    s_setprio 0
    s_waitcnt lgkmcnt(0)
    s_barrier
    ds_read_b128 v[32:35], v4 offset:7168
    ds_read_b128 v[36:39], v4 offset:7232
    s_waitcnt lgkmcnt(0)
    s_waitcnt vmcnt(0)
    v_mfma_f32_16x16x32_bf16 v[64:67], v[96:99], v[32:35], v[64:67]
    v_mfma_f32_16x16x32_bf16 v[68:71], v[100:103], v[32:35], v[68:71]
    v_mfma_f32_16x16x32_bf16 v[72:75], v[104:107], v[32:35], v[72:75]
    v_mfma_f32_16x16x32_bf16 v[76:79], v[108:111], v[32:35], v[76:79]
    v_mfma_f32_16x16x32_bf16 v[80:83], v[112:115], v[32:35], v[80:83]
    v_mfma_f32_16x16x32_bf16 v[84:87], v[116:119], v[32:35], v[84:87]
    v_mfma_f32_16x16x32_bf16 v[88:91], v[120:123], v[32:35], v[88:91]
    v_mfma_f32_16x16x32_bf16 v[92:95], v[124:127], v[32:35], v[92:95]
    v_mfma_f32_16x16x32_bf16 v[64:67], v[128:131], v[36:39], v[64:67]
    v_mfma_f32_16x16x32_bf16 v[68:71], v[132:135], v[36:39], v[68:71]
    v_mfma_f32_16x16x32_bf16 v[72:75], v[136:139], v[36:39], v[72:75]
    v_mfma_f32_16x16x32_bf16 v[76:79], v[140:143], v[36:39], v[76:79]
    v_mfma_f32_16x16x32_bf16 v[80:83], v[144:147], v[36:39], v[80:83]
    v_mfma_f32_16x16x32_bf16 v[84:87], v[148:151], v[36:39], v[84:87]
    v_mfma_f32_16x16x32_bf16 v[88:91], v[152:155], v[36:39], v[88:91]
    v_mfma_f32_16x16x32_bf16 v[92:95], v[156:159], v[36:39], v[92:95]
    s_add_u32 s61, s61, 0x10000
    s_cmp_lt_u32 s61, 0x80000
    s_cbranch_scc1 M_HSLOOP
    s_nop 7
    s_branch M_FINAL
M_SF0:
    buffer_store_dword v10, v11, s[28:31], s35 offen sc1
    s_branch M_SE0
M_SF1:
    buffer_store_dwordx4 v[128:131], v125, s[28:31], s41 offen sc1
    buffer_store_dwordx4 v[132:135], v125, s[28:31], s4 offen sc1
    buffer_store_dwordx4 v[136:139], v125, s[28:31], s5 offen sc1
    buffer_store_dwordx4 v[140:143], v125, s[28:31], s6 offen sc1
    buffer_store_dwordx4 v[144:147], v125, s[28:31], s7 offen sc1
    buffer_store_dwordx4 v[148:151], v125, s[28:31], s8 offen sc1
    buffer_store_dwordx4 v[152:155], v125, s[28:31], s9 offen sc1
    buffer_store_dwordx4 v[156:159], v125, s[28:31], s10 offen sc1
    s_branch M_SE1
M_SF2:
    buffer_store_dword v126, v127, s[28:31], s35 offen sc1
    s_branch M_SE2
M_SF3:
    buffer_store_dwordx4 v[96:99], v57, s[28:31], s39 offen sc1
    buffer_store_dwordx4 v[100:103], v57, s[28:31], s39 offen offset:2048 sc1
    s_branch M_SE3
M_SF4:
    buffer_store_dwordx4 v[64:67], v57, s[28:31], s38 offen offset:0 sc1
    s_branch M_SE4
M_SF5:
    buffer_store_dwordx4 v[68:71], v57, s[28:31], s38 offen offset:2048 sc1
    s_branch M_SE5
M_SF6:
    buffer_store_dword v10, v11, s[28:31], s38 offen sc1
    s_branch M_SE6
M_SF7:
    buffer_store_dwordx4 v[32:35], v12, s[28:31], s42 offen offset:0 sc1
    s_branch M_SE7
M_SF8:
    buffer_store_dwordx4 v[36:39], v12, s[28:31], s42 offen offset:1024 sc1
    s_branch M_SE8
M_SF9:
    buffer_store_dwordx4 v[40:43], v12, s[28:31], s42 offen offset:2048 sc1
    s_branch M_SE9
M_SF10:
    buffer_store_dwordx4 v[44:47], v12, s[28:31], s42 offen offset:3072 sc1
    s_branch M_SE10
M_SF11:
    buffer_store_dword v10, v11, s[28:31], s35 offen sc1
    s_branch M_SE11
CODE_END:
.section .rodata,"a"
.p2align 6
.amdhsa_kernel sequential_preLN__grouped_kv_mqa__geglu_ffn__prompt_kernel
  .amdhsa_next_free_vgpr 256
  .amdhsa_next_free_sgpr 102
  .amdhsa_accum_offset 256
  .amdhsa_group_segment_fixed_size 0
  .amdhsa_kernarg_size 96
  .amdhsa_user_sgpr_count 2
  .amdhsa_user_sgpr_kernarg_segment_ptr 1
  .amdhsa_system_sgpr_workgroup_id_x 1
.end_amdhsa_kernel
```
